```python
import torch

def _softmax(x, axis=-1):
    return torch.softmax(x, dim=axis)
def _gelu(x):
    return torch.nn.functional.gelu(x, approximate="tanh")
def _silu(x):
    return torch.nn.functional.silu(x)
def _sigmoid(x):
    return torch.sigmoid(x)
def _layernorm(x, axis=-1, eps=1e-5):
    m = x.mean(dim=axis, keepdim=True)
    v = x.var(dim=axis, keepdim=True, unbiased=False)
    return (x - m) / torch.sqrt(v + eps)
def _scatter_add(tgt, idx, src, axis=0):
    return tgt.clone().index_add_(axis, idx, src)
def _segment_sum(src, seg, n):
    out = torch.zeros((n,) + src.shape[1:], dtype=src.dtype)
    return out.index_add_(0, seg, src)
def _pad(x, pw):
    flat = tuple(v for pair in reversed(pw) for v in pair)
    return torch.nn.functional.pad(x, flat)

kernel_name = 'recurrent_scan__ssm_conv_h3__mixer_s_mlp__prompt'

def setup_inputs():

    _w = (lambda a: (lambda t: t.to(torch.bfloat16) if t.is_floating_point() else t)(torch.as_tensor(a)))
    def _A_setup():
        B, S, D = 1, 2048, 1024
        ks = 4
        return {
            "q": _w((lambda *s: torch.randn(*s, dtype=torch.bfloat16) * 0.05)(B, S, D)),
            "k": _w((lambda *s: torch.randn(*s, dtype=torch.bfloat16) * 0.2)(B, S, D)),
            "v": _w((lambda *s: torch.randn(*s, dtype=torch.bfloat16) * 0.2)(B, S, D)),
            "shift_k": _w((lambda *s: torch.randn(*s, dtype=torch.bfloat16) * 0.2)(D, ks) * 0.5),
            "ssm_k": _w((lambda *s: torch.randn(*s, dtype=torch.bfloat16) * 0.2)(D, S) * (1.0 / S ** 0.5)),
            "ssm_D": _w((lambda *s: torch.randn(*s, dtype=torch.bfloat16) * 0.2)(D)),
        }
    _A_in = _A_setup()

    def _B_setup():
        B, S, D, F = 1, 2048, 1024, 3584
        return {
            "x":  _w((lambda *s: torch.randn(*s, dtype=torch.bfloat16) * 0.05)(B, S, D)),
            "w1": _w((lambda *s: torch.randn(*s, dtype=torch.bfloat16) * 1.6)(D, D) * (D ** -0.5)),
            "w2": _w((lambda *s: torch.randn(*s, dtype=torch.bfloat16) * 1.6)(D, D) * (D ** -0.5)),
            "w3": _w((lambda *s: torch.randn(*s, dtype=torch.bfloat16) * 1.6)(D, F) * (D ** -0.5)),
            "w4": _w((lambda *s: torch.randn(*s, dtype=torch.bfloat16) * 1.6)(F, D) * (F ** -0.5)),
        }
    _B_in = _B_setup()

    return {
        "A_q": _A_in["q"],
        "A_k": _A_in["k"],
        "A_v": _A_in["v"],
        "A_shift_k": _A_in["shift_k"],
        "A_ssm_k": _A_in["ssm_k"],
        "A_ssm_D": _A_in["ssm_D"],
        "B_x": _B_in["x"],
        "B_w1": _B_in["w1"],
        "B_w2": _B_in["w2"],
        "B_w3": _B_in["w3"],
        "B_w4": _B_in["w4"],
    }

def reference(A_q, A_k, A_v, A_shift_k, A_ssm_k, A_ssm_D, B_x, B_w1, B_w2, B_w3, B_w4):
    def _A_ref(q, k, v, shift_k, ssm_k, ssm_D):
        B, S, D = q.shape
        ks = shift_k.shape[-1]
        k_pad = _pad(k, ((0, 0), (ks - 1, 0), (0, 0)))
        k_shift = torch.zeros_like(k)
        for t in range(ks):
            k_shift = k_shift + k_pad[:, t:t + S, :] * shift_k[:, ks - 1 - t][None, None, :]
        kv = k_shift * v
        L = 2 * S
        kv_pad = _pad(kv, ((0, 0), (0, S), (0, 0)))
        kf_pad = _pad(ssm_k, ((0, 0), (0, S)))
        kv_f = (lambda x, axes=(-2,-1): torch.fft.rfft2(x.float(), dim=axes))(kv_pad[:, None, :, :], axes=(1, 2))
        kf_f = (lambda x, axes=(-2,-1): torch.fft.rfft2(x.float(), dim=axes))(kf_pad[:, None, :], axes=(1, 2))
        kf_f = (lambda x, *d: x.permute(*d))(kf_f, 1, 2, 0)
        y_f = kv_f * kf_f[None, :, :, :]
        y = (lambda x, s, axes=(-2,-1): torch.fft.irfft2(x, s=s, dim=axes).to(torch.bfloat16))(y_f, (1, L), axes=(1, 2))[:, 0, :S, :]
        y = y + kv * ssm_D[None, None, :]
        return q * y

    def _B_ref(x, w1, w2, w3, w4):
        B, S, D = x.shape
        h = _gelu(_layernorm(x, axis=-1) @ w1)
        c = D // 4
        g0 = _pad(h[:, :, 0*c:1*c], ((0, 0), (1, 0), (0, 0)))[:, :S, :]
        g1 = _pad(h[:, :, 1*c:2*c], ((0, 0), (0, 1), (0, 0)))[:, 1:, :]
        g2 = _pad(h[:, :, 2*c:3*c], ((0, 0), (2, 0), (0, 0)))[:, :S, :]
        g3 = _pad(h[:, :, 3*c:   ], ((0, 0), (0, 2), (0, 0)))[:, 2:, :]
        hs = torch.concatenate([g0, g1, g2, g3], axis=-1) @ w2
        x1 = x + hs
        h2 = _gelu(_layernorm(x1, axis=-1) @ w3) @ w4
        return x1 + h2

    x = A_q
    xn = _layernorm(x, axis=-1)
    s = _A_ref(xn, A_k, A_v, A_shift_k, A_ssm_k, A_ssm_D)
    g = _silu(_B_ref(xn, B_w1, B_w2, B_w3, B_w4))
    return x + s * g
```

```asm
; @launch grid=(256,1,1) block=(512,1,1) lds=163840
.amdgcn_target "amdgcn-amd-amdhsa--gfx950"
.text
.globl recurrent_scan__ssm_conv_h3__mixer_s_mlp__prompt_kernel
.p2align 8
.type recurrent_scan__ssm_conv_h3__mixer_s_mlp__prompt_kernel,@function
recurrent_scan__ssm_conv_h3__mixer_s_mlp__prompt_kernel:
  s_cmp_ge_u32 s2, 256
  s_cbranch_scc1 recurrent_scan__ssm_conv_h3__mixer_s_mlp__prompt_kernel_end
  s_load_dwordx2 s[4:5], s[0:1], 104
  s_mov_b32 s6, 268435456
  s_mov_b32 s7, 0x20000
  v_lshrrev_b32 v2, 6, v0
  v_and_b32 v1, 63, v0
  v_readfirstlane_b32 s33, v2
  s_and_b32 s28, s2, 7
  s_lshr_b32 s29, s2, 3
  s_mov_b32 s101, 0
  s_cmp_lg_u32 s33, 3
  s_cbranch_scc1 recurrent_scan__ssm_conv_h3__mixer_s_mlp__prompt_kernel_nopf2
  s_getpc_b64 s[96:97]
recurrent_scan__ssm_conv_h3__mixer_s_mlp__prompt_kernel_pc1:
  s_sub_u32 s96, s96, recurrent_scan__ssm_conv_h3__mixer_s_mlp__prompt_kernel_pc1-recurrent_scan__ssm_conv_h3__mixer_s_mlp__prompt_kernel
  s_subb_u32 s97, s97, 0
  s_mov_b32 s98, code_end-recurrent_scan__ssm_conv_h3__mixer_s_mlp__prompt_kernel
  s_mov_b32 s99, 0x20000
  s_mov_b32 s95, ((code_end-recurrent_scan__ssm_conv_h3__mixer_s_mlp__prompt_kernel+4095)>>12)-1
  v_min_u32 v191, s95, v1
  s_mul_i32 s95, s29, ((code_end-recurrent_scan__ssm_conv_h3__mixer_s_mlp__prompt_kernel+4095)>>12)*128
  v_lshlrev_b32 v191, 7, v191
  buffer_load_dword v191, v191, s[96:99], s95 offen
recurrent_scan__ssm_conv_h3__mixer_s_mlp__prompt_kernel_nopf2:
  s_load_dwordx2 s[8:9], s[0:1], 0
  s_mov_b32 s10, 4194304
  s_mov_b32 s11, 0x20000
  s_load_dwordx2 s[12:13], s[0:1], 56
  s_mov_b32 s14, 2097152
  s_mov_b32 s15, 0x20000
  s_load_dwordx2 s[76:77], s[0:1], 96
  s_mov_b32 s78, 256
  s_mov_b32 s79, 0x20000
  s_cmp_lt_u32 s29, 16
  s_cbranch_scc1 k1_prep
  s_sub_u32 s29, s29, 16
  s_lshr_b32 s36, s28, 1
  s_mul_i32 s36, s36, 4
  s_lshr_b32 s37, s29, 2
  s_add_u32 s34, s36, s37
  s_and_b32 s36, s28, 1
  s_mul_i32 s36, s36, 4
  s_and_b32 s37, s29, 3
  s_add_u32 s35, s36, s37
  s_lshr_b32 s36, s35, 2
  s_add_u32 s36, s36, 1
  s_sub_u32 s37, 0, s36
  s_bitcmp1_b32 s35, 1
  s_cselect_b32 s36, s36, s37
  s_lshl_b32 s43, s34, 7
  s_add_u32 s43, s43, s36
  s_mov_b32 s30, 0
  s_lshl_b32 s31, s35, 8
  s_cmp_ge_u32 s33, 4
  s_cbranch_scc0 k1_compute
  s_sub_u32 s40, s33, 4
  s_lshl_b32 s41, s40, 12
  v_lshrrev_b32 v2, 3, v1
  v_and_b32 v3, 7, v1
  v_xor_b32 v3, v3, v2
  v_lshlrev_b32 v3, 4, v3
  s_lshl_b32 s36, s40, 5
  s_add_u32 s36, s36, s43
  v_add_u32 v2, s36, v2
  v_lshl_add_u32 v6, v2, 11, v3
  v_add_u32 v7, 15360, v6
  v_add_u32 v8, 30720, v6
  v_add_u32 v9, 46080, v6
  v_lshrrev_b32 v2, 4, v1
  v_and_b32 v3, 15, v1
  v_lshlrev_b32 v4, 1, v2
  v_xor_b32 v3, v3, v4
  v_lshlrev_b32 v3, 4, v3
  v_lshl_add_u32 v3, v2, 11, v3
  s_lshl_b32 s36, s40, 15
  v_add_u32_e64 v10, s36, v3
  v_add_u32 v11, 7168, v10
  v_xor_b32 v3, 128, v10
  v_add_u32 v12, 14336, v3
  v_add_u32 v13, 21504, v3
  s_mul_i32 s42, s40, 4096
  s_add_u32 s42, s42, 16384
  s_waitcnt lgkmcnt(0)
  s_add_u32 m0, s41, 0
  s_nop 0
  buffer_load_dwordx4 v6, s[8:11], s30 offen offset:0  lds
  buffer_load_dwordx4 v7, s[8:11], s30 offen offset:1024  lds
  buffer_load_dwordx4 v8, s[8:11], s30 offen offset:2048  lds
  buffer_load_dwordx4 v9, s[8:11], s30 offen offset:3072  lds
  s_add_u32 s30, s30, 128
  s_add_u32 m0, s42, 0
  s_nop 0
  buffer_load_dwordx4 v10, s[12:15], s31 offen offset:0 lds
  buffer_load_dwordx4 v11, s[12:15], s31 offen offset:1024 lds
  buffer_load_dwordx4 v12, s[12:15], s31 offen offset:2048 lds
  buffer_load_dwordx4 v13, s[12:15], s31 offen offset:3072 lds
  s_add_u32 s31, s31, 131072
  s_add_u32 m0, s41, 32768
  s_nop 0
  buffer_load_dwordx4 v6, s[8:11], s30 offen offset:0  lds
  buffer_load_dwordx4 v7, s[8:11], s30 offen offset:1024  lds
  buffer_load_dwordx4 v8, s[8:11], s30 offen offset:2048  lds
  buffer_load_dwordx4 v9, s[8:11], s30 offen offset:3072  lds
  s_add_u32 s30, s30, 128
  s_add_u32 m0, s42, 32768
  s_nop 0
  buffer_load_dwordx4 v10, s[12:15], s31 offen offset:0 lds
  buffer_load_dwordx4 v11, s[12:15], s31 offen offset:1024 lds
  buffer_load_dwordx4 v12, s[12:15], s31 offen offset:2048 lds
  buffer_load_dwordx4 v13, s[12:15], s31 offen offset:3072 lds
  s_add_u32 s31, s31, 131072
  s_add_u32 s20, s4, 36732928
  s_addc_u32 s21, s5, 0
  s_mov_b32 s22, 16384
  s_mov_b32 s23, 0x20000
  s_load_dwordx2 s[16:17], s[0:1], 64
  s_mov_b32 s18, 2097152
  s_mov_b32 s19, 0x20000
  s_lshl_b32 s81, s35, 8
  s_lshl_b32 s84, s35, 1
  s_add_u32 s85, s84, 1
  s_waitcnt lgkmcnt(0)
  v_and_b32 v2, 31, v1
  s_lshl_b32 s50, s40, 5
  v_add_u32 v2, s50, v2
  v_add_u32 v3, s43, v2
  v_lshlrev_b32 v20, 3, v3
  v_lshlrev_b32 v21, 3, v2
  v_add_u32 v21, 131072, v21
  v_lshrrev_b32 v3, 5, v1
  v_lshlrev_b32 v3, 14, v3
  v_lshl_add_u32 v22, v2, 2, v3
  v_lshlrev_b32 v23, 2, v2
  v_add_u32 v23, 132096, v23
  s_lshl_b32 s50, s35, 9
  s_add_u32 s50, s50, 37224448
  v_and_b32 v24, 7, v1
  v_lshlrev_b32 v24, 5, v24
  s_waitcnt vmcnt(8)
  s_barrier
  s_add_u32 m0, s41, 65536
  s_nop 0
  buffer_load_dwordx4 v6, s[8:11], s30 offen offset:0  lds
  buffer_load_dwordx4 v7, s[8:11], s30 offen offset:1024  lds
  buffer_load_dwordx4 v8, s[8:11], s30 offen offset:2048  lds
  buffer_load_dwordx4 v9, s[8:11], s30 offen offset:3072  lds
  s_add_u32 s30, s30, 128
  s_add_u32 m0, s42, 65536
  s_nop 0
  buffer_load_dwordx4 v10, s[12:15], s31 offen offset:0 lds
  buffer_load_dwordx4 v11, s[12:15], s31 offen offset:1024 lds
  buffer_load_dwordx4 v12, s[12:15], s31 offen offset:2048 lds
  buffer_load_dwordx4 v13, s[12:15], s31 offen offset:3072 lds
  s_add_u32 s31, s31, 131072
  s_add_u32 m0, s41, 98304
  s_nop 0
  buffer_load_dwordx4 v6, s[8:11], s30 offen offset:0  lds
  buffer_load_dwordx4 v7, s[8:11], s30 offen offset:1024  lds
  buffer_load_dwordx4 v8, s[8:11], s30 offen offset:2048  lds
  buffer_load_dwordx4 v9, s[8:11], s30 offen offset:3072  lds
  s_add_u32 s30, s30, 128
  s_add_u32 m0, s42, 98304
  s_nop 0
  buffer_load_dwordx4 v10, s[12:15], s31 offen offset:0 lds
  buffer_load_dwordx4 v11, s[12:15], s31 offen offset:1024 lds
  buffer_load_dwordx4 v12, s[12:15], s31 offen offset:2048 lds
  buffer_load_dwordx4 v13, s[12:15], s31 offen offset:3072 lds
  s_add_u32 s31, s31, 131072
  s_waitcnt vmcnt(16)
  s_barrier
  s_add_u32 m0, s41, 0
  s_nop 0
  buffer_load_dwordx4 v6, s[8:11], s30 offen offset:0  lds
  buffer_load_dwordx4 v7, s[8:11], s30 offen offset:1024  lds
  buffer_load_dwordx4 v8, s[8:11], s30 offen offset:2048  lds
  buffer_load_dwordx4 v9, s[8:11], s30 offen offset:3072  lds
  s_add_u32 s30, s30, 128
  s_add_u32 m0, s42, 0
  s_nop 0
  buffer_load_dwordx4 v10, s[12:15], s31 offen offset:0 lds
  buffer_load_dwordx4 v11, s[12:15], s31 offen offset:1024 lds
  buffer_load_dwordx4 v12, s[12:15], s31 offen offset:2048 lds
  buffer_load_dwordx4 v13, s[12:15], s31 offen offset:3072 lds
  s_add_u32 s31, s31, 131072
  s_waitcnt vmcnt(16)
  s_barrier
  s_add_u32 m0, s41, 32768
  s_nop 0
  buffer_load_dwordx4 v6, s[8:11], s30 offen offset:0  lds
  buffer_load_dwordx4 v7, s[8:11], s30 offen offset:1024  lds
  buffer_load_dwordx4 v8, s[8:11], s30 offen offset:2048  lds
  buffer_load_dwordx4 v9, s[8:11], s30 offen offset:3072  lds
  s_add_u32 s30, s30, 128
  s_add_u32 m0, s42, 32768
  s_nop 0
  buffer_load_dwordx4 v10, s[12:15], s31 offen offset:0 lds
  buffer_load_dwordx4 v11, s[12:15], s31 offen offset:1024 lds
  buffer_load_dwordx4 v12, s[12:15], s31 offen offset:2048 lds
  buffer_load_dwordx4 v13, s[12:15], s31 offen offset:3072 lds
  s_add_u32 s31, s31, 131072
  s_waitcnt vmcnt(16)
  s_barrier
  s_add_u32 m0, s41, 65536
  s_nop 0
  buffer_load_dwordx4 v6, s[8:11], s30 offen offset:0  lds
  buffer_load_dwordx4 v7, s[8:11], s30 offen offset:1024  lds
  buffer_load_dwordx4 v8, s[8:11], s30 offen offset:2048  lds
  buffer_load_dwordx4 v9, s[8:11], s30 offen offset:3072  lds
  s_add_u32 s30, s30, 128
  s_add_u32 m0, s42, 65536
  s_nop 0
  buffer_load_dwordx4 v10, s[12:15], s31 offen offset:0 lds
  buffer_load_dwordx4 v11, s[12:15], s31 offen offset:1024 lds
  buffer_load_dwordx4 v12, s[12:15], s31 offen offset:2048 lds
  buffer_load_dwordx4 v13, s[12:15], s31 offen offset:3072 lds
  s_add_u32 s31, s31, 131072
  s_waitcnt vmcnt(16)
  s_barrier
  s_add_u32 m0, s41, 98304
  s_nop 0
  buffer_load_dwordx4 v6, s[8:11], s30 offen offset:0  lds
  buffer_load_dwordx4 v7, s[8:11], s30 offen offset:1024  lds
  buffer_load_dwordx4 v8, s[8:11], s30 offen offset:2048  lds
  buffer_load_dwordx4 v9, s[8:11], s30 offen offset:3072  lds
  s_add_u32 s30, s30, 128
  s_add_u32 m0, s42, 98304
  s_nop 0
  buffer_load_dwordx4 v10, s[12:15], s31 offen offset:0 lds
  buffer_load_dwordx4 v11, s[12:15], s31 offen offset:1024 lds
  buffer_load_dwordx4 v12, s[12:15], s31 offen offset:2048 lds
  buffer_load_dwordx4 v13, s[12:15], s31 offen offset:3072 lds
  s_add_u32 s31, s31, 131072
  s_waitcnt vmcnt(16)
  s_barrier
  s_add_u32 m0, s41, 0
  s_nop 0
  buffer_load_dwordx4 v6, s[8:11], s30 offen offset:0  lds
  buffer_load_dwordx4 v7, s[8:11], s30 offen offset:1024  lds
  buffer_load_dwordx4 v8, s[8:11], s30 offen offset:2048  lds
  buffer_load_dwordx4 v9, s[8:11], s30 offen offset:3072  lds
  s_add_u32 s30, s30, 128
  s_add_u32 m0, s42, 0
  s_nop 0
  buffer_load_dwordx4 v10, s[12:15], s31 offen offset:0 lds
  buffer_load_dwordx4 v11, s[12:15], s31 offen offset:1024 lds
  buffer_load_dwordx4 v12, s[12:15], s31 offen offset:2048 lds
  buffer_load_dwordx4 v13, s[12:15], s31 offen offset:3072 lds
  s_add_u32 s31, s31, 131072
  s_waitcnt vmcnt(16)
  s_barrier
  s_add_u32 m0, s41, 32768
  s_nop 0
  buffer_load_dwordx4 v6, s[8:11], s30 offen offset:0  lds
  buffer_load_dwordx4 v7, s[8:11], s30 offen offset:1024  lds
  buffer_load_dwordx4 v8, s[8:11], s30 offen offset:2048  lds
  buffer_load_dwordx4 v9, s[8:11], s30 offen offset:3072  lds
  s_add_u32 s30, s30, 128
  s_add_u32 m0, s42, 32768
  s_nop 0
  buffer_load_dwordx4 v10, s[12:15], s31 offen offset:0 lds
  buffer_load_dwordx4 v11, s[12:15], s31 offen offset:1024 lds
  buffer_load_dwordx4 v12, s[12:15], s31 offen offset:2048 lds
  buffer_load_dwordx4 v13, s[12:15], s31 offen offset:3072 lds
  s_add_u32 s31, s31, 131072
  s_waitcnt vmcnt(16)
  s_barrier
  s_add_u32 m0, s41, 65536
  s_nop 0
  buffer_load_dwordx4 v6, s[8:11], s30 offen offset:0  lds
  buffer_load_dwordx4 v7, s[8:11], s30 offen offset:1024  lds
  buffer_load_dwordx4 v8, s[8:11], s30 offen offset:2048  lds
  buffer_load_dwordx4 v9, s[8:11], s30 offen offset:3072  lds
  s_add_u32 s30, s30, 128
  s_add_u32 m0, s42, 65536
  s_nop 0
  buffer_load_dwordx4 v10, s[12:15], s31 offen offset:0 lds
  buffer_load_dwordx4 v11, s[12:15], s31 offen offset:1024 lds
  buffer_load_dwordx4 v12, s[12:15], s31 offen offset:2048 lds
  buffer_load_dwordx4 v13, s[12:15], s31 offen offset:3072 lds
  s_add_u32 s31, s31, 131072
  s_waitcnt vmcnt(16)
  s_barrier
  s_add_u32 m0, s41, 98304
  s_nop 0
  buffer_load_dwordx4 v6, s[8:11], s30 offen offset:0  lds
  buffer_load_dwordx4 v7, s[8:11], s30 offen offset:1024  lds
  buffer_load_dwordx4 v8, s[8:11], s30 offen offset:2048  lds
  buffer_load_dwordx4 v9, s[8:11], s30 offen offset:3072  lds
  s_add_u32 s30, s30, 128
  s_add_u32 m0, s42, 98304
  s_nop 0
  buffer_load_dwordx4 v10, s[12:15], s31 offen offset:0 lds
  buffer_load_dwordx4 v11, s[12:15], s31 offen offset:1024 lds
  buffer_load_dwordx4 v12, s[12:15], s31 offen offset:2048 lds
  buffer_load_dwordx4 v13, s[12:15], s31 offen offset:3072 lds
  s_add_u32 s31, s31, 131072
  s_waitcnt vmcnt(16)
  s_barrier
  s_add_u32 m0, s41, 0
  s_nop 0
  buffer_load_dwordx4 v6, s[8:11], s30 offen offset:0  lds
  buffer_load_dwordx4 v7, s[8:11], s30 offen offset:1024  lds
  buffer_load_dwordx4 v8, s[8:11], s30 offen offset:2048  lds
  buffer_load_dwordx4 v9, s[8:11], s30 offen offset:3072  lds
  s_add_u32 s30, s30, 128
  s_add_u32 m0, s42, 0
  s_nop 0
  buffer_load_dwordx4 v10, s[12:15], s31 offen offset:0 lds
  buffer_load_dwordx4 v11, s[12:15], s31 offen offset:1024 lds
  buffer_load_dwordx4 v12, s[12:15], s31 offen offset:2048 lds
  buffer_load_dwordx4 v13, s[12:15], s31 offen offset:3072 lds
  s_add_u32 s31, s31, 131072
  s_waitcnt vmcnt(16)
  s_barrier
  s_add_u32 m0, s41, 32768
  s_nop 0
  buffer_load_dwordx4 v6, s[8:11], s30 offen offset:0  lds
  buffer_load_dwordx4 v7, s[8:11], s30 offen offset:1024  lds
  buffer_load_dwordx4 v8, s[8:11], s30 offen offset:2048  lds
  buffer_load_dwordx4 v9, s[8:11], s30 offen offset:3072  lds
  s_add_u32 s30, s30, 128
  s_add_u32 m0, s42, 32768
  s_nop 0
  buffer_load_dwordx4 v10, s[12:15], s31 offen offset:0 lds
  buffer_load_dwordx4 v11, s[12:15], s31 offen offset:1024 lds
  buffer_load_dwordx4 v12, s[12:15], s31 offen offset:2048 lds
  buffer_load_dwordx4 v13, s[12:15], s31 offen offset:3072 lds
  s_add_u32 s31, s31, 131072
  s_waitcnt vmcnt(16)
  s_barrier
  s_add_u32 m0, s41, 65536
  s_nop 0
  buffer_load_dwordx4 v6, s[8:11], s30 offen offset:0  lds
  buffer_load_dwordx4 v7, s[8:11], s30 offen offset:1024  lds
  buffer_load_dwordx4 v8, s[8:11], s30 offen offset:2048  lds
  buffer_load_dwordx4 v9, s[8:11], s30 offen offset:3072  lds
  s_add_u32 s30, s30, 128
  s_add_u32 m0, s42, 65536
  s_nop 0
  buffer_load_dwordx4 v10, s[12:15], s31 offen offset:0 lds
  buffer_load_dwordx4 v11, s[12:15], s31 offen offset:1024 lds
  buffer_load_dwordx4 v12, s[12:15], s31 offen offset:2048 lds
  buffer_load_dwordx4 v13, s[12:15], s31 offen offset:3072 lds
  s_add_u32 s31, s31, 131072
  s_waitcnt vmcnt(16)
  s_barrier
  buffer_load_dword v25, v24, s[76:79], 0 offen sc1
  s_add_u32 m0, s41, 98304
  s_nop 0
  buffer_load_dwordx4 v6, s[8:11], s30 offen offset:0  lds
  buffer_load_dwordx4 v7, s[8:11], s30 offen offset:1024  lds
  buffer_load_dwordx4 v8, s[8:11], s30 offen offset:2048  lds
  buffer_load_dwordx4 v9, s[8:11], s30 offen offset:3072  lds
  s_add_u32 s30, s30, 128
  s_add_u32 m0, s42, 98304
  s_nop 0
  buffer_load_dwordx4 v10, s[12:15], s31 offen offset:0 lds
  buffer_load_dwordx4 v11, s[12:15], s31 offen offset:1024 lds
  buffer_load_dwordx4 v12, s[12:15], s31 offen offset:2048 lds
  buffer_load_dwordx4 v13, s[12:15], s31 offen offset:3072 lds
  s_add_u32 s31, s31, 131072
  s_waitcnt vmcnt(17)
  s_barrier
  s_waitcnt vmcnt(8)
k1_poll:
  v_cmp_gt_u32 vcc, 16, v25
  s_nop 4
  s_cbranch_vccz k1_ready
  s_sleep 8
  buffer_load_dword v25, v24, s[76:79], 0 offen sc1
  s_waitcnt vmcnt(0)
  s_add_u32 s101, s101, 1
  s_cmp_lt_u32 s101, 0x40000
  s_cbranch_scc1 k1_poll
k1_ready:
  buffer_load_dwordx2 v[32:33], v20, s[20:23], 0 offen sc1
  buffer_load_dword v34, v22, s[4:7], s50 offen sc1
  s_add_u32 s50, s50, 4096
  buffer_load_dword v35, v22, s[4:7], s50 offen sc1
  s_add_u32 s50, s50, 4096
  buffer_load_dword v36, v22, s[4:7], s50 offen sc1
  s_add_u32 s50, s50, 4096
  buffer_load_dword v37, v22, s[4:7], s50 offen sc1
  s_add_u32 s86, s84, 0
  s_mul_i32 s86, s86, 131072
  s_add_u32 s31, s81, s86
  s_add_u32 m0, s42, 0
  s_nop 0
  buffer_load_dwordx4 v10, s[16:19], s31 offen offset:0 lds
  buffer_load_dwordx4 v11, s[16:19], s31 offen offset:1024 lds
  buffer_load_dwordx4 v12, s[16:19], s31 offen offset:2048 lds
  buffer_load_dwordx4 v13, s[16:19], s31 offen offset:3072 lds
  s_barrier
  s_add_u32 s86, s84, 1
  s_mul_i32 s86, s86, 131072
  s_add_u32 s31, s81, s86
  s_add_u32 m0, s42, 32768
  s_nop 0
  buffer_load_dwordx4 v10, s[16:19], s31 offen offset:0 lds
  buffer_load_dwordx4 v11, s[16:19], s31 offen offset:1024 lds
  buffer_load_dwordx4 v12, s[16:19], s31 offen offset:2048 lds
  buffer_load_dwordx4 v13, s[16:19], s31 offen offset:3072 lds
  s_waitcnt vmcnt(13)
  s_barrier
  s_cmp_gt_u32 s84, 0
  s_cselect_b32 s86, 0, 2
  s_mul_i32 s86, s86, 131072
  s_add_u32 s31, s81, s86
  s_add_u32 m0, s42, 65536
  s_nop 0
  buffer_load_dwordx4 v10, s[16:19], s31 offen offset:0 lds
  buffer_load_dwordx4 v11, s[16:19], s31 offen offset:1024 lds
  buffer_load_dwordx4 v12, s[16:19], s31 offen offset:2048 lds
  buffer_load_dwordx4 v13, s[16:19], s31 offen offset:3072 lds
  s_waitcnt vmcnt(12)
  ds_write_b64 v21, v[32:33]
  v_add_f32 v34, v34, v35
  v_add_f32 v34, v34, v36
  v_add_f32 v34, v34, v37
  v_mov_b32 v35, v34
  s_nop 1
  v_permlane32_swap_b32 v34, v35
  v_add_f32 v34, v34, v35
  ds_write_b32 v23, v34
  s_waitcnt lgkmcnt(0)
  s_barrier
  s_load_dwordx2 s[12:13], s[0:1], 64
  s_mov_b32 s14, 2097152
  s_mov_b32 s15, 0x20000
  s_mul_i32 s30, s34, 262144
  s_lshl_b32 s31, s35, 8
  s_lshl_b32 s87, s34, 3
  s_add_u32 s87, s87, s35
  s_lshl_b32 s87, s87, 7
  s_add_u32 s87, s87, 39911424
  s_sub_u32 s40, s33, 4
  s_lshl_b32 s41, s40, 12
  s_mul_i32 s36, s40, 4096
  v_lshl_add_u32 v6, v1, 4, s36
  v_add_u32 v7, 0, v6
  v_lshrrev_b32 v2, 4, v1
  v_and_b32 v3, 15, v1
  v_lshlrev_b32 v4, 1, v2
  v_xor_b32 v3, v3, v4
  v_lshlrev_b32 v3, 4, v3
  v_lshl_add_u32 v3, v2, 11, v3
  s_lshl_b32 s36, s40, 15
  v_add_u32 v10, s36, v3
  v_add_u32 v11, 7168, v10
  v_xor_b32 v3, 128, v10
  v_add_u32 v12, 14336, v3
  v_add_u32 v13, 21504, v3
  s_mul_i32 s42, s40, 4096
  s_add_u32 s42, s42, 16384
  v_lshrrev_b32 v2, 4, v1
  v_and_b32 v3, 15, v1
  v_xor_b32 v3, v3, v2
  v_lshlrev_b32 v3, 4, v3
  v_lshl_add_u32 v20, v2, 11, v3
  v_xor_b32 v21, 64, v20
  v_xor_b32 v22, 128, v20
  v_xor_b32 v23, 192, v20
  s_lshl_b32 s50, s34, 18
  s_lshl_b32 s51, s40, 16
  s_add_u32 s50, s50, s51
  s_lshl_b32 s51, s35, 8
  s_add_u32 s50, s50, s51
  s_lshl_b32 s51, s40, 13
  s_add_u32 s51, s51, 131072
  s_lshl_b32 s84, s35, 1
  s_add_u32 s85, s84, 1
  v_and_b32 v24, 7, v1
  v_lshlrev_b32 v24, 7, v24
  v_mov_b32 v26, 1
  s_lshl_b32 s53, s34, 10
  s_add_u32 s55, s53, 39976960
  s_add_u32 s53, s53, 39927808
  s_lshl_b32 s54, s35, 7
  s_add_u32 s54, s54, s53
  s_lshl_b32 s56, s35, 7
  s_add_u32 s56, s56, s55
  s_waitcnt lgkmcnt(0)
  s_mov_b32 s80, s30
  s_mov_b32 s81, s31
  s_cmp_gt_u32 s84, 2
  s_cselect_b32 s86, 2, 4
  s_mul_i32 s86, s86, 131072
  s_add_u32 s31, s81, s86
  s_add_u32 m0, s42, 98304
  s_nop 0
  buffer_load_dwordx4 v10, s[12:15], s31 offen offset:0 lds
  buffer_load_dwordx4 v11, s[12:15], s31 offen offset:1024 lds
  buffer_load_dwordx4 v12, s[12:15], s31 offen offset:2048 lds
  buffer_load_dwordx4 v13, s[12:15], s31 offen offset:3072 lds
  s_barrier
  s_cmp_eq_u32 s40, 0
  s_cselect_b32 s86, s56, -1
  s_mov_b64 exec, 1
  buffer_store_dword v26, v24, s[4:7], s86 offen sc1
  s_mov_b64 exec, -1
  s_waitcnt vmcnt(1)
  s_barrier
  buffer_load_dword v25, v24, s[4:7], s55 offen sc1
  s_barrier
  s_waitcnt vmcnt(0)
k2a_gate:
  v_cmp_ne_u32 vcc, 1, v25
  s_nop 4
  s_cbranch_vccz k2a_gok
  s_sleep 4
  buffer_load_dword v25, v24, s[4:7], s55 offen sc1
  s_waitcnt vmcnt(0)
  s_add_u32 s101, s101, 1
  s_cmp_lt_u32 s101, 0x40000
  s_cbranch_scc1 k2a_gate
k2a_gok:
  s_cmp_gt_u32 s84, 0
  s_cselect_b32 s86, 0, 2
  s_mul_i32 s86, s86, 16384
  s_add_u32 s30, s80, s86
  s_add_u32 m0, s41, 65536
  s_nop 0
  buffer_load_dwordx4 v6, s[4:7], s30 offen offset:0 sc1 lds
  buffer_load_dwordx4 v6, s[4:7], s30 offen offset:1024 sc1 lds
  buffer_load_dwordx4 v7, s[4:7], s30 offen offset:2048 sc1 lds
  buffer_load_dwordx4 v7, s[4:7], s30 offen offset:3072 sc1 lds
  s_cmp_gt_u32 s84, 2
  s_cselect_b32 s86, 2, 4
  s_mul_i32 s86, s86, 16384
  s_add_u32 s30, s80, s86
  s_add_u32 m0, s41, 98304
  s_nop 0
  buffer_load_dwordx4 v6, s[4:7], s30 offen offset:0 sc1 lds
  buffer_load_dwordx4 v6, s[4:7], s30 offen offset:1024 sc1 lds
  buffer_load_dwordx4 v7, s[4:7], s30 offen offset:2048 sc1 lds
  buffer_load_dwordx4 v7, s[4:7], s30 offen offset:3072 sc1 lds
  s_cmp_gt_u32 s84, 4
  s_cselect_b32 s86, 4, 6
  s_mul_i32 s86, s86, 16384
  s_add_u32 s30, s80, s86
  s_add_u32 m0, s41, 0
  s_nop 0
  buffer_load_dwordx4 v6, s[4:7], s30 offen offset:0 sc1 lds
  buffer_load_dwordx4 v6, s[4:7], s30 offen offset:1024 sc1 lds
  buffer_load_dwordx4 v7, s[4:7], s30 offen offset:2048 sc1 lds
  buffer_load_dwordx4 v7, s[4:7], s30 offen offset:3072 sc1 lds
  s_cmp_gt_u32 s84, 4
  s_cselect_b32 s86, 4, 6
  s_mul_i32 s86, s86, 131072
  s_add_u32 s31, s81, s86
  s_add_u32 m0, s42, 0
  s_nop 0
  buffer_load_dwordx4 v10, s[12:15], s31 offen offset:0 lds
  buffer_load_dwordx4 v11, s[12:15], s31 offen offset:1024 lds
  buffer_load_dwordx4 v12, s[12:15], s31 offen offset:2048 lds
  buffer_load_dwordx4 v13, s[12:15], s31 offen offset:3072 lds
  s_waitcnt vmcnt(12)
  s_barrier
  s_cmp_eq_u32 s40, 0
  s_cselect_b32 s86, s54, -1
  s_mov_b64 exec, 1
  buffer_store_dword v26, v24, s[4:7], s86 offen sc1
  s_mov_b64 exec, -1
  s_cmp_gt_u32 s84, 6
  s_cselect_b32 s86, 6, 8
  s_mul_i32 s86, s86, 16384
  s_add_u32 s30, s80, s86
  s_add_u32 m0, s41, 32768
  s_nop 0
  buffer_load_dwordx4 v6, s[4:7], s30 offen offset:0 sc1 lds
  buffer_load_dwordx4 v6, s[4:7], s30 offen offset:1024 sc1 lds
  buffer_load_dwordx4 v7, s[4:7], s30 offen offset:2048 sc1 lds
  buffer_load_dwordx4 v7, s[4:7], s30 offen offset:3072 sc1 lds
  s_cmp_gt_u32 s84, 6
  s_cselect_b32 s86, 6, 8
  s_mul_i32 s86, s86, 131072
  s_add_u32 s31, s81, s86
  s_add_u32 m0, s42, 32768
  s_nop 0
  buffer_load_dwordx4 v10, s[12:15], s31 offen offset:0 lds
  buffer_load_dwordx4 v11, s[12:15], s31 offen offset:1024 lds
  buffer_load_dwordx4 v12, s[12:15], s31 offen offset:2048 lds
  buffer_load_dwordx4 v13, s[12:15], s31 offen offset:3072 lds
  s_add_u32 m0, s51, 0
  s_nop 0
  buffer_load_dwordx4 v20, s[8:11], s50 offen lds
  s_add_u32 s50, s50, 8192
  s_add_u32 m0, s51, 1024
  s_nop 0
  buffer_load_dwordx4 v21, s[8:11], s50 offen lds
  s_add_u32 s50, s50, 8192
  s_waitcnt vmcnt(19)
  s_barrier
  s_cmp_gt_u32 s84, 8
  s_cselect_b32 s86, 8, 10
  s_mul_i32 s86, s86, 16384
  s_add_u32 s30, s80, s86
  s_add_u32 m0, s41, 65536
  s_nop 0
  buffer_load_dwordx4 v6, s[4:7], s30 offen offset:0 sc1 lds
  buffer_load_dwordx4 v6, s[4:7], s30 offen offset:1024 sc1 lds
  buffer_load_dwordx4 v7, s[4:7], s30 offen offset:2048 sc1 lds
  buffer_load_dwordx4 v7, s[4:7], s30 offen offset:3072 sc1 lds
  s_cmp_gt_u32 s84, 8
  s_cselect_b32 s86, 8, 10
  s_mul_i32 s86, s86, 131072
  s_add_u32 s31, s81, s86
  s_add_u32 m0, s42, 65536
  s_nop 0
  buffer_load_dwordx4 v10, s[12:15], s31 offen offset:0 lds
  buffer_load_dwordx4 v11, s[12:15], s31 offen offset:1024 lds
  buffer_load_dwordx4 v12, s[12:15], s31 offen offset:2048 lds
  buffer_load_dwordx4 v13, s[12:15], s31 offen offset:3072 lds
  s_add_u32 m0, s51, 2048
  s_nop 0
  buffer_load_dwordx4 v22, s[8:11], s50 offen lds
  s_add_u32 s50, s50, 8192
  s_add_u32 m0, s51, 3072
  s_nop 0
  buffer_load_dwordx4 v23, s[8:11], s50 offen lds
  s_add_u32 s50, s50, 8192
  s_waitcnt vmcnt(21)
  s_barrier
  s_cmp_gt_u32 s84, 10
  s_cselect_b32 s86, 10, 12
  s_mul_i32 s86, s86, 16384
  s_add_u32 s30, s80, s86
  s_add_u32 m0, s41, 98304
  s_nop 0
  buffer_load_dwordx4 v6, s[4:7], s30 offen offset:0 sc1 lds
  buffer_load_dwordx4 v6, s[4:7], s30 offen offset:1024 sc1 lds
  buffer_load_dwordx4 v7, s[4:7], s30 offen offset:2048 sc1 lds
  buffer_load_dwordx4 v7, s[4:7], s30 offen offset:3072 sc1 lds
  s_cmp_gt_u32 s84, 10
  s_cselect_b32 s86, 10, 12
  s_mul_i32 s86, s86, 131072
  s_add_u32 s31, s81, s86
  s_add_u32 m0, s42, 98304
  s_nop 0
  buffer_load_dwordx4 v10, s[12:15], s31 offen offset:0 lds
  buffer_load_dwordx4 v11, s[12:15], s31 offen offset:1024 lds
  buffer_load_dwordx4 v12, s[12:15], s31 offen offset:2048 lds
  buffer_load_dwordx4 v13, s[12:15], s31 offen offset:3072 lds
  s_add_u32 m0, s51, 4096
  s_nop 0
  buffer_load_dwordx4 v20, s[8:11], s50 offen lds
  s_add_u32 s50, s50, 8192
  s_add_u32 m0, s51, 5120
  s_nop 0
  buffer_load_dwordx4 v21, s[8:11], s50 offen lds
  s_add_u32 s50, s50, 8192
  s_waitcnt vmcnt(22)
  s_barrier
  buffer_load_dword v25, v24, s[4:7], s53 offen sc1
  s_cmp_gt_u32 s84, 12
  s_cselect_b32 s86, 12, 14
  s_mul_i32 s86, s86, 16384
  s_add_u32 s30, s80, s86
  s_add_u32 m0, s41, 0
  s_nop 0
  buffer_load_dwordx4 v6, s[4:7], s30 offen offset:0 sc1 lds
  buffer_load_dwordx4 v6, s[4:7], s30 offen offset:1024 sc1 lds
  buffer_load_dwordx4 v7, s[4:7], s30 offen offset:2048 sc1 lds
  buffer_load_dwordx4 v7, s[4:7], s30 offen offset:3072 sc1 lds
  s_cmp_gt_u32 s84, 12
  s_cselect_b32 s86, 12, 14
  s_mul_i32 s86, s86, 131072
  s_add_u32 s31, s81, s86
  s_add_u32 m0, s42, 0
  s_nop 0
  buffer_load_dwordx4 v10, s[12:15], s31 offen offset:0 lds
  buffer_load_dwordx4 v11, s[12:15], s31 offen offset:1024 lds
  buffer_load_dwordx4 v12, s[12:15], s31 offen offset:2048 lds
  buffer_load_dwordx4 v13, s[12:15], s31 offen offset:3072 lds
  s_add_u32 m0, s51, 6144
  s_nop 0
  buffer_load_dwordx4 v22, s[8:11], s50 offen lds
  s_add_u32 s50, s50, 8192
  s_add_u32 m0, s51, 7168
  s_nop 0
  buffer_load_dwordx4 v23, s[8:11], s50 offen lds
  s_add_u32 s50, s50, 8192
  s_waitcnt vmcnt(23)
  s_barrier
  s_waitcnt vmcnt(10)
k2_gate:
  v_cmp_ne_u32 vcc, 1, v25
  s_nop 4
  s_cbranch_vccz k2_gok
  s_sleep 4
  buffer_load_dword v25, v24, s[4:7], s53 offen sc1
  s_waitcnt vmcnt(0)
  s_add_u32 s101, s101, 1
  s_cmp_lt_u32 s101, 0x40000
  s_cbranch_scc1 k2_gate
k2_gok:
  s_cmp_gt_u32 s85, 1
  s_cselect_b32 s86, 1, 3
  s_mul_i32 s86, s86, 16384
  s_add_u32 s30, s80, s86
  s_add_u32 m0, s41, 32768
  s_nop 0
  buffer_load_dwordx4 v6, s[4:7], s30 offen offset:0 sc1 lds
  buffer_load_dwordx4 v6, s[4:7], s30 offen offset:1024 sc1 lds
  buffer_load_dwordx4 v7, s[4:7], s30 offen offset:2048 sc1 lds
  buffer_load_dwordx4 v7, s[4:7], s30 offen offset:3072 sc1 lds
  s_cmp_gt_u32 s85, 1
  s_cselect_b32 s86, 1, 3
  s_mul_i32 s86, s86, 131072
  s_add_u32 s31, s81, s86
  s_add_u32 m0, s42, 32768
  s_nop 0
  buffer_load_dwordx4 v10, s[12:15], s31 offen offset:0 lds
  buffer_load_dwordx4 v11, s[12:15], s31 offen offset:1024 lds
  buffer_load_dwordx4 v12, s[12:15], s31 offen offset:2048 lds
  buffer_load_dwordx4 v13, s[12:15], s31 offen offset:3072 lds
  s_barrier
  s_cmp_gt_u32 s85, 3
  s_cselect_b32 s86, 3, 5
  s_mul_i32 s86, s86, 16384
  s_add_u32 s30, s80, s86
  s_add_u32 m0, s41, 65536
  s_nop 0
  buffer_load_dwordx4 v6, s[4:7], s30 offen offset:0 sc1 lds
  buffer_load_dwordx4 v6, s[4:7], s30 offen offset:1024 sc1 lds
  buffer_load_dwordx4 v7, s[4:7], s30 offen offset:2048 sc1 lds
  buffer_load_dwordx4 v7, s[4:7], s30 offen offset:3072 sc1 lds
  s_cmp_gt_u32 s85, 3
  s_cselect_b32 s86, 3, 5
  s_mul_i32 s86, s86, 131072
  s_add_u32 s31, s81, s86
  s_add_u32 m0, s42, 65536
  s_nop 0
  buffer_load_dwordx4 v10, s[12:15], s31 offen offset:0 lds
  buffer_load_dwordx4 v11, s[12:15], s31 offen offset:1024 lds
  buffer_load_dwordx4 v12, s[12:15], s31 offen offset:2048 lds
  buffer_load_dwordx4 v13, s[12:15], s31 offen offset:3072 lds
  s_waitcnt vmcnt(16)
  s_barrier
  s_cmp_gt_u32 s85, 5
  s_cselect_b32 s86, 5, 7
  s_mul_i32 s86, s86, 16384
  s_add_u32 s30, s80, s86
  s_add_u32 m0, s41, 98304
  s_nop 0
  buffer_load_dwordx4 v6, s[4:7], s30 offen offset:0 sc1 lds
  buffer_load_dwordx4 v6, s[4:7], s30 offen offset:1024 sc1 lds
  buffer_load_dwordx4 v7, s[4:7], s30 offen offset:2048 sc1 lds
  buffer_load_dwordx4 v7, s[4:7], s30 offen offset:3072 sc1 lds
  s_cmp_gt_u32 s85, 5
  s_cselect_b32 s86, 5, 7
  s_mul_i32 s86, s86, 131072
  s_add_u32 s31, s81, s86
  s_add_u32 m0, s42, 98304
  s_nop 0
  buffer_load_dwordx4 v10, s[12:15], s31 offen offset:0 lds
  buffer_load_dwordx4 v11, s[12:15], s31 offen offset:1024 lds
  buffer_load_dwordx4 v12, s[12:15], s31 offen offset:2048 lds
  buffer_load_dwordx4 v13, s[12:15], s31 offen offset:3072 lds
  s_waitcnt vmcnt(16)
  s_barrier
  s_cmp_gt_u32 s85, 7
  s_cselect_b32 s86, 7, 9
  s_mul_i32 s86, s86, 16384
  s_add_u32 s30, s80, s86
  s_add_u32 m0, s41, 0
  s_nop 0
  buffer_load_dwordx4 v6, s[4:7], s30 offen offset:0 sc1 lds
  buffer_load_dwordx4 v6, s[4:7], s30 offen offset:1024 sc1 lds
  buffer_load_dwordx4 v7, s[4:7], s30 offen offset:2048 sc1 lds
  buffer_load_dwordx4 v7, s[4:7], s30 offen offset:3072 sc1 lds
  s_cmp_gt_u32 s85, 7
  s_cselect_b32 s86, 7, 9
  s_mul_i32 s86, s86, 131072
  s_add_u32 s31, s81, s86
  s_add_u32 m0, s42, 0
  s_nop 0
  buffer_load_dwordx4 v10, s[12:15], s31 offen offset:0 lds
  buffer_load_dwordx4 v11, s[12:15], s31 offen offset:1024 lds
  buffer_load_dwordx4 v12, s[12:15], s31 offen offset:2048 lds
  buffer_load_dwordx4 v13, s[12:15], s31 offen offset:3072 lds
  s_waitcnt vmcnt(16)
  s_barrier
  s_cmp_gt_u32 s85, 9
  s_cselect_b32 s86, 9, 11
  s_mul_i32 s86, s86, 16384
  s_add_u32 s30, s80, s86
  s_add_u32 m0, s41, 32768
  s_nop 0
  buffer_load_dwordx4 v6, s[4:7], s30 offen offset:0 sc1 lds
  buffer_load_dwordx4 v6, s[4:7], s30 offen offset:1024 sc1 lds
  buffer_load_dwordx4 v7, s[4:7], s30 offen offset:2048 sc1 lds
  buffer_load_dwordx4 v7, s[4:7], s30 offen offset:3072 sc1 lds
  s_cmp_gt_u32 s85, 9
  s_cselect_b32 s86, 9, 11
  s_mul_i32 s86, s86, 131072
  s_add_u32 s31, s81, s86
  s_add_u32 m0, s42, 32768
  s_nop 0
  buffer_load_dwordx4 v10, s[12:15], s31 offen offset:0 lds
  buffer_load_dwordx4 v11, s[12:15], s31 offen offset:1024 lds
  buffer_load_dwordx4 v12, s[12:15], s31 offen offset:2048 lds
  buffer_load_dwordx4 v13, s[12:15], s31 offen offset:3072 lds
  s_waitcnt vmcnt(16)
  s_barrier
  s_cmp_gt_u32 s85, 11
  s_cselect_b32 s86, 11, 13
  s_mul_i32 s86, s86, 16384
  s_add_u32 s30, s80, s86
  s_add_u32 m0, s41, 65536
  s_nop 0
  buffer_load_dwordx4 v6, s[4:7], s30 offen offset:0 sc1 lds
  buffer_load_dwordx4 v6, s[4:7], s30 offen offset:1024 sc1 lds
  buffer_load_dwordx4 v7, s[4:7], s30 offen offset:2048 sc1 lds
  buffer_load_dwordx4 v7, s[4:7], s30 offen offset:3072 sc1 lds
  s_cmp_gt_u32 s85, 11
  s_cselect_b32 s86, 11, 13
  s_mul_i32 s86, s86, 131072
  s_add_u32 s31, s81, s86
  s_add_u32 m0, s42, 65536
  s_nop 0
  buffer_load_dwordx4 v10, s[12:15], s31 offen offset:0 lds
  buffer_load_dwordx4 v11, s[12:15], s31 offen offset:1024 lds
  buffer_load_dwordx4 v12, s[12:15], s31 offen offset:2048 lds
  buffer_load_dwordx4 v13, s[12:15], s31 offen offset:3072 lds
  s_waitcnt vmcnt(16)
  s_barrier
  s_cmp_gt_u32 s85, 13
  s_cselect_b32 s86, 13, 15
  s_mul_i32 s86, s86, 16384
  s_add_u32 s30, s80, s86
  s_add_u32 m0, s41, 98304
  s_nop 0
  buffer_load_dwordx4 v6, s[4:7], s30 offen offset:0 sc1 lds
  buffer_load_dwordx4 v6, s[4:7], s30 offen offset:1024 sc1 lds
  buffer_load_dwordx4 v7, s[4:7], s30 offen offset:2048 sc1 lds
  buffer_load_dwordx4 v7, s[4:7], s30 offen offset:3072 sc1 lds
  s_cmp_gt_u32 s85, 13
  s_cselect_b32 s86, 13, 15
  s_mul_i32 s86, s86, 131072
  s_add_u32 s31, s81, s86
  s_add_u32 m0, s42, 98304
  s_nop 0
  buffer_load_dwordx4 v10, s[12:15], s31 offen offset:0 lds
  buffer_load_dwordx4 v11, s[12:15], s31 offen offset:1024 lds
  buffer_load_dwordx4 v12, s[12:15], s31 offen offset:2048 lds
  buffer_load_dwordx4 v13, s[12:15], s31 offen offset:3072 lds
  s_waitcnt vmcnt(16)
  s_barrier
k3_lbody:
  s_lshr_b32 s29, s2, 3
  s_lshl_b32 s27, s28, 3
  s_and_b32 s27, s27, 16
  s_xor_b32 s29, s29, s27
  s_xor_b32 s29, s29, 16
  s_load_dwordx2 s[12:13], s[0:1], 72
  s_mov_b32 s14, 7340032
  s_mov_b32 s15, 0x20000
  s_load_dwordx2 s[16:17], s[0:1], 80
  s_mov_b32 s18, 7340032
  s_mov_b32 s19, 0x20000
  s_load_dwordx2 s[8:9], s[0:1], 0
  s_mov_b32 s10, 4194304
  s_mov_b32 s11, 0x20000
  s_lshr_b32 s36, s28, 2
  s_mul_i32 s36, s36, 8
  s_lshr_b32 s37, s29, 2
  s_add_u32 s34, s36, s37
  s_and_b32 s36, s28, 3
  s_mul_i32 s36, s36, 4
  s_and_b32 s37, s29, 3
  s_add_u32 s35, s36, s37
  s_mul_i32 s30, s34, 262144
  s_add_u32 s30, s30, 16777216
  s_mul_i32 s31, s35, 448
  s_sub_u32 s40, s33, 4
  s_lshl_b32 s41, s40, 12
  s_mul_i32 s36, s40, 4096
  v_lshl_add_u32 v6, v1, 4, s36
  v_add_u32 v7, 0, v6
  s_mul_i32 s36, s40, 448
  s_mov_b32 s37, 7168
  s_and_b32 s38, s35, 1
  s_lshl_b32 s38, s38, 2
  v_add_u32 v2, s36, v1
  v_mul_u32_u24 v3, 2341, v2
  v_lshrrev_b32 v3, 16, v3
  v_mul_u32_u24 v4, 28, v3
  v_sub_u32 v2, v2, v4
  v_bfe_u32 v4, v3, 3, 1
  v_lshlrev_b32 v4, 1, v4
  v_xor_b32 v2, v2, v4
  v_add_u32 v2, s38, v2
  v_subrev_u32 v4, 28, v2
  v_min_u32 v2, v2, v4
  v_mul_lo_u32 v3, v3, s37
  v_lshl_add_u32 v10, v2, 4, v3
  v_add_u32 v2, s36, v1
  v_add_u32 v2, 64, v2
  v_mul_u32_u24 v3, 2341, v2
  v_lshrrev_b32 v3, 16, v3
  v_mul_u32_u24 v4, 28, v3
  v_sub_u32 v2, v2, v4
  v_bfe_u32 v4, v3, 3, 1
  v_lshlrev_b32 v4, 1, v4
  v_xor_b32 v2, v2, v4
  v_add_u32 v2, s38, v2
  v_subrev_u32 v4, 28, v2
  v_min_u32 v2, v2, v4
  s_nop 0
  v_mul_lo_u32 v3, v3, s37
  v_lshl_add_u32 v11, v2, 4, v3
  v_subrev_u32 v11, 1024, v11
  v_add_u32 v2, s36, v1
  v_add_u32 v2, 128, v2
  v_mul_u32_u24 v3, 2341, v2
  v_lshrrev_b32 v3, 16, v3
  v_mul_u32_u24 v4, 28, v3
  v_sub_u32 v2, v2, v4
  v_bfe_u32 v4, v3, 3, 1
  v_lshlrev_b32 v4, 1, v4
  v_xor_b32 v2, v2, v4
  v_add_u32 v2, s38, v2
  v_subrev_u32 v4, 28, v2
  v_min_u32 v2, v2, v4
  s_nop 0
  v_mul_lo_u32 v3, v3, s37
  v_lshl_add_u32 v12, v2, 4, v3
  v_subrev_u32 v12, 2048, v12
  v_add_u32 v2, s36, v1
  v_add_u32 v2, 192, v2
  v_mul_u32_u24 v3, 2341, v2
  s_cmp_lt_u32 s2, 128
  s_cbranch_scc1 k3_eb0
  s_waitcnt vmcnt(8)
  s_barrier
k3_eb0:
  v_lshrrev_b32 v3, 16, v3
  v_mul_u32_u24 v4, 28, v3
  v_sub_u32 v2, v2, v4
  v_bfe_u32 v4, v3, 3, 1
  v_lshlrev_b32 v4, 1, v4
  v_xor_b32 v2, v2, v4
  v_add_u32 v2, s38, v2
  v_subrev_u32 v4, 28, v2
  v_min_u32 v2, v2, v4
  v_mul_lo_u32 v3, v3, s37
  v_lshl_add_u32 v13, v2, 4, v3
  v_subrev_u32 v13, 3072, v13
  v_add_u32 v2, s36, v1
  v_add_u32 v2, 256, v2
  v_mul_u32_u24 v3, 2341, v2
  v_lshrrev_b32 v3, 16, v3
  v_mul_u32_u24 v4, 28, v3
  v_sub_u32 v2, v2, v4
  v_bfe_u32 v4, v3, 3, 1
  v_lshlrev_b32 v4, 1, v4
  v_xor_b32 v2, v2, v4
  v_add_u32 v2, s38, v2
  v_subrev_u32 v4, 28, v2
  v_min_u32 v2, v2, v4
  v_mul_lo_u32 v3, v3, s37
  v_lshl_add_u32 v14, v2, 4, v3
  v_add_u32 v2, s36, v1
  v_add_u32 v2, 320, v2
  v_mul_u32_u24 v3, 2341, v2
  v_lshrrev_b32 v3, 16, v3
  v_mul_u32_u24 v4, 28, v3
  v_sub_u32 v2, v2, v4
  v_bfe_u32 v4, v3, 3, 1
  v_lshlrev_b32 v4, 1, v4
  v_xor_b32 v2, v2, v4
  v_add_u32 v2, s38, v2
  v_subrev_u32 v4, 28, v2
  v_min_u32 v2, v2, v4
  v_mul_lo_u32 v3, v3, s37
  v_lshl_add_u32 v15, v2, 4, v3
  v_subrev_u32 v15, 1024, v15
  v_add_u32 v2, s36, v1
  v_add_u32 v2, 384, v2
  v_mul_u32_u24 v3, 2341, v2
  v_lshrrev_b32 v3, 16, v3
  v_mul_u32_u24 v4, 28, v3
  v_sub_u32 v2, v2, v4
  v_bfe_u32 v4, v3, 3, 1
  v_lshlrev_b32 v4, 1, v4
  v_xor_b32 v2, v2, v4
  v_add_u32 v2, s38, v2
  v_subrev_u32 v4, 28, v2
  v_min_u32 v2, v2, v4
  s_nop 0
  v_mul_lo_u32 v3, v3, s37
  v_lshl_add_u32 v16, v2, 4, v3
  v_subrev_u32 v16, 2048, v16
  s_cmp_lt_u32 s2, 128
  s_cbranch_scc1 k3_eb1
  s_waitcnt vmcnt(0)
  s_barrier
k3_eb1:
  s_mul_i32 s42, s40, 7168
  s_add_u32 s42, s42, 16384
  v_and_b32 v28, 7, v1
  v_lshlrev_b32 v28, 7, v28
  v_mov_b32 v29, 1
  v_lshlrev_b32 v30, 3, v1
  s_lshl_b32 s53, s34, 10
  s_add_u32 s53, s53, 39911424
  s_mov_b32 s57, 39944192
  s_add_u32 s59, s87, 81920
  s_add_u32 s58, s53, 0
  s_add_u32 s53, s53, 81920
  s_add_u32 s30, s30, 16384
  s_add_u32 s31, s31, 458752
  s_waitcnt lgkmcnt(0)
  v_and_b32 v2, 31, v1
  v_lshrrev_b32 v3, 5, v1
  v_lshlrev_b32 v20, 3, v2
  v_lshl_add_u32 v21, v3, 17, v20
  s_lshl_b32 s50, s34, 10
  s_lshl_b32 s51, s40, 8
  s_add_u32 s50, s50, s51
  s_add_u32 s50, s50, 37748736
  v_add_u32 v20, s51, v20
  v_add_u32 v20, 135168, v20
  s_mul_i32 s51, s40, 56
  v_add_u32 v23, s51, v1
  s_and_b32 s52, s35, 1
  s_lshl_b32 s52, s52, 5
  v_add_u32 v22, s52, v23
  v_subrev_u32 v2, 224, v22
  v_min_u32 v22, v22, v2
  v_lshlrev_b32 v22, 2, v22
  v_lshlrev_b32 v23, 2, v23
  v_add_u32 v23, 136192, v23
  s_mul_i32 s52, s35, 896
  s_add_u32 s52, s52, 38797312
  v_lshrrev_b32 v24, 3, v1
  v_and_b32 v25, 7, v1
  v_lshlrev_b32 v25, 7, v25
  v_lshl_add_u32 v24, v24, 11, v25
  s_lshl_b32 s54, s29, 2
  s_add_u32 s54, s54, s40
  s_lshl_b32 s54, s54, 14
  s_and_b32 s55, s28, 1
  s_lshl_b32 s55, s55, 10
  s_and_b32 s56, s28, 2
  s_mul_i32 s56, s56, 1835008
  s_add_u32 s55, s55, s56
  s_add_u32 s54, s54, s55
  v_min_u32 v27, 13, v1
  v_lshlrev_b32 v27, 11, v27
  s_lshl_b32 s56, s29, 2
  s_add_u32 s56, s56, s40
  s_mul_i32 s56, s56, 28672
  s_add_u32 s56, s56, s55
  s_cmp_lt_u32 s2, 128
  s_cbranch_scc1 k3_eb2
  s_barrier
k3_eb2:
  s_cmp_lt_u32 s2, 128
  s_cbranch_scc1 k3_lconv
  s_barrier
  s_cmp_lg_u32 s40, 0
  s_cbranch_scc1 recurrent_scan__ssm_conv_h3__mixer_s_mlp__prompt_kernel_nf1003
  s_mov_b64 exec, 1
  buffer_store_dword v29, v28, s[4:7], s59 offen sc1
  s_mov_b64 exec, -1
recurrent_scan__ssm_conv_h3__mixer_s_mlp__prompt_kernel_nf1003:
  s_add_u32 m0, s42, 0
  s_nop 0
  buffer_load_dwordx4 v10, s[12:15], s31 offen offset:0 lds
  buffer_load_dwordx4 v11, s[12:15], s31 offen offset:1024 lds
  buffer_load_dwordx4 v12, s[12:15], s31 offen offset:2048 lds
  buffer_load_dwordx4 v13, s[12:15], s31 offen offset:3072 lds
  s_add_u32 m0, s42, 4096
  s_nop 0
  buffer_load_dwordx4 v14, s[12:15], s31 offen offset:0 lds
  buffer_load_dwordx4 v15, s[12:15], s31 offen offset:1024 lds
  buffer_load_dwordx4 v16, s[12:15], s31 offen offset:2048 lds
  s_add_u32 s31, s31, 917504
  s_add_u32 m0, s42, 45056
  s_nop 0
  buffer_load_dwordx4 v10, s[12:15], s31 offen offset:0 lds
  buffer_load_dwordx4 v11, s[12:15], s31 offen offset:1024 lds
  buffer_load_dwordx4 v12, s[12:15], s31 offen offset:2048 lds
  buffer_load_dwordx4 v13, s[12:15], s31 offen offset:3072 lds
  s_add_u32 m0, s42, 49152
  s_nop 0
  buffer_load_dwordx4 v14, s[12:15], s31 offen offset:0 lds
  buffer_load_dwordx4 v15, s[12:15], s31 offen offset:1024 lds
  buffer_load_dwordx4 v16, s[12:15], s31 offen offset:2048 lds
  s_add_u32 s31, s31, 917504
  s_barrier
  s_cmp_lg_u32 s40, 0
  s_cbranch_scc1 recurrent_scan__ssm_conv_h3__mixer_s_mlp__prompt_kernel_nf1004
  s_mov_b64 exec, 1
  buffer_store_dword v29, v28, s[4:7], s87 offen sc1
  s_mov_b64 exec, -1
recurrent_scan__ssm_conv_h3__mixer_s_mlp__prompt_kernel_nf1004:
  s_cmp_lg_u32 s40, 0
  s_cbranch_scc1 k3a_gok
k3a_gate:
  buffer_load_dword v31, v28, s[4:7], s53 offen sc1
  s_waitcnt vmcnt(0)
  v_cmp_ne_u32 vcc, 1, v31
  s_nop 4
  s_cbranch_vccz k3a_gok
  s_sleep 4
  s_add_u32 s101, s101, 1
  s_cmp_lt_u32 s101, 0x40000
  s_cbranch_scc1 k3a_gate
k3a_gok:
  s_barrier
  s_add_u32 m0, s41, 0
  s_nop 0
  buffer_load_dwordx4 v6, s[4:7], s30 offen offset:0 sc1 lds
  buffer_load_dwordx4 v6, s[4:7], s30 offen offset:1024 sc1 lds
  buffer_load_dwordx4 v7, s[4:7], s30 offen offset:2048 sc1 lds
  buffer_load_dwordx4 v7, s[4:7], s30 offen offset:3072 sc1 lds
  s_add_u32 s30, s30, 32768
  s_add_u32 m0, s41, 45056
  s_nop 0
  buffer_load_dwordx4 v6, s[4:7], s30 offen offset:0 sc1 lds
  buffer_load_dwordx4 v6, s[4:7], s30 offen offset:1024 sc1 lds
  buffer_load_dwordx4 v7, s[4:7], s30 offen offset:2048 sc1 lds
  buffer_load_dwordx4 v7, s[4:7], s30 offen offset:3072 sc1 lds
  s_add_u32 s30, s30, 32768
  s_waitcnt vmcnt(4)
  s_barrier
  s_branch k3_ljoin
k3_lconv:
  s_add_u32 m0, s42, 0
  s_nop 0
  buffer_load_dwordx4 v10, s[12:15], s31 offen offset:0 lds
  buffer_load_dwordx4 v11, s[12:15], s31 offen offset:1024 lds
  buffer_load_dwordx4 v12, s[12:15], s31 offen offset:2048 lds
  buffer_load_dwordx4 v13, s[12:15], s31 offen offset:3072 lds
  s_add_u32 m0, s42, 4096
  s_nop 0
  buffer_load_dwordx4 v14, s[12:15], s31 offen offset:0 lds
  buffer_load_dwordx4 v15, s[12:15], s31 offen offset:1024 lds
  buffer_load_dwordx4 v16, s[12:15], s31 offen offset:2048 lds
  s_add_u32 s31, s31, 917504
  s_add_u32 m0, s42, 45056
  s_nop 0
  buffer_load_dwordx4 v10, s[12:15], s31 offen offset:0 lds
  buffer_load_dwordx4 v11, s[12:15], s31 offen offset:1024 lds
  buffer_load_dwordx4 v12, s[12:15], s31 offen offset:2048 lds
  buffer_load_dwordx4 v13, s[12:15], s31 offen offset:3072 lds
  s_add_u32 m0, s42, 49152
  s_nop 0
  buffer_load_dwordx4 v14, s[12:15], s31 offen offset:0 lds
  buffer_load_dwordx4 v15, s[12:15], s31 offen offset:1024 lds
  buffer_load_dwordx4 v16, s[12:15], s31 offen offset:2048 lds
  s_add_u32 s31, s31, 917504
k3b_gate:
  buffer_load_dword v31, v28, s[4:7], s53 offen sc1
  s_waitcnt vmcnt(0)
  v_cmp_ne_u32 vcc, 1, v31
  s_nop 4
  s_cbranch_vccz k3b_gok
  s_cmp_eq_u64 vcc, exec
  s_cbranch_scc0 k3b_sh
  s_sleep 24
k3b_sh:
  s_sleep 4
  s_add_u32 s101, s101, 1
  s_cmp_lt_u32 s101, 0x40000
  s_cbranch_scc1 k3b_gate
k3b_gok:
  s_add_u32 m0, s41, 0
  s_nop 0
  buffer_load_dwordx4 v6, s[4:7], s30 offen offset:0 sc1 lds
  buffer_load_dwordx4 v6, s[4:7], s30 offen offset:1024 sc1 lds
  buffer_load_dwordx4 v7, s[4:7], s30 offen offset:2048 sc1 lds
  buffer_load_dwordx4 v7, s[4:7], s30 offen offset:3072 sc1 lds
  s_add_u32 s30, s30, 32768
  s_add_u32 m0, s41, 45056
  s_nop 0
  buffer_load_dwordx4 v6, s[4:7], s30 offen offset:0 sc1 lds
  buffer_load_dwordx4 v6, s[4:7], s30 offen offset:1024 sc1 lds
  buffer_load_dwordx4 v7, s[4:7], s30 offen offset:2048 sc1 lds
  buffer_load_dwordx4 v7, s[4:7], s30 offen offset:3072 sc1 lds
  s_add_u32 s30, s30, 32768
  s_waitcnt vmcnt(4)
  s_barrier
  s_barrier
  s_barrier
  s_cmp_lg_u32 s40, 0
  s_cbranch_scc1 recurrent_scan__ssm_conv_h3__mixer_s_mlp__prompt_kernel_nf1005
  s_mov_b64 exec, 1
  buffer_store_dword v29, v28, s[4:7], s87 offen sc1
  s_mov_b64 exec, -1
recurrent_scan__ssm_conv_h3__mixer_s_mlp__prompt_kernel_nf1005:
k3_ljoin:
  s_add_u32 m0, s41, 90112
  s_nop 0
  buffer_load_dwordx4 v6, s[4:7], s30 offen offset:0 sc1 lds
  buffer_load_dwordx4 v6, s[4:7], s30 offen offset:1024 sc1 lds
  buffer_load_dwordx4 v7, s[4:7], s30 offen offset:2048 sc1 lds
  buffer_load_dwordx4 v7, s[4:7], s30 offen offset:3072 sc1 lds
  s_add_u32 s30, s30, 32768
  s_add_u32 m0, s42, 90112
  s_nop 0
  buffer_load_dwordx4 v10, s[12:15], s31 offen offset:0 lds
  buffer_load_dwordx4 v11, s[12:15], s31 offen offset:1024 lds
  buffer_load_dwordx4 v12, s[12:15], s31 offen offset:2048 lds
  buffer_load_dwordx4 v13, s[12:15], s31 offen offset:3072 lds
  s_add_u32 m0, s42, 94208
  s_nop 0
  buffer_load_dwordx4 v14, s[12:15], s31 offen offset:0 lds
  buffer_load_dwordx4 v15, s[12:15], s31 offen offset:1024 lds
  buffer_load_dwordx4 v16, s[12:15], s31 offen offset:2048 lds
  s_add_u32 s31, s31, 917504
  s_waitcnt vmcnt(11)
  s_barrier
  s_add_u32 m0, s41, 0
  s_nop 0
  buffer_load_dwordx4 v6, s[4:7], s30 offen offset:0 sc1 lds
  buffer_load_dwordx4 v6, s[4:7], s30 offen offset:1024 sc1 lds
  buffer_load_dwordx4 v7, s[4:7], s30 offen offset:2048 sc1 lds
  buffer_load_dwordx4 v7, s[4:7], s30 offen offset:3072 sc1 lds
  s_add_u32 s30, s30, 32768
  s_add_u32 m0, s42, 0
  s_nop 0
  buffer_load_dwordx4 v10, s[12:15], s31 offen offset:0 lds
  buffer_load_dwordx4 v11, s[12:15], s31 offen offset:1024 lds
  buffer_load_dwordx4 v12, s[12:15], s31 offen offset:2048 lds
  buffer_load_dwordx4 v13, s[12:15], s31 offen offset:3072 lds
  s_add_u32 m0, s42, 4096
  s_nop 0
  buffer_load_dwordx4 v14, s[12:15], s31 offen offset:0 lds
  buffer_load_dwordx4 v15, s[12:15], s31 offen offset:1024 lds
  buffer_load_dwordx4 v16, s[12:15], s31 offen offset:2048 lds
  s_add_u32 s31, s31, 917504
  s_waitcnt vmcnt(11) lgkmcnt(0)
  s_barrier
  s_add_u32 m0, s41, 45056
  s_nop 0
  buffer_load_dwordx4 v6, s[4:7], s30 offen offset:0 sc1 lds
  buffer_load_dwordx4 v6, s[4:7], s30 offen offset:1024 sc1 lds
  buffer_load_dwordx4 v7, s[4:7], s30 offen offset:2048 sc1 lds
  buffer_load_dwordx4 v7, s[4:7], s30 offen offset:3072 sc1 lds
  s_add_u32 s30, s30, 32768
  s_add_u32 m0, s42, 45056
  s_nop 0
  buffer_load_dwordx4 v10, s[12:15], s31 offen offset:0 lds
  buffer_load_dwordx4 v11, s[12:15], s31 offen offset:1024 lds
  buffer_load_dwordx4 v12, s[12:15], s31 offen offset:2048 lds
  buffer_load_dwordx4 v13, s[12:15], s31 offen offset:3072 lds
  s_add_u32 m0, s42, 49152
  s_nop 0
  buffer_load_dwordx4 v14, s[12:15], s31 offen offset:0 lds
  buffer_load_dwordx4 v15, s[12:15], s31 offen offset:1024 lds
  buffer_load_dwordx4 v16, s[12:15], s31 offen offset:2048 lds
  s_add_u32 s31, s31, 917504
  s_waitcnt vmcnt(11) lgkmcnt(0)
  s_barrier
  s_add_u32 m0, s41, 90112
  s_nop 0
  buffer_load_dwordx4 v6, s[4:7], s30 offen offset:0 sc1 lds
  buffer_load_dwordx4 v6, s[4:7], s30 offen offset:1024 sc1 lds
  buffer_load_dwordx4 v7, s[4:7], s30 offen offset:2048 sc1 lds
  buffer_load_dwordx4 v7, s[4:7], s30 offen offset:3072 sc1 lds
  s_add_u32 s30, s30, 32768
  s_add_u32 m0, s42, 90112
  s_nop 0
  buffer_load_dwordx4 v10, s[12:15], s31 offen offset:0 lds
  buffer_load_dwordx4 v11, s[12:15], s31 offen offset:1024 lds
  buffer_load_dwordx4 v12, s[12:15], s31 offen offset:2048 lds
  buffer_load_dwordx4 v13, s[12:15], s31 offen offset:3072 lds
  s_add_u32 m0, s42, 94208
  s_nop 0
  buffer_load_dwordx4 v14, s[12:15], s31 offen offset:0 lds
  buffer_load_dwordx4 v15, s[12:15], s31 offen offset:1024 lds
  buffer_load_dwordx4 v16, s[12:15], s31 offen offset:2048 lds
  s_add_u32 s31, s31, 917504
  s_waitcnt vmcnt(11) lgkmcnt(0)
  s_barrier
  s_add_u32 m0, s41, 0
  s_nop 0
  buffer_load_dwordx4 v6, s[4:7], s30 offen offset:0 sc1 lds
  buffer_load_dwordx4 v6, s[4:7], s30 offen offset:1024 sc1 lds
  buffer_load_dwordx4 v7, s[4:7], s30 offen offset:2048 sc1 lds
  buffer_load_dwordx4 v7, s[4:7], s30 offen offset:3072 sc1 lds
  s_add_u32 s30, s30, 32768
  s_add_u32 m0, s42, 0
  s_nop 0
  buffer_load_dwordx4 v10, s[12:15], s31 offen offset:0 lds
  buffer_load_dwordx4 v11, s[12:15], s31 offen offset:1024 lds
  buffer_load_dwordx4 v12, s[12:15], s31 offen offset:2048 lds
  buffer_load_dwordx4 v13, s[12:15], s31 offen offset:3072 lds
  s_add_u32 m0, s42, 4096
  s_nop 0
  buffer_load_dwordx4 v14, s[12:15], s31 offen offset:0 lds
  buffer_load_dwordx4 v15, s[12:15], s31 offen offset:1024 lds
  buffer_load_dwordx4 v16, s[12:15], s31 offen offset:2048 lds
  s_add_u32 s31, s31, 917504
  s_waitcnt vmcnt(11) lgkmcnt(0)
  s_barrier
  buffer_load_dword v31, v28, s[4:7], s58 offen sc1
  s_add_u32 m0, s41, 45056
  s_nop 0
  buffer_load_dwordx4 v6, s[4:7], s30 offen offset:0 sc1 lds
  buffer_load_dwordx4 v6, s[4:7], s30 offen offset:1024 sc1 lds
  buffer_load_dwordx4 v7, s[4:7], s30 offen offset:2048 sc1 lds
  buffer_load_dwordx4 v7, s[4:7], s30 offen offset:3072 sc1 lds
  s_add_u32 s30, s30, 4294721536
  s_add_u32 m0, s42, 45056
  s_nop 0
  buffer_load_dwordx4 v10, s[12:15], s31 offen offset:0 lds
  buffer_load_dwordx4 v11, s[12:15], s31 offen offset:1024 lds
  buffer_load_dwordx4 v12, s[12:15], s31 offen offset:2048 lds
  buffer_load_dwordx4 v13, s[12:15], s31 offen offset:3072 lds
  s_add_u32 m0, s42, 49152
  s_nop 0
  buffer_load_dwordx4 v14, s[12:15], s31 offen offset:0 lds
  buffer_load_dwordx4 v15, s[12:15], s31 offen offset:1024 lds
  buffer_load_dwordx4 v16, s[12:15], s31 offen offset:2048 lds
  s_add_u32 s31, s31, 4288086016
  s_waitcnt vmcnt(11) lgkmcnt(0)
  s_barrier
k3f_gate:
  v_cmp_ne_u32 vcc, 1, v31
  s_nop 4
  s_cbranch_vccz k3f_gok
  s_sleep 4
  buffer_load_dword v31, v28, s[4:7], s58 offen sc1
  s_waitcnt vmcnt(0)
  s_add_u32 s101, s101, 1
  s_cmp_lt_u32 s101, 0x40000
  s_cbranch_scc1 k3f_gate
k3f_gok:
  s_add_u32 m0, s41, 90112
  s_nop 0
  buffer_load_dwordx4 v6, s[4:7], s30 offen offset:0 sc1 lds
  buffer_load_dwordx4 v6, s[4:7], s30 offen offset:1024 sc1 lds
  buffer_load_dwordx4 v7, s[4:7], s30 offen offset:2048 sc1 lds
  buffer_load_dwordx4 v7, s[4:7], s30 offen offset:3072 sc1 lds
  s_add_u32 s30, s30, 32768
  s_add_u32 m0, s42, 90112
  s_nop 0
  buffer_load_dwordx4 v10, s[12:15], s31 offen offset:0 lds
  buffer_load_dwordx4 v11, s[12:15], s31 offen offset:1024 lds
  buffer_load_dwordx4 v12, s[12:15], s31 offen offset:2048 lds
  buffer_load_dwordx4 v13, s[12:15], s31 offen offset:3072 lds
  s_add_u32 m0, s42, 94208
  s_nop 0
  buffer_load_dwordx4 v14, s[12:15], s31 offen offset:0 lds
  buffer_load_dwordx4 v15, s[12:15], s31 offen offset:1024 lds
  buffer_load_dwordx4 v16, s[12:15], s31 offen offset:2048 lds
  s_add_u32 s31, s31, 917504
  s_waitcnt vmcnt(11) lgkmcnt(0)
  s_barrier
  s_add_u32 m0, s41, 0
  s_nop 0
  buffer_load_dwordx4 v6, s[4:7], s30 offen offset:0 sc1 lds
  buffer_load_dwordx4 v6, s[4:7], s30 offen offset:1024 sc1 lds
  buffer_load_dwordx4 v7, s[4:7], s30 offen offset:2048 sc1 lds
  buffer_load_dwordx4 v7, s[4:7], s30 offen offset:3072 sc1 lds
  s_add_u32 s30, s30, 32768
  s_add_u32 m0, s42, 0
  s_nop 0
  buffer_load_dwordx4 v10, s[12:15], s31 offen offset:0 lds
  buffer_load_dwordx4 v11, s[12:15], s31 offen offset:1024 lds
  buffer_load_dwordx4 v12, s[12:15], s31 offen offset:2048 lds
  buffer_load_dwordx4 v13, s[12:15], s31 offen offset:3072 lds
  s_add_u32 m0, s42, 4096
  s_nop 0
  buffer_load_dwordx4 v14, s[12:15], s31 offen offset:0 lds
  buffer_load_dwordx4 v15, s[12:15], s31 offen offset:1024 lds
  buffer_load_dwordx4 v16, s[12:15], s31 offen offset:2048 lds
  s_add_u32 s31, s31, 917504
  s_waitcnt vmcnt(11) lgkmcnt(0)
  s_barrier
  s_add_u32 m0, s41, 45056
  s_nop 0
  buffer_load_dwordx4 v6, s[4:7], s30 offen offset:0 sc1 lds
  buffer_load_dwordx4 v6, s[4:7], s30 offen offset:1024 sc1 lds
  buffer_load_dwordx4 v7, s[4:7], s30 offen offset:2048 sc1 lds
  buffer_load_dwordx4 v7, s[4:7], s30 offen offset:3072 sc1 lds
  s_add_u32 s30, s30, 32768
  s_add_u32 m0, s42, 45056
  s_nop 0
  buffer_load_dwordx4 v10, s[12:15], s31 offen offset:0 lds
  buffer_load_dwordx4 v11, s[12:15], s31 offen offset:1024 lds
  buffer_load_dwordx4 v12, s[12:15], s31 offen offset:2048 lds
  buffer_load_dwordx4 v13, s[12:15], s31 offen offset:3072 lds
  s_add_u32 m0, s42, 49152
  s_nop 0
  buffer_load_dwordx4 v14, s[12:15], s31 offen offset:0 lds
  buffer_load_dwordx4 v15, s[12:15], s31 offen offset:1024 lds
  buffer_load_dwordx4 v16, s[12:15], s31 offen offset:2048 lds
  s_add_u32 s31, s31, 917504
  s_waitcnt vmcnt(11) lgkmcnt(0)
  s_barrier
  s_add_u32 m0, s41, 90112
  s_nop 0
  buffer_load_dwordx4 v6, s[4:7], s30 offen offset:0 sc1 lds
  buffer_load_dwordx4 v6, s[4:7], s30 offen offset:1024 sc1 lds
  buffer_load_dwordx4 v7, s[4:7], s30 offen offset:2048 sc1 lds
  buffer_load_dwordx4 v7, s[4:7], s30 offen offset:3072 sc1 lds
  s_add_u32 s30, s30, 32768
  s_add_u32 m0, s42, 90112
  s_nop 0
  buffer_load_dwordx4 v10, s[12:15], s31 offen offset:0 lds
  buffer_load_dwordx4 v11, s[12:15], s31 offen offset:1024 lds
  buffer_load_dwordx4 v12, s[12:15], s31 offen offset:2048 lds
  buffer_load_dwordx4 v13, s[12:15], s31 offen offset:3072 lds
  s_add_u32 m0, s42, 94208
  s_nop 0
  buffer_load_dwordx4 v14, s[12:15], s31 offen offset:0 lds
  buffer_load_dwordx4 v15, s[12:15], s31 offen offset:1024 lds
  buffer_load_dwordx4 v16, s[12:15], s31 offen offset:2048 lds
  s_add_u32 s31, s31, 917504
  s_waitcnt vmcnt(11) lgkmcnt(0)
  s_barrier
  s_add_u32 m0, s41, 0
  s_nop 0
  buffer_load_dwordx4 v6, s[4:7], s30 offen offset:0 sc1 lds
  buffer_load_dwordx4 v6, s[4:7], s30 offen offset:1024 sc1 lds
  buffer_load_dwordx4 v7, s[4:7], s30 offen offset:2048 sc1 lds
  buffer_load_dwordx4 v7, s[4:7], s30 offen offset:3072 sc1 lds
  s_add_u32 s30, s30, 32768
  s_add_u32 m0, s42, 0
  s_nop 0
  buffer_load_dwordx4 v10, s[12:15], s31 offen offset:0 lds
  buffer_load_dwordx4 v11, s[12:15], s31 offen offset:1024 lds
  buffer_load_dwordx4 v12, s[12:15], s31 offen offset:2048 lds
  buffer_load_dwordx4 v13, s[12:15], s31 offen offset:3072 lds
  s_add_u32 m0, s42, 4096
  s_nop 0
  buffer_load_dwordx4 v14, s[12:15], s31 offen offset:0 lds
  buffer_load_dwordx4 v15, s[12:15], s31 offen offset:1024 lds
  buffer_load_dwordx4 v16, s[12:15], s31 offen offset:2048 lds
  s_add_u32 s31, s31, 917504
  s_waitcnt vmcnt(11) lgkmcnt(0)
  s_barrier
  s_add_u32 m0, s41, 45056
  s_nop 0
  buffer_load_dwordx4 v6, s[4:7], s30 offen offset:0 sc1 lds
  buffer_load_dwordx4 v6, s[4:7], s30 offen offset:1024 sc1 lds
  buffer_load_dwordx4 v7, s[4:7], s30 offen offset:2048 sc1 lds
  buffer_load_dwordx4 v7, s[4:7], s30 offen offset:3072 sc1 lds
  s_add_u32 s30, s30, 32768
  s_add_u32 m0, s42, 45056
  s_nop 0
  buffer_load_dwordx4 v10, s[12:15], s31 offen offset:0 lds
  buffer_load_dwordx4 v11, s[12:15], s31 offen offset:1024 lds
  buffer_load_dwordx4 v12, s[12:15], s31 offen offset:2048 lds
  buffer_load_dwordx4 v13, s[12:15], s31 offen offset:3072 lds
  s_add_u32 m0, s42, 49152
  s_nop 0
  buffer_load_dwordx4 v14, s[12:15], s31 offen offset:0 lds
  buffer_load_dwordx4 v15, s[12:15], s31 offen offset:1024 lds
  buffer_load_dwordx4 v16, s[12:15], s31 offen offset:2048 lds
  s_add_u32 s31, s31, 917504
  s_waitcnt vmcnt(11) lgkmcnt(0)
  s_barrier
  s_add_u32 m0, s41, 90112
  s_nop 0
  buffer_load_dwordx4 v6, s[4:7], s30 offen offset:0 sc1 lds
  buffer_load_dwordx4 v6, s[4:7], s30 offen offset:1024 sc1 lds
  buffer_load_dwordx4 v7, s[4:7], s30 offen offset:2048 sc1 lds
  buffer_load_dwordx4 v7, s[4:7], s30 offen offset:3072 sc1 lds
  s_add_u32 s30, s30, 32768
  s_add_u32 m0, s42, 90112
  s_nop 0
  buffer_load_dwordx4 v10, s[12:15], s31 offen offset:0 lds
  buffer_load_dwordx4 v11, s[12:15], s31 offen offset:1024 lds
  buffer_load_dwordx4 v12, s[12:15], s31 offen offset:2048 lds
  buffer_load_dwordx4 v13, s[12:15], s31 offen offset:3072 lds
  s_add_u32 m0, s42, 94208
  s_nop 0
  buffer_load_dwordx4 v14, s[12:15], s31 offen offset:0 lds
  buffer_load_dwordx4 v15, s[12:15], s31 offen offset:1024 lds
  buffer_load_dwordx4 v16, s[12:15], s31 offen offset:2048 lds
  s_add_u32 s31, s31, 917504
  s_waitcnt vmcnt(11) lgkmcnt(0)
  s_barrier
  s_add_u32 m0, s41, 0
  s_nop 0
  buffer_load_dwordx4 v6, s[4:7], s30 offen offset:0 sc1 lds
  buffer_load_dwordx4 v6, s[4:7], s30 offen offset:1024 sc1 lds
  buffer_load_dwordx4 v7, s[4:7], s30 offen offset:2048 sc1 lds
  buffer_load_dwordx4 v7, s[4:7], s30 offen offset:3072 sc1 lds
  s_add_u32 s30, s30, 32768
  s_add_u32 m0, s42, 0
  s_nop 0
  buffer_load_dwordx4 v10, s[12:15], s31 offen offset:0 lds
  buffer_load_dwordx4 v11, s[12:15], s31 offen offset:1024 lds
  buffer_load_dwordx4 v12, s[12:15], s31 offen offset:2048 lds
  buffer_load_dwordx4 v13, s[12:15], s31 offen offset:3072 lds
  s_add_u32 m0, s42, 4096
  s_nop 0
  buffer_load_dwordx4 v14, s[12:15], s31 offen offset:0 lds
  buffer_load_dwordx4 v15, s[12:15], s31 offen offset:1024 lds
  buffer_load_dwordx4 v16, s[12:15], s31 offen offset:2048 lds
  s_add_u32 s31, s31, 917504
  buffer_load_dwordx2 v[80:81], v30, s[4:7], s57 offen sc1
  s_waitcnt vmcnt(12) lgkmcnt(0)
  s_barrier
k3_gatec:
  s_waitcnt vmcnt(0)
  v_and_b32 v80, v80, v81
  v_cmp_ne_u32 vcc, 1, v80
  s_nop 4
  s_cbranch_vccz k3_gcok
  s_sleep 4
  buffer_load_dwordx2 v[80:81], v30, s[4:7], s57 offen sc1
  s_add_u32 s101, s101, 1
  s_cmp_lt_u32 s101, 0x40000
  s_cbranch_scc1 k3_gatec
k3_gcok:
  buffer_load_dwordx2 v[32:33], v21, s[4:7], s50 offen sc1
  s_add_u32 s50, s50, 16384
  buffer_load_dwordx2 v[34:35], v21, s[4:7], s50 offen sc1
  s_add_u32 s50, s50, 16384
  buffer_load_dwordx2 v[36:37], v21, s[4:7], s50 offen sc1
  s_add_u32 s50, s50, 16384
  buffer_load_dwordx2 v[38:39], v21, s[4:7], s50 offen sc1
  s_add_u32 s50, s50, 16384
  buffer_load_dwordx2 v[40:41], v21, s[4:7], s50 offen sc1
  s_add_u32 s50, s50, 16384
  buffer_load_dwordx2 v[42:43], v21, s[4:7], s50 offen sc1
  s_add_u32 s50, s50, 16384
  buffer_load_dwordx2 v[44:45], v21, s[4:7], s50 offen sc1
  s_add_u32 s50, s50, 16384
  buffer_load_dwordx2 v[46:47], v21, s[4:7], s50 offen sc1
  buffer_load_dword v64, v22, s[4:7], s52 offen sc1
  s_add_u32 s52, s52, 14336
  buffer_load_dword v65, v22, s[4:7], s52 offen sc1
  s_add_u32 s52, s52, 14336
  buffer_load_dword v66, v22, s[4:7], s52 offen sc1
  s_add_u32 s52, s52, 14336
  buffer_load_dword v67, v22, s[4:7], s52 offen sc1
  s_waitcnt vmcnt(12) lgkmcnt(0)
  s_barrier
  s_waitcnt vmcnt(0)
  v_add_f32 v32, v32, v34
  v_add_f32 v33, v33, v35
  v_add_f32 v32, v32, v36
  v_add_f32 v33, v33, v37
  v_add_f32 v32, v32, v38
  v_add_f32 v33, v33, v39
  v_add_f32 v32, v32, v40
  v_add_f32 v33, v33, v41
  v_add_f32 v32, v32, v42
  v_add_f32 v33, v33, v43
  v_add_f32 v32, v32, v44
  v_add_f32 v33, v33, v45
  v_add_f32 v32, v32, v46
  v_add_f32 v33, v33, v47
  v_mov_b32 v34, v32
  v_mov_b32 v35, v33
  s_nop 0
  v_permlane32_swap_b32 v32, v34
  v_permlane32_swap_b32 v33, v35
  v_add_f32 v32, v32, v34
  v_add_f32 v33, v33, v35
  v_mul_f32 v32, 0x3a800000, v32
  v_mul_f32 v33, 0x3a800000, v33
  v_fma_f32 v33, -v32, v32, v33
  v_max_f32_e64 v33, 0, v33
  v_cvt_pk_bf16_f32 v36, v32, v32
  v_and_b32 v36, 0xffff0000, v36
  v_cvt_pk_bf16_f32 v34, v33, v33
  v_and_b32 v34, 0xffff0000, v34
  v_add_f32 v34, 0x3727c5ac, v34
  v_cvt_pk_bf16_f32 v34, v34, v34
  v_and_b32 v34, 0xffff0000, v34
  v_sqrt_f32 v34, v34
  s_nop 0
  v_cvt_pk_bf16_f32 v34, v34, v34
  v_and_b32 v34, 0xffff0000, v34
  v_rcp_f32 v38, v34
  s_nop 0
  v_mul_f32 v39, v36, v38
  v_sub_f32 v39, 0, v39
  ds_write_b64 v20, v[38:39]
  v_add_f32 v64, v64, v65
  v_add_f32 v64, v64, v66
  v_add_f32 v64, v64, v67
  ds_write_b32 v23, v64
  s_waitcnt lgkmcnt(0)
  s_barrier
  s_waitcnt lgkmcnt(0)
  s_lshr_b32 s26, s35, 3
  s_and_b32 s35, s35, 7
  s_lshl_b32 s27, s35, 1
  s_add_u32 s27, s27, s26
  s_mul_i32 s30, s34, 917504
  s_mul_i32 s36, s26, 458752
  s_add_u32 s30, s30, s36
  s_add_u32 s30, s30, 50331648
  s_lshl_b32 s31, s35, 8
  s_mul_i32 s36, s26, 3670016
  s_add_u32 s31, s31, s36
  s_sub_u32 s40, s33, 4
  s_lshl_b32 s41, s40, 12
  s_mul_i32 s36, s40, 4096
  v_lshl_add_u32 v6, v1, 4, s36
  v_add_u32 v7, 0, v6
  v_lshrrev_b32 v2, 4, v1
  v_and_b32 v3, 15, v1
  v_lshlrev_b32 v4, 1, v2
  v_xor_b32 v3, v3, v4
  v_lshlrev_b32 v3, 4, v3
  v_lshl_add_u32 v3, v2, 11, v3
  s_lshl_b32 s36, s40, 15
  v_add_u32_e64 v10, s36, v3
  v_add_u32 v11, 7168, v10
  v_xor_b32 v3, 128, v10
  v_add_u32 v12, 14336, v3
  v_add_u32 v13, 21504, v3
  s_mul_i32 s42, s40, 4096
  s_add_u32 s42, s42, 16384
  v_and_b32 v24, 7, v1
  v_lshlrev_b32 v24, 7, v24
  v_mov_b32 v23, 1
  s_lshl_b32 s53, s34, 1
  s_add_u32 s53, s53, s26
  s_lshl_b32 s53, s53, 10
  s_add_u32 s57, s53, 40009728
  s_add_u32 s53, s53, 39878656
  s_lshl_b32 s54, s35, 7
  s_add_u32 s54, s54, s53
  s_mul_i32 s84, s35, 7
  s_add_u32 s84, s84, 1
  s_lshr_b32 s84, s84, 1
  s_add_u32 s85, s84, 2
  s_lshl_b32 s58, s35, 7
  s_add_u32 s58, s58, s57
  s_mov_b32 s80, s30
  s_mov_b32 s81, s31
  s_add_u32 s86, s84, 0
  s_mul_i32 s86, s86, 131072
  s_add_u32 s31, s81, s86
  s_add_u32 m0, s42, 0
  s_nop 0
  buffer_load_dwordx4 v10, s[16:19], s31 offen offset:0 lds
  buffer_load_dwordx4 v11, s[16:19], s31 offen offset:1024 lds
  buffer_load_dwordx4 v12, s[16:19], s31 offen offset:2048 lds
  buffer_load_dwordx4 v13, s[16:19], s31 offen offset:3072 lds
  v_lshrrev_b32 v2, 3, v1
  v_and_b32 v3, 7, v1
  v_lshrrev_b32 v4, 4, v1
  v_xor_b32 v3, v3, v4
  v_lshlrev_b32 v3, 4, v3
  v_lshl_add_u32 v20, v2, 11, v3
  v_xor_b32 v21, 64, v20
  s_lshl_b32 s46, s34, 18
  s_lshl_b32 s47, s40, 16
  s_add_u32 s46, s46, s47
  s_lshl_b32 s47, s27, 7
  s_add_u32 s46, s46, s47
  s_add_u32 s47, s41, 131072
  v_lshlrev_b32 v22, 4, v1
  s_lshl_b32 s50, s34, 18
  s_lshl_b32 s51, s27, 14
  s_add_u32 s50, s50, s51
  s_add_u32 s50, s50, s41
  s_add_u32 s50, s50, 20971520
  s_mul_i32 s52, s34, 262144
  s_lshl_b32 s51, s27, 14
  s_add_u32 s52, s52, s51
  s_add_u32 s52, s52, 16777216
  v_and_b32 v27, 1, v1
  v_lshlrev_b32 v27, 11, v27
  s_lshl_b32 s56, s29, 2
  s_add_u32 s56, s56, s40
  s_lshl_b32 s56, s56, 1
  s_add_u32 s56, s56, 768
  s_lshl_b32 s56, s56, 11
  s_add_u32 s56, s56, s55
  s_add_u32 s86, s84, 1
  s_mul_i32 s86, s86, 131072
  s_add_u32 s31, s81, s86
  s_add_u32 m0, s42, 32768
  s_nop 0
  buffer_load_dwordx4 v10, s[16:19], s31 offen offset:0 lds
  buffer_load_dwordx4 v11, s[16:19], s31 offen offset:1024 lds
  buffer_load_dwordx4 v12, s[16:19], s31 offen offset:2048 lds
  buffer_load_dwordx4 v13, s[16:19], s31 offen offset:3072 lds
  s_add_u32 s86, s84, 2
  s_mul_i32 s86, s86, 131072
  s_add_u32 s31, s81, s86
  s_add_u32 m0, s42, 65536
  s_nop 0
  buffer_load_dwordx4 v10, s[16:19], s31 offen offset:0 lds
  buffer_load_dwordx4 v11, s[16:19], s31 offen offset:1024 lds
  buffer_load_dwordx4 v12, s[16:19], s31 offen offset:2048 lds
  buffer_load_dwordx4 v13, s[16:19], s31 offen offset:3072 lds
  s_cmp_gt_u32 s84, 0
  s_cselect_b32 s86, 0, 4
  s_mul_i32 s86, s86, 131072
  s_add_u32 s31, s81, s86
  s_add_u32 m0, s42, 98304
  s_nop 0
  buffer_load_dwordx4 v10, s[16:19], s31 offen offset:0 lds
  buffer_load_dwordx4 v11, s[16:19], s31 offen offset:1024 lds
  buffer_load_dwordx4 v12, s[16:19], s31 offen offset:2048 lds
  buffer_load_dwordx4 v13, s[16:19], s31 offen offset:3072 lds
  s_barrier
  s_cmp_eq_u32 s40, 0
  s_cselect_b32 s86, s58, -1
  s_mov_b64 exec, 1
  buffer_store_dword v23, v24, s[4:7], s86 offen sc1
  s_mov_b64 exec, -1
  s_barrier
  buffer_load_dword v25, v24, s[4:7], s57 offen sc1
  s_waitcnt vmcnt(0)
  s_barrier
k4a_gate:
  v_cmp_ne_u32 vcc, 1, v25
  s_nop 4
  s_cbranch_vccz k4a_gok
  s_sleep 4
  buffer_load_dword v25, v24, s[4:7], s57 offen sc1
  s_waitcnt vmcnt(0)
  s_add_u32 s101, s101, 1
  s_cmp_lt_u32 s101, 0x40000
  s_cbranch_scc1 k4a_gate
k4a_gok:
  s_cmp_gt_u32 s84, 0
  s_cselect_b32 s86, 0, 4
  s_mul_i32 s86, s86, 16384
  s_add_u32 s30, s80, s86
  s_add_u32 m0, s41, 98304
  s_nop 0
  buffer_load_dwordx4 v6, s[4:7], s30 offen offset:0 sc1 lds
  buffer_load_dwordx4 v6, s[4:7], s30 offen offset:1024 sc1 lds
  buffer_load_dwordx4 v7, s[4:7], s30 offen offset:2048 sc1 lds
  buffer_load_dwordx4 v7, s[4:7], s30 offen offset:3072 sc1 lds
  s_barrier
  s_cmp_gt_u32 s84, 1
  s_cselect_b32 s86, 1, 5
  s_mul_i32 s86, s86, 16384
  s_add_u32 s30, s80, s86
  s_add_u32 m0, s41, 0
  s_nop 0
  buffer_load_dwordx4 v6, s[4:7], s30 offen offset:0 sc1 lds
  buffer_load_dwordx4 v6, s[4:7], s30 offen offset:1024 sc1 lds
  buffer_load_dwordx4 v7, s[4:7], s30 offen offset:2048 sc1 lds
  buffer_load_dwordx4 v7, s[4:7], s30 offen offset:3072 sc1 lds
  s_cmp_gt_u32 s84, 1
  s_cselect_b32 s86, 1, 5
  s_mul_i32 s86, s86, 131072
  s_add_u32 s31, s81, s86
  s_add_u32 m0, s42, 0
  s_nop 0
  buffer_load_dwordx4 v10, s[16:19], s31 offen offset:0 lds
  buffer_load_dwordx4 v11, s[16:19], s31 offen offset:1024 lds
  buffer_load_dwordx4 v12, s[16:19], s31 offen offset:2048 lds
  buffer_load_dwordx4 v13, s[16:19], s31 offen offset:3072 lds
  s_barrier
  s_cmp_eq_u32 s40, 0
  s_cselect_b32 s86, s54, -1
  s_mov_b64 exec, 1
  buffer_store_dword v23, v24, s[4:7], s86 offen sc1
  s_mov_b64 exec, -1
  s_cmp_gt_u32 s84, 4
  s_cselect_b32 s86, 4, 7
  s_mul_i32 s86, s86, 16384
  s_add_u32 s30, s80, s86
  s_add_u32 m0, s41, 32768
  s_nop 0
  buffer_load_dwordx4 v6, s[4:7], s30 offen offset:0 sc1 lds
  buffer_load_dwordx4 v6, s[4:7], s30 offen offset:1024 sc1 lds
  buffer_load_dwordx4 v7, s[4:7], s30 offen offset:2048 sc1 lds
  buffer_load_dwordx4 v7, s[4:7], s30 offen offset:3072 sc1 lds
  s_cmp_gt_u32 s84, 4
  s_cselect_b32 s86, 4, 7
  s_mul_i32 s86, s86, 131072
  s_add_u32 s31, s81, s86
  s_add_u32 m0, s42, 32768
  s_nop 0
  buffer_load_dwordx4 v10, s[16:19], s31 offen offset:0 lds
  buffer_load_dwordx4 v11, s[16:19], s31 offen offset:1024 lds
  buffer_load_dwordx4 v12, s[16:19], s31 offen offset:2048 lds
  buffer_load_dwordx4 v13, s[16:19], s31 offen offset:3072 lds
  s_waitcnt vmcnt(17)
  s_barrier
  s_cmp_gt_u32 s84, 5
  s_cselect_b32 s86, 5, 8
  s_mul_i32 s86, s86, 16384
  s_add_u32 s30, s80, s86
  s_add_u32 m0, s41, 65536
  s_nop 0
  buffer_load_dwordx4 v6, s[4:7], s30 offen offset:0 sc1 lds
  buffer_load_dwordx4 v6, s[4:7], s30 offen offset:1024 sc1 lds
  buffer_load_dwordx4 v7, s[4:7], s30 offen offset:2048 sc1 lds
  buffer_load_dwordx4 v7, s[4:7], s30 offen offset:3072 sc1 lds
  s_cmp_gt_u32 s84, 5
  s_cselect_b32 s86, 5, 8
  s_mul_i32 s86, s86, 131072
  s_add_u32 s31, s81, s86
  s_add_u32 m0, s42, 65536
  s_nop 0
  buffer_load_dwordx4 v10, s[16:19], s31 offen offset:0 lds
  buffer_load_dwordx4 v11, s[16:19], s31 offen offset:1024 lds
  buffer_load_dwordx4 v12, s[16:19], s31 offen offset:2048 lds
  buffer_load_dwordx4 v13, s[16:19], s31 offen offset:3072 lds
  s_waitcnt vmcnt(17)
  s_barrier
  s_cmp_gt_u32 s84, 7
  s_cselect_b32 s86, 7, 11
  s_mul_i32 s86, s86, 16384
  s_add_u32 s30, s80, s86
  s_add_u32 m0, s41, 98304
  s_nop 0
  buffer_load_dwordx4 v6, s[4:7], s30 offen offset:0 sc1 lds
  buffer_load_dwordx4 v6, s[4:7], s30 offen offset:1024 sc1 lds
  buffer_load_dwordx4 v7, s[4:7], s30 offen offset:2048 sc1 lds
  buffer_load_dwordx4 v7, s[4:7], s30 offen offset:3072 sc1 lds
  s_cmp_gt_u32 s84, 7
  s_cselect_b32 s86, 7, 11
  s_mul_i32 s86, s86, 131072
  s_add_u32 s31, s81, s86
  s_add_u32 m0, s42, 98304
  s_nop 0
  buffer_load_dwordx4 v10, s[16:19], s31 offen offset:0 lds
  buffer_load_dwordx4 v11, s[16:19], s31 offen offset:1024 lds
  buffer_load_dwordx4 v12, s[16:19], s31 offen offset:2048 lds
  buffer_load_dwordx4 v13, s[16:19], s31 offen offset:3072 lds
  s_waitcnt vmcnt(16)
  s_barrier
  s_cmp_gt_u32 s84, 8
  s_cselect_b32 s86, 8, 12
  s_mul_i32 s86, s86, 16384
  s_add_u32 s30, s80, s86
  s_add_u32 m0, s41, 0
  s_nop 0
  buffer_load_dwordx4 v6, s[4:7], s30 offen offset:0 sc1 lds
  buffer_load_dwordx4 v6, s[4:7], s30 offen offset:1024 sc1 lds
  buffer_load_dwordx4 v7, s[4:7], s30 offen offset:2048 sc1 lds
  buffer_load_dwordx4 v7, s[4:7], s30 offen offset:3072 sc1 lds
  s_cmp_gt_u32 s84, 8
  s_cselect_b32 s86, 8, 12
  s_mul_i32 s86, s86, 131072
  s_add_u32 s31, s81, s86
  s_add_u32 m0, s42, 0
  s_nop 0
  buffer_load_dwordx4 v10, s[16:19], s31 offen offset:0 lds
  buffer_load_dwordx4 v11, s[16:19], s31 offen offset:1024 lds
  buffer_load_dwordx4 v12, s[16:19], s31 offen offset:2048 lds
  buffer_load_dwordx4 v13, s[16:19], s31 offen offset:3072 lds
  s_add_u32 m0, s47, 0
  s_nop 0
  buffer_load_dwordx4 v20, s[8:11], s46 offen lds
  s_add_u32 s46, s46, 16384
  s_waitcnt vmcnt(17)
  s_barrier
  s_cmp_gt_u32 s84, 11
  s_cselect_b32 s86, 11, 14
  s_mul_i32 s86, s86, 16384
  s_add_u32 s30, s80, s86
  s_add_u32 m0, s41, 32768
  s_nop 0
  buffer_load_dwordx4 v6, s[4:7], s30 offen offset:0 sc1 lds
  buffer_load_dwordx4 v6, s[4:7], s30 offen offset:1024 sc1 lds
  buffer_load_dwordx4 v7, s[4:7], s30 offen offset:2048 sc1 lds
  buffer_load_dwordx4 v7, s[4:7], s30 offen offset:3072 sc1 lds
  s_cmp_gt_u32 s84, 11
  s_cselect_b32 s86, 11, 14
  s_mul_i32 s86, s86, 131072
  s_add_u32 s31, s81, s86
  s_add_u32 m0, s42, 32768
  s_nop 0
  buffer_load_dwordx4 v10, s[16:19], s31 offen offset:0 lds
  buffer_load_dwordx4 v11, s[16:19], s31 offen offset:1024 lds
  buffer_load_dwordx4 v12, s[16:19], s31 offen offset:2048 lds
  buffer_load_dwordx4 v13, s[16:19], s31 offen offset:3072 lds
  s_waitcnt vmcnt(17)
  s_barrier
  s_cmp_gt_u32 s84, 12
  s_cselect_b32 s86, 12, 15
  s_mul_i32 s86, s86, 16384
  s_add_u32 s30, s80, s86
  s_add_u32 m0, s41, 65536
  s_nop 0
  buffer_load_dwordx4 v6, s[4:7], s30 offen offset:0 sc1 lds
  buffer_load_dwordx4 v6, s[4:7], s30 offen offset:1024 sc1 lds
  buffer_load_dwordx4 v7, s[4:7], s30 offen offset:2048 sc1 lds
  buffer_load_dwordx4 v7, s[4:7], s30 offen offset:3072 sc1 lds
  s_cmp_gt_u32 s84, 12
  s_cselect_b32 s86, 12, 15
  s_mul_i32 s86, s86, 131072
  s_add_u32 s31, s81, s86
  s_add_u32 m0, s42, 65536
  s_nop 0
  buffer_load_dwordx4 v10, s[16:19], s31 offen offset:0 lds
  buffer_load_dwordx4 v11, s[16:19], s31 offen offset:1024 lds
  buffer_load_dwordx4 v12, s[16:19], s31 offen offset:2048 lds
  buffer_load_dwordx4 v13, s[16:19], s31 offen offset:3072 lds
  s_add_u32 m0, s47, 1024
  s_nop 0
  buffer_load_dwordx4 v21, s[8:11], s46 offen lds
  s_add_u32 s46, s46, 16384
  s_waitcnt vmcnt(18)
  s_barrier
  s_cmp_gt_u32 s84, 14
  s_cselect_b32 s86, 14, 18
  s_mul_i32 s86, s86, 16384
  s_add_u32 s30, s80, s86
  s_add_u32 m0, s41, 98304
  s_nop 0
  buffer_load_dwordx4 v6, s[4:7], s30 offen offset:0 sc1 lds
  buffer_load_dwordx4 v6, s[4:7], s30 offen offset:1024 sc1 lds
  buffer_load_dwordx4 v7, s[4:7], s30 offen offset:2048 sc1 lds
  buffer_load_dwordx4 v7, s[4:7], s30 offen offset:3072 sc1 lds
  s_cmp_gt_u32 s84, 14
  s_cselect_b32 s86, 14, 18
  s_mul_i32 s86, s86, 131072
  s_add_u32 s31, s81, s86
  s_add_u32 m0, s42, 98304
  s_nop 0
  buffer_load_dwordx4 v10, s[16:19], s31 offen offset:0 lds
  buffer_load_dwordx4 v11, s[16:19], s31 offen offset:1024 lds
  buffer_load_dwordx4 v12, s[16:19], s31 offen offset:2048 lds
  buffer_load_dwordx4 v13, s[16:19], s31 offen offset:3072 lds
  s_waitcnt vmcnt(17)
  s_barrier
  s_cmp_gt_u32 s84, 15
  s_cselect_b32 s86, 15, 19
  s_mul_i32 s86, s86, 16384
  s_add_u32 s30, s80, s86
  s_add_u32 m0, s41, 0
  s_nop 0
  buffer_load_dwordx4 v6, s[4:7], s30 offen offset:0 sc1 lds
  buffer_load_dwordx4 v6, s[4:7], s30 offen offset:1024 sc1 lds
  buffer_load_dwordx4 v7, s[4:7], s30 offen offset:2048 sc1 lds
  buffer_load_dwordx4 v7, s[4:7], s30 offen offset:3072 sc1 lds
  s_cmp_gt_u32 s84, 15
  s_cselect_b32 s86, 15, 19
  s_mul_i32 s86, s86, 131072
  s_add_u32 s31, s81, s86
  s_add_u32 m0, s42, 0
  s_nop 0
  buffer_load_dwordx4 v10, s[16:19], s31 offen offset:0 lds
  buffer_load_dwordx4 v11, s[16:19], s31 offen offset:1024 lds
  buffer_load_dwordx4 v12, s[16:19], s31 offen offset:2048 lds
  buffer_load_dwordx4 v13, s[16:19], s31 offen offset:3072 lds
  s_add_u32 m0, s47, 2048
  s_nop 0
  buffer_load_dwordx4 v20, s[8:11], s46 offen lds
  s_add_u32 s46, s46, 16384
  s_waitcnt vmcnt(18)
  s_barrier
  s_cmp_gt_u32 s84, 18
  s_cselect_b32 s86, 18, 21
  s_mul_i32 s86, s86, 16384
  s_add_u32 s30, s80, s86
  s_add_u32 m0, s41, 32768
  s_nop 0
  buffer_load_dwordx4 v6, s[4:7], s30 offen offset:0 sc1 lds
  buffer_load_dwordx4 v6, s[4:7], s30 offen offset:1024 sc1 lds
  buffer_load_dwordx4 v7, s[4:7], s30 offen offset:2048 sc1 lds
  buffer_load_dwordx4 v7, s[4:7], s30 offen offset:3072 sc1 lds
  s_cmp_gt_u32 s84, 18
  s_cselect_b32 s86, 18, 21
  s_mul_i32 s86, s86, 131072
  s_add_u32 s31, s81, s86
  s_add_u32 m0, s42, 32768
  s_nop 0
  buffer_load_dwordx4 v10, s[16:19], s31 offen offset:0 lds
  buffer_load_dwordx4 v11, s[16:19], s31 offen offset:1024 lds
  buffer_load_dwordx4 v12, s[16:19], s31 offen offset:2048 lds
  buffer_load_dwordx4 v13, s[16:19], s31 offen offset:3072 lds
  s_waitcnt vmcnt(17)
  s_barrier
  s_cmp_gt_u32 s84, 19
  s_cselect_b32 s86, 19, 22
  s_mul_i32 s86, s86, 16384
  s_add_u32 s30, s80, s86
  s_add_u32 m0, s41, 65536
  s_nop 0
  buffer_load_dwordx4 v6, s[4:7], s30 offen offset:0 sc1 lds
  buffer_load_dwordx4 v6, s[4:7], s30 offen offset:1024 sc1 lds
  buffer_load_dwordx4 v7, s[4:7], s30 offen offset:2048 sc1 lds
  buffer_load_dwordx4 v7, s[4:7], s30 offen offset:3072 sc1 lds
  s_cmp_gt_u32 s84, 19
  s_cselect_b32 s86, 19, 22
  s_mul_i32 s86, s86, 131072
  s_add_u32 s31, s81, s86
  s_add_u32 m0, s42, 65536
  s_nop 0
  buffer_load_dwordx4 v10, s[16:19], s31 offen offset:0 lds
  buffer_load_dwordx4 v11, s[16:19], s31 offen offset:1024 lds
  buffer_load_dwordx4 v12, s[16:19], s31 offen offset:2048 lds
  buffer_load_dwordx4 v13, s[16:19], s31 offen offset:3072 lds
  s_add_u32 m0, s47, 3072
  s_nop 0
  buffer_load_dwordx4 v21, s[8:11], s46 offen lds
  s_add_u32 s46, s46, 16384
  s_waitcnt vmcnt(18)
  s_barrier
  s_cmp_gt_u32 s84, 21
  s_cselect_b32 s86, 21, 25
  s_mul_i32 s86, s86, 16384
  s_add_u32 s30, s80, s86
  s_add_u32 m0, s41, 98304
  s_nop 0
  buffer_load_dwordx4 v6, s[4:7], s30 offen offset:0 sc1 lds
  buffer_load_dwordx4 v6, s[4:7], s30 offen offset:1024 sc1 lds
  buffer_load_dwordx4 v7, s[4:7], s30 offen offset:2048 sc1 lds
  buffer_load_dwordx4 v7, s[4:7], s30 offen offset:3072 sc1 lds
  s_cmp_gt_u32 s84, 21
  s_cselect_b32 s86, 21, 25
  s_mul_i32 s86, s86, 131072
  s_add_u32 s31, s81, s86
  s_add_u32 m0, s42, 98304
  s_nop 0
  buffer_load_dwordx4 v10, s[16:19], s31 offen offset:0 lds
  buffer_load_dwordx4 v11, s[16:19], s31 offen offset:1024 lds
  buffer_load_dwordx4 v12, s[16:19], s31 offen offset:2048 lds
  buffer_load_dwordx4 v13, s[16:19], s31 offen offset:3072 lds
  s_waitcnt vmcnt(17)
  s_barrier
  buffer_load_dword v25, v24, s[4:7], s53 offen sc1
  s_cmp_gt_u32 s84, 22
  s_cselect_b32 s86, 22, 26
  s_mul_i32 s86, s86, 16384
  s_add_u32 s30, s80, s86
  s_add_u32 m0, s41, 0
  s_nop 0
  buffer_load_dwordx4 v6, s[4:7], s30 offen offset:0 sc1 lds
  buffer_load_dwordx4 v6, s[4:7], s30 offen offset:1024 sc1 lds
  buffer_load_dwordx4 v7, s[4:7], s30 offen offset:2048 sc1 lds
  buffer_load_dwordx4 v7, s[4:7], s30 offen offset:3072 sc1 lds
  s_cmp_gt_u32 s84, 22
  s_cselect_b32 s86, 22, 26
  s_mul_i32 s86, s86, 131072
  s_add_u32 s31, s81, s86
  s_add_u32 m0, s42, 0
  s_nop 0
  buffer_load_dwordx4 v10, s[16:19], s31 offen offset:0 lds
  buffer_load_dwordx4 v11, s[16:19], s31 offen offset:1024 lds
  buffer_load_dwordx4 v12, s[16:19], s31 offen offset:2048 lds
  buffer_load_dwordx4 v13, s[16:19], s31 offen offset:3072 lds
  s_add_u32 m0, s41, 147456
  s_nop 0
  buffer_load_dwordx4 v22, s[4:7], s50 offen sc1 lds
  s_add_u32 s50, s50, 1024
  s_waitcnt vmcnt(19)
  s_barrier
  s_waitcnt vmcnt(9)
k3_gate:
  v_cmp_ne_u32 vcc, 1, v25
  s_nop 4
  s_cbranch_vccz k3_gok
  s_sleep 4
  buffer_load_dword v25, v24, s[4:7], s53 offen sc1
  s_waitcnt vmcnt(0)
  s_add_u32 s101, s101, 1
  s_cmp_lt_u32 s101, 0x40000
  s_cbranch_scc1 k3_gate
k3_gok:
  s_cmp_gt_u32 s85, 2
  s_cselect_b32 s86, 2, 3
  s_mul_i32 s86, s86, 16384
  s_add_u32 s30, s80, s86
  s_add_u32 m0, s41, 32768
  s_nop 0
  buffer_load_dwordx4 v6, s[4:7], s30 offen offset:0 sc1 lds
  buffer_load_dwordx4 v6, s[4:7], s30 offen offset:1024 sc1 lds
  buffer_load_dwordx4 v7, s[4:7], s30 offen offset:2048 sc1 lds
  buffer_load_dwordx4 v7, s[4:7], s30 offen offset:3072 sc1 lds
  s_cmp_gt_u32 s85, 2
  s_cselect_b32 s86, 2, 3
  s_mul_i32 s86, s86, 131072
  s_add_u32 s31, s81, s86
  s_add_u32 m0, s42, 32768
  s_nop 0
  buffer_load_dwordx4 v10, s[16:19], s31 offen offset:0 lds
  buffer_load_dwordx4 v11, s[16:19], s31 offen offset:1024 lds
  buffer_load_dwordx4 v12, s[16:19], s31 offen offset:2048 lds
  buffer_load_dwordx4 v13, s[16:19], s31 offen offset:3072 lds
  s_barrier
  s_cmp_gt_u32 s85, 3
  s_cselect_b32 s86, 3, 6
  s_mul_i32 s86, s86, 16384
  s_add_u32 s30, s80, s86
  s_add_u32 m0, s41, 65536
  s_nop 0
  buffer_load_dwordx4 v6, s[4:7], s30 offen offset:0 sc1 lds
  buffer_load_dwordx4 v6, s[4:7], s30 offen offset:1024 sc1 lds
  buffer_load_dwordx4 v7, s[4:7], s30 offen offset:2048 sc1 lds
  buffer_load_dwordx4 v7, s[4:7], s30 offen offset:3072 sc1 lds
  s_cmp_gt_u32 s85, 3
  s_cselect_b32 s86, 3, 6
  s_mul_i32 s86, s86, 131072
  s_add_u32 s31, s81, s86
  s_add_u32 m0, s42, 65536
  s_nop 0
  buffer_load_dwordx4 v10, s[16:19], s31 offen offset:0 lds
  buffer_load_dwordx4 v11, s[16:19], s31 offen offset:1024 lds
  buffer_load_dwordx4 v12, s[16:19], s31 offen offset:2048 lds
  buffer_load_dwordx4 v13, s[16:19], s31 offen offset:3072 lds
  s_add_u32 m0, s41, 148480
  s_nop 0
  buffer_load_dwordx4 v22, s[4:7], s50 offen sc1 lds
  s_add_u32 s50, s50, 1024
  s_waitcnt vmcnt(18)
  s_barrier
  s_cmp_gt_u32 s85, 6
  s_cselect_b32 s86, 6, 9
  s_mul_i32 s86, s86, 16384
  s_add_u32 s30, s80, s86
  s_add_u32 m0, s41, 98304
  s_nop 0
  buffer_load_dwordx4 v6, s[4:7], s30 offen offset:0 sc1 lds
  buffer_load_dwordx4 v6, s[4:7], s30 offen offset:1024 sc1 lds
  buffer_load_dwordx4 v7, s[4:7], s30 offen offset:2048 sc1 lds
  buffer_load_dwordx4 v7, s[4:7], s30 offen offset:3072 sc1 lds
  s_cmp_gt_u32 s85, 6
  s_cselect_b32 s86, 6, 9
  s_mul_i32 s86, s86, 131072
  s_add_u32 s31, s81, s86
  s_add_u32 m0, s42, 98304
  s_nop 0
  buffer_load_dwordx4 v10, s[16:19], s31 offen offset:0 lds
  buffer_load_dwordx4 v11, s[16:19], s31 offen offset:1024 lds
  buffer_load_dwordx4 v12, s[16:19], s31 offen offset:2048 lds
  buffer_load_dwordx4 v13, s[16:19], s31 offen offset:3072 lds
  s_waitcnt vmcnt(17)
  s_barrier
  s_cmp_gt_u32 s85, 9
  s_cselect_b32 s86, 9, 10
  s_mul_i32 s86, s86, 16384
  s_add_u32 s30, s80, s86
  s_add_u32 m0, s41, 0
  s_nop 0
  buffer_load_dwordx4 v6, s[4:7], s30 offen offset:0 sc1 lds
  buffer_load_dwordx4 v6, s[4:7], s30 offen offset:1024 sc1 lds
  buffer_load_dwordx4 v7, s[4:7], s30 offen offset:2048 sc1 lds
  buffer_load_dwordx4 v7, s[4:7], s30 offen offset:3072 sc1 lds
  s_cmp_gt_u32 s85, 9
  s_cselect_b32 s86, 9, 10
  s_mul_i32 s86, s86, 131072
  s_add_u32 s31, s81, s86
  s_add_u32 m0, s42, 0
  s_nop 0
  buffer_load_dwordx4 v10, s[16:19], s31 offen offset:0 lds
  buffer_load_dwordx4 v11, s[16:19], s31 offen offset:1024 lds
  buffer_load_dwordx4 v12, s[16:19], s31 offen offset:2048 lds
  buffer_load_dwordx4 v13, s[16:19], s31 offen offset:3072 lds
  s_add_u32 m0, s41, 149504
  s_nop 0
  buffer_load_dwordx4 v22, s[4:7], s50 offen sc1 lds
  s_add_u32 s50, s50, 1024
  s_waitcnt vmcnt(18)
  s_barrier
  s_cmp_gt_u32 s85, 10
  s_cselect_b32 s86, 10, 13
  s_mul_i32 s86, s86, 16384
  s_add_u32 s30, s80, s86
  s_add_u32 m0, s41, 32768
  s_nop 0
  buffer_load_dwordx4 v6, s[4:7], s30 offen offset:0 sc1 lds
  buffer_load_dwordx4 v6, s[4:7], s30 offen offset:1024 sc1 lds
  buffer_load_dwordx4 v7, s[4:7], s30 offen offset:2048 sc1 lds
  buffer_load_dwordx4 v7, s[4:7], s30 offen offset:3072 sc1 lds
  s_cmp_gt_u32 s85, 10
  s_cselect_b32 s86, 10, 13
  s_mul_i32 s86, s86, 131072
  s_add_u32 s31, s81, s86
  s_add_u32 m0, s42, 32768
  s_nop 0
  buffer_load_dwordx4 v10, s[16:19], s31 offen offset:0 lds
  buffer_load_dwordx4 v11, s[16:19], s31 offen offset:1024 lds
  buffer_load_dwordx4 v12, s[16:19], s31 offen offset:2048 lds
  buffer_load_dwordx4 v13, s[16:19], s31 offen offset:3072 lds
  s_waitcnt vmcnt(17)
  s_barrier
  s_cmp_gt_u32 s85, 13
  s_cselect_b32 s86, 13, 16
  s_mul_i32 s86, s86, 16384
  s_add_u32 s30, s80, s86
  s_add_u32 m0, s41, 65536
  s_nop 0
  buffer_load_dwordx4 v6, s[4:7], s30 offen offset:0 sc1 lds
  buffer_load_dwordx4 v6, s[4:7], s30 offen offset:1024 sc1 lds
  buffer_load_dwordx4 v7, s[4:7], s30 offen offset:2048 sc1 lds
  buffer_load_dwordx4 v7, s[4:7], s30 offen offset:3072 sc1 lds
  s_cmp_gt_u32 s85, 13
  s_cselect_b32 s86, 13, 16
  s_mul_i32 s86, s86, 131072
  s_add_u32 s31, s81, s86
  s_add_u32 m0, s42, 65536
  s_nop 0
  buffer_load_dwordx4 v10, s[16:19], s31 offen offset:0 lds
  buffer_load_dwordx4 v11, s[16:19], s31 offen offset:1024 lds
  buffer_load_dwordx4 v12, s[16:19], s31 offen offset:2048 lds
  buffer_load_dwordx4 v13, s[16:19], s31 offen offset:3072 lds
  s_add_u32 m0, s41, 150528
  s_nop 0
  buffer_load_dwordx4 v22, s[4:7], s50 offen sc1 lds
  s_add_u32 s50, s50, 1024
  s_waitcnt vmcnt(18)
  s_barrier
  s_cmp_gt_u32 s85, 16
  s_cselect_b32 s86, 16, 17
  s_mul_i32 s86, s86, 16384
  s_add_u32 s30, s80, s86
  s_add_u32 m0, s41, 98304
  s_nop 0
  buffer_load_dwordx4 v6, s[4:7], s30 offen offset:0 sc1 lds
  buffer_load_dwordx4 v6, s[4:7], s30 offen offset:1024 sc1 lds
  buffer_load_dwordx4 v7, s[4:7], s30 offen offset:2048 sc1 lds
  buffer_load_dwordx4 v7, s[4:7], s30 offen offset:3072 sc1 lds
  s_cmp_gt_u32 s85, 16
  s_cselect_b32 s86, 16, 17
  s_mul_i32 s86, s86, 131072
  s_add_u32 s31, s81, s86
  s_add_u32 m0, s42, 98304
  s_nop 0
  buffer_load_dwordx4 v10, s[16:19], s31 offen offset:0 lds
  buffer_load_dwordx4 v11, s[16:19], s31 offen offset:1024 lds
  buffer_load_dwordx4 v12, s[16:19], s31 offen offset:2048 lds
  buffer_load_dwordx4 v13, s[16:19], s31 offen offset:3072 lds
  s_waitcnt vmcnt(17)
  s_barrier
  s_cmp_gt_u32 s85, 17
  s_cselect_b32 s86, 17, 20
  s_mul_i32 s86, s86, 16384
  s_add_u32 s30, s80, s86
  s_add_u32 m0, s41, 0
  s_nop 0
  buffer_load_dwordx4 v6, s[4:7], s30 offen offset:0 sc1 lds
  buffer_load_dwordx4 v6, s[4:7], s30 offen offset:1024 sc1 lds
  buffer_load_dwordx4 v7, s[4:7], s30 offen offset:2048 sc1 lds
  buffer_load_dwordx4 v7, s[4:7], s30 offen offset:3072 sc1 lds
  s_cmp_gt_u32 s85, 17
  s_cselect_b32 s86, 17, 20
  s_mul_i32 s86, s86, 131072
  s_add_u32 s31, s81, s86
  s_add_u32 m0, s42, 0
  s_nop 0
  buffer_load_dwordx4 v10, s[16:19], s31 offen offset:0 lds
  buffer_load_dwordx4 v11, s[16:19], s31 offen offset:1024 lds
  buffer_load_dwordx4 v12, s[16:19], s31 offen offset:2048 lds
  buffer_load_dwordx4 v13, s[16:19], s31 offen offset:3072 lds
  s_waitcnt vmcnt(17)
  s_barrier
  s_cmp_gt_u32 s85, 20
  s_cselect_b32 s86, 20, 23
  s_mul_i32 s86, s86, 16384
  s_add_u32 s30, s80, s86
  s_add_u32 m0, s41, 32768
  s_nop 0
  buffer_load_dwordx4 v6, s[4:7], s30 offen offset:0 sc1 lds
  buffer_load_dwordx4 v6, s[4:7], s30 offen offset:1024 sc1 lds
  buffer_load_dwordx4 v7, s[4:7], s30 offen offset:2048 sc1 lds
  buffer_load_dwordx4 v7, s[4:7], s30 offen offset:3072 sc1 lds
  s_cmp_gt_u32 s85, 20
  s_cselect_b32 s86, 20, 23
  s_mul_i32 s86, s86, 131072
  s_add_u32 s31, s81, s86
  s_add_u32 m0, s42, 32768
  s_nop 0
  buffer_load_dwordx4 v10, s[16:19], s31 offen offset:0 lds
  buffer_load_dwordx4 v11, s[16:19], s31 offen offset:1024 lds
  buffer_load_dwordx4 v12, s[16:19], s31 offen offset:2048 lds
  buffer_load_dwordx4 v13, s[16:19], s31 offen offset:3072 lds
  s_waitcnt vmcnt(16)
  s_barrier
  s_cmp_gt_u32 s85, 23
  s_cselect_b32 s86, 23, 24
  s_mul_i32 s86, s86, 16384
  s_add_u32 s30, s80, s86
  s_add_u32 m0, s41, 65536
  s_nop 0
  buffer_load_dwordx4 v6, s[4:7], s30 offen offset:0 sc1 lds
  buffer_load_dwordx4 v6, s[4:7], s30 offen offset:1024 sc1 lds
  buffer_load_dwordx4 v7, s[4:7], s30 offen offset:2048 sc1 lds
  buffer_load_dwordx4 v7, s[4:7], s30 offen offset:3072 sc1 lds
  s_cmp_gt_u32 s85, 23
  s_cselect_b32 s86, 23, 24
  s_mul_i32 s86, s86, 131072
  s_add_u32 s31, s81, s86
  s_add_u32 m0, s42, 65536
  s_nop 0
  buffer_load_dwordx4 v10, s[16:19], s31 offen offset:0 lds
  buffer_load_dwordx4 v11, s[16:19], s31 offen offset:1024 lds
  buffer_load_dwordx4 v12, s[16:19], s31 offen offset:2048 lds
  buffer_load_dwordx4 v13, s[16:19], s31 offen offset:3072 lds
  s_waitcnt vmcnt(16)
  s_barrier
  s_cmp_gt_u32 s85, 24
  s_cselect_b32 s86, 24, 27
  s_mul_i32 s86, s86, 16384
  s_add_u32 s30, s80, s86
  s_add_u32 m0, s41, 98304
  s_nop 0
  buffer_load_dwordx4 v6, s[4:7], s30 offen offset:0 sc1 lds
  buffer_load_dwordx4 v6, s[4:7], s30 offen offset:1024 sc1 lds
  buffer_load_dwordx4 v7, s[4:7], s30 offen offset:2048 sc1 lds
  buffer_load_dwordx4 v7, s[4:7], s30 offen offset:3072 sc1 lds
  s_cmp_gt_u32 s85, 24
  s_cselect_b32 s86, 24, 27
  s_mul_i32 s86, s86, 131072
  s_add_u32 s31, s81, s86
  s_add_u32 m0, s42, 98304
  s_nop 0
  buffer_load_dwordx4 v10, s[16:19], s31 offen offset:0 lds
  buffer_load_dwordx4 v11, s[16:19], s31 offen offset:1024 lds
  buffer_load_dwordx4 v12, s[16:19], s31 offen offset:2048 lds
  buffer_load_dwordx4 v13, s[16:19], s31 offen offset:3072 lds
  s_waitcnt vmcnt(16)
  s_barrier
  s_waitcnt vmcnt(8)
  s_barrier
  s_waitcnt vmcnt(0)
  s_barrier
  s_endpgm
k1_compute:
  s_lshr_b32 s40, s33, 1
  s_and_b32 s41, s33, 1
  v_and_b32 v2, 15, v1
  v_lshrrev_b32 v3, 4, v1
  v_and_b32 v4, 7, v1
  v_xor_b32 v4, v4, v3
  v_lshlrev_b32 v4, 4, v4
  v_lshl_add_u32 v4, v2, 7, v4
  s_lshl_b32 s36, s40, 13
  v_add_u32 v6, s36, v4
  v_xor_b32 v7, 64, v6
  v_bfe_u32 v2, v1, 2, 2
  v_lshl_add_u32 v2, v3, 3, v2
  v_and_b32 v4, 3, v2
  v_bfe_u32 v5, v2, 3, 1
  v_lshl_or_b32 v4, v5, 2, v4
  v_mul_u32_u24 v2, 256, v2
  v_and_b32 v3, 3, v1
  v_lshl_add_u32 v2, v3, 3, v2
  v_add_u32 v2, 16384, v2
  s_mul_i32 s36, s41, 4
  s_lshl_b32 s37, s41, 1
  s_add_u32 s37, s37, 0
  v_xor_b32 v3, s37, v4
  v_lshl_add_u32 v10, v3, 5, v2
  s_lshl_b32 s37, s41, 1
  s_add_u32 s37, s37, 1
  v_xor_b32 v3, s37, v4
  v_lshl_add_u32 v11, v3, 5, v2
  s_lshl_b32 s37, s41, 1
  s_add_u32 s37, s37, 4
  v_xor_b32 v3, s37, v4
  v_lshl_add_u32 v12, v3, 5, v2
  s_lshl_b32 s37, s41, 1
  s_add_u32 s37, s37, 5
  v_xor_b32 v3, s37, v4
  v_lshl_add_u32 v13, v3, 5, v2
  v_add_u32 v8, 65536, v6
  v_add_u32 v9, 65536, v7
  v_add_u32 v14, 65536, v10
  v_add_u32 v15, 65536, v11
  v_add_u32 v16, 65536, v12
  v_add_u32 v17, 65536, v13
  v_mov_b32 v32, 0
  v_mov_b32 v33, 0
  v_mov_b32 v34, 0
  v_mov_b32 v35, 0
  v_mov_b32 v36, 0
  v_mov_b32 v37, 0
  v_mov_b32 v38, 0
  v_mov_b32 v39, 0
  v_mov_b32 v40, 0
  v_mov_b32 v41, 0
  v_mov_b32 v42, 0
  v_mov_b32 v43, 0
  v_mov_b32 v44, 0
  v_mov_b32 v45, 0
  v_mov_b32 v46, 0
  v_mov_b32 v47, 0
  v_mov_b32 v48, 0
  v_mov_b32 v49, 0
  v_mov_b32 v50, 0
  v_mov_b32 v51, 0
  v_mov_b32 v52, 0
  v_mov_b32 v53, 0
  v_mov_b32 v54, 0
  v_mov_b32 v55, 0
  v_mov_b32 v56, 0
  v_mov_b32 v57, 0
  v_mov_b32 v58, 0
  v_mov_b32 v59, 0
  v_mov_b32 v60, 0
  v_mov_b32 v61, 0
  v_mov_b32 v62, 0
  v_mov_b32 v63, 0
  v_mov_b32 v64, 0
  v_mov_b32 v65, 0
  v_mov_b32 v66, 0
  v_mov_b32 v67, 0
  v_mov_b32 v68, 0
  v_mov_b32 v69, 0
  v_mov_b32 v70, 0
  v_mov_b32 v71, 0
  v_mov_b32 v72, 0
  v_mov_b32 v73, 0
  v_mov_b32 v74, 0
  v_mov_b32 v75, 0
  v_mov_b32 v76, 0
  v_mov_b32 v77, 0
  v_mov_b32 v78, 0
  v_mov_b32 v79, 0
  v_mov_b32 v80, 0
  v_mov_b32 v81, 0
  v_mov_b32 v82, 0
  v_mov_b32 v83, 0
  v_mov_b32 v84, 0
  v_mov_b32 v85, 0
  v_mov_b32 v86, 0
  v_mov_b32 v87, 0
  v_mov_b32 v88, 0
  v_mov_b32 v89, 0
  v_mov_b32 v90, 0
  v_mov_b32 v91, 0
  v_mov_b32 v92, 0
  v_mov_b32 v93, 0
  v_mov_b32 v94, 0
  v_mov_b32 v95, 0
  v_and_b32 v2, 15, v1
  v_lshrrev_b32 v3, 4, v1
  v_and_b32 v4, 1, v3
  v_lshrrev_b32 v3, 1, v3
  v_lshl_or_b32 v3, v4, 1, v3
  v_lshlrev_b32 v3, 11, v3
  v_lshl_add_u32 v28, v2, 4, v3
  v_add_u32 v29, 16384, v28
  s_lshl_b32 s36, s41, 13
  s_lshl_b32 s37, s40, 10
  s_add_u32 s36, s36, s37
  v_add_u32 v30, s36, v28
  s_lshl_b32 s38, s35, 15
  s_add_u32 s38, s38, s36
  s_mul_i32 s36, s34, 262144
  s_add_u32 s38, s38, s36
  v_mov_b32 v18, 1
  v_mov_b32 v19, 0
  s_lshl_b32 s50, s34, 3
  s_add_u32 s50, s50, s35
  s_lshl_b32 s50, s50, 5
  s_add_u32 s50, s50, s33
  s_lshl_b32 s50, s50, 2
  s_add_u32 s50, s50, 39976960
  s_waitcnt lgkmcnt(0)
  s_barrier
  ds_read_b64_tr_b16 a[16:17], v10 offset:0
  ds_read_b64_tr_b16 a[18:19], v10 offset:1024
  ds_read_b128 a[0:3], v6 offset:0
  ds_read_b128 a[4:7], v6 offset:2048
  ds_read_b128 a[8:11], v6 offset:4096
  ds_read_b128 a[12:15], v6 offset:6144
  ds_read_b64_tr_b16 a[20:21], v11 offset:0
  ds_read_b64_tr_b16 a[22:23], v11 offset:1024
  ds_read_b64_tr_b16 a[24:25], v12 offset:0
  ds_read_b64_tr_b16 a[26:27], v12 offset:1024
  ds_read_b64_tr_b16 a[28:29], v13 offset:0
  ds_read_b64_tr_b16 a[30:31], v13 offset:1024
  s_mov_b32 s32, 3
  .p2align 3
recurrent_scan__ssm_conv_h3__mixer_s_mlp__prompt_kernel_cm3:
  s_waitcnt lgkmcnt(9)
  v_mfma_f32_16x16x32_bf16 v[32:35], a[16:19], a[0:3], v[32:35]
  ds_read_b64_tr_b16 a[48:49], v10 offset:8192
  s_waitcnt lgkmcnt(9)
  v_mfma_f32_16x16x32_bf16 v[48:51], a[16:19], a[4:7], v[48:51]
  ds_read_b64_tr_b16 a[50:51], v10 offset:9216
  s_waitcnt lgkmcnt(9)
  v_mfma_f32_16x16x32_bf16 v[64:67], a[16:19], a[8:11], v[64:67]
  ds_read_b128 a[32:35], v7 offset:0
  s_waitcnt lgkmcnt(9)
  v_mfma_f32_16x16x32_bf16 v[80:83], a[16:19], a[12:15], v[80:83]
  ds_read_b128 a[36:39], v7 offset:2048
  s_waitcnt lgkmcnt(8)
  v_mfma_f32_16x16x32_bf16 v[36:39], a[20:23], a[0:3], v[36:39]
  ds_read_b128 a[40:43], v7 offset:4096
  v_mfma_f32_16x16x32_bf16 v[52:55], a[20:23], a[4:7], v[52:55]
  ds_read_b128 a[44:47], v7 offset:6144
  v_mfma_f32_16x16x32_bf16 v[68:71], a[20:23], a[8:11], v[68:71]
  ds_read_b64_tr_b16 a[52:53], v11 offset:8192
  v_mfma_f32_16x16x32_bf16 v[84:87], a[20:23], a[12:15], v[84:87]
  ds_read_b64_tr_b16 a[54:55], v11 offset:9216
  s_waitcnt lgkmcnt(10)
  v_mfma_f32_16x16x32_bf16 v[40:43], a[24:27], a[0:3], v[40:43]
  ds_read_b64_tr_b16 a[56:57], v12 offset:8192
  v_mfma_f32_16x16x32_bf16 v[56:59], a[24:27], a[4:7], v[56:59]
  ds_read_b64_tr_b16 a[58:59], v12 offset:9216
  v_mfma_f32_16x16x32_bf16 v[72:75], a[24:27], a[8:11], v[72:75]
  ds_read_b64_tr_b16 a[60:61], v13 offset:8192
  v_mfma_f32_16x16x32_bf16 v[88:91], a[24:27], a[12:15], v[88:91]
  ds_read_b64_tr_b16 a[62:63], v13 offset:9216
  s_waitcnt lgkmcnt(12)
  v_mfma_f32_16x16x32_bf16 v[44:47], a[28:31], a[0:3], v[44:47]
  v_mfma_f32_16x16x32_bf16 v[60:63], a[28:31], a[4:7], v[60:63]
  v_mfma_f32_16x16x32_bf16 v[76:79], a[28:31], a[8:11], v[76:79]
  v_mfma_f32_16x16x32_bf16 v[92:95], a[28:31], a[12:15], v[92:95]
  s_waitcnt lgkmcnt(9)
  v_mfma_f32_16x16x32_bf16 v[32:35], a[48:51], a[32:35], v[32:35]
  s_waitcnt lgkmcnt(8)
  v_mfma_f32_16x16x32_bf16 v[48:51], a[48:51], a[36:39], v[48:51]
  s_waitcnt lgkmcnt(7)
  v_mfma_f32_16x16x32_bf16 v[64:67], a[48:51], a[40:43], v[64:67]
  s_waitcnt lgkmcnt(6)
  v_mfma_f32_16x16x32_bf16 v[80:83], a[48:51], a[44:47], v[80:83]
  s_waitcnt lgkmcnt(0)
  s_barrier
  ds_read_b64_tr_b16 a[16:17], v10 offset:32768
  v_mfma_f32_16x16x32_bf16 v[36:39], a[52:55], a[32:35], v[36:39]
  ds_read_b64_tr_b16 a[18:19], v10 offset:33792
  v_mfma_f32_16x16x32_bf16 v[52:55], a[52:55], a[36:39], v[52:55]
  ds_read_b128 a[0:3], v6 offset:32768
  v_mfma_f32_16x16x32_bf16 v[68:71], a[52:55], a[40:43], v[68:71]
  ds_read_b128 a[4:7], v6 offset:34816
  v_mfma_f32_16x16x32_bf16 v[84:87], a[52:55], a[44:47], v[84:87]
  ds_read_b128 a[8:11], v6 offset:36864
  v_mfma_f32_16x16x32_bf16 v[40:43], a[56:59], a[32:35], v[40:43]
  ds_read_b128 a[12:15], v6 offset:38912
  v_mfma_f32_16x16x32_bf16 v[56:59], a[56:59], a[36:39], v[56:59]
  ds_read_b64_tr_b16 a[20:21], v11 offset:32768
  v_mfma_f32_16x16x32_bf16 v[72:75], a[56:59], a[40:43], v[72:75]
  ds_read_b64_tr_b16 a[22:23], v11 offset:33792
  v_mfma_f32_16x16x32_bf16 v[88:91], a[56:59], a[44:47], v[88:91]
  ds_read_b64_tr_b16 a[24:25], v12 offset:32768
  v_mfma_f32_16x16x32_bf16 v[44:47], a[60:63], a[32:35], v[44:47]
  ds_read_b64_tr_b16 a[26:27], v12 offset:33792
  v_mfma_f32_16x16x32_bf16 v[60:63], a[60:63], a[36:39], v[60:63]
  ds_read_b64_tr_b16 a[28:29], v13 offset:32768
  v_mfma_f32_16x16x32_bf16 v[76:79], a[60:63], a[40:43], v[76:79]
  ds_read_b64_tr_b16 a[30:31], v13 offset:33792
  v_mfma_f32_16x16x32_bf16 v[92:95], a[60:63], a[44:47], v[92:95]
  s_waitcnt lgkmcnt(9)
  v_mfma_f32_16x16x32_bf16 v[32:35], a[16:19], a[0:3], v[32:35]
  ds_read_b64_tr_b16 a[48:49], v10 offset:40960
  s_waitcnt lgkmcnt(9)
  v_mfma_f32_16x16x32_bf16 v[48:51], a[16:19], a[4:7], v[48:51]
  ds_read_b64_tr_b16 a[50:51], v10 offset:41984
  s_waitcnt lgkmcnt(9)
  v_mfma_f32_16x16x32_bf16 v[64:67], a[16:19], a[8:11], v[64:67]
  ds_read_b128 a[32:35], v7 offset:32768
  s_waitcnt lgkmcnt(9)
  v_mfma_f32_16x16x32_bf16 v[80:83], a[16:19], a[12:15], v[80:83]
  ds_read_b128 a[36:39], v7 offset:34816
  s_waitcnt lgkmcnt(8)
  v_mfma_f32_16x16x32_bf16 v[36:39], a[20:23], a[0:3], v[36:39]
  ds_read_b128 a[40:43], v7 offset:36864
  v_mfma_f32_16x16x32_bf16 v[52:55], a[20:23], a[4:7], v[52:55]
  ds_read_b128 a[44:47], v7 offset:38912
  v_mfma_f32_16x16x32_bf16 v[68:71], a[20:23], a[8:11], v[68:71]
  ds_read_b64_tr_b16 a[52:53], v11 offset:40960
  v_mfma_f32_16x16x32_bf16 v[84:87], a[20:23], a[12:15], v[84:87]
  ds_read_b64_tr_b16 a[54:55], v11 offset:41984
  s_waitcnt lgkmcnt(10)
  v_mfma_f32_16x16x32_bf16 v[40:43], a[24:27], a[0:3], v[40:43]
  ds_read_b64_tr_b16 a[56:57], v12 offset:40960
  v_mfma_f32_16x16x32_bf16 v[56:59], a[24:27], a[4:7], v[56:59]
  ds_read_b64_tr_b16 a[58:59], v12 offset:41984
  v_mfma_f32_16x16x32_bf16 v[72:75], a[24:27], a[8:11], v[72:75]
  ds_read_b64_tr_b16 a[60:61], v13 offset:40960
  v_mfma_f32_16x16x32_bf16 v[88:91], a[24:27], a[12:15], v[88:91]
  ds_read_b64_tr_b16 a[62:63], v13 offset:41984
  s_waitcnt lgkmcnt(12)
  v_mfma_f32_16x16x32_bf16 v[44:47], a[28:31], a[0:3], v[44:47]
  v_mfma_f32_16x16x32_bf16 v[60:63], a[28:31], a[4:7], v[60:63]
  v_mfma_f32_16x16x32_bf16 v[76:79], a[28:31], a[8:11], v[76:79]
  v_mfma_f32_16x16x32_bf16 v[92:95], a[28:31], a[12:15], v[92:95]
  s_waitcnt lgkmcnt(9)
  v_mfma_f32_16x16x32_bf16 v[32:35], a[48:51], a[32:35], v[32:35]
  s_waitcnt lgkmcnt(8)
  v_mfma_f32_16x16x32_bf16 v[48:51], a[48:51], a[36:39], v[48:51]
  s_waitcnt lgkmcnt(7)
  v_mfma_f32_16x16x32_bf16 v[64:67], a[48:51], a[40:43], v[64:67]
  s_waitcnt lgkmcnt(6)
  v_mfma_f32_16x16x32_bf16 v[80:83], a[48:51], a[44:47], v[80:83]
  s_waitcnt lgkmcnt(0)
  s_barrier
  ds_read_b64_tr_b16 a[16:17], v14 offset:0
  v_mfma_f32_16x16x32_bf16 v[36:39], a[52:55], a[32:35], v[36:39]
  ds_read_b64_tr_b16 a[18:19], v14 offset:1024
  v_mfma_f32_16x16x32_bf16 v[52:55], a[52:55], a[36:39], v[52:55]
  ds_read_b128 a[0:3], v8 offset:0
  v_mfma_f32_16x16x32_bf16 v[68:71], a[52:55], a[40:43], v[68:71]
  ds_read_b128 a[4:7], v8 offset:2048
  v_mfma_f32_16x16x32_bf16 v[84:87], a[52:55], a[44:47], v[84:87]
  ds_read_b128 a[8:11], v8 offset:4096
  v_mfma_f32_16x16x32_bf16 v[40:43], a[56:59], a[32:35], v[40:43]
  ds_read_b128 a[12:15], v8 offset:6144
  v_mfma_f32_16x16x32_bf16 v[56:59], a[56:59], a[36:39], v[56:59]
  ds_read_b64_tr_b16 a[20:21], v15 offset:0
  v_mfma_f32_16x16x32_bf16 v[72:75], a[56:59], a[40:43], v[72:75]
  ds_read_b64_tr_b16 a[22:23], v15 offset:1024
  v_mfma_f32_16x16x32_bf16 v[88:91], a[56:59], a[44:47], v[88:91]
  ds_read_b64_tr_b16 a[24:25], v16 offset:0
  v_mfma_f32_16x16x32_bf16 v[44:47], a[60:63], a[32:35], v[44:47]
  ds_read_b64_tr_b16 a[26:27], v16 offset:1024
  v_mfma_f32_16x16x32_bf16 v[60:63], a[60:63], a[36:39], v[60:63]
  ds_read_b64_tr_b16 a[28:29], v17 offset:0
  v_mfma_f32_16x16x32_bf16 v[76:79], a[60:63], a[40:43], v[76:79]
  ds_read_b64_tr_b16 a[30:31], v17 offset:1024
  v_mfma_f32_16x16x32_bf16 v[92:95], a[60:63], a[44:47], v[92:95]
  s_waitcnt lgkmcnt(9)
  v_mfma_f32_16x16x32_bf16 v[32:35], a[16:19], a[0:3], v[32:35]
  ds_read_b64_tr_b16 a[48:49], v14 offset:8192
  s_waitcnt lgkmcnt(9)
  v_mfma_f32_16x16x32_bf16 v[48:51], a[16:19], a[4:7], v[48:51]
  ds_read_b64_tr_b16 a[50:51], v14 offset:9216
  s_waitcnt lgkmcnt(9)
  v_mfma_f32_16x16x32_bf16 v[64:67], a[16:19], a[8:11], v[64:67]
  ds_read_b128 a[32:35], v9 offset:0
  s_waitcnt lgkmcnt(9)
  v_mfma_f32_16x16x32_bf16 v[80:83], a[16:19], a[12:15], v[80:83]
  ds_read_b128 a[36:39], v9 offset:2048
  s_waitcnt lgkmcnt(8)
  v_mfma_f32_16x16x32_bf16 v[36:39], a[20:23], a[0:3], v[36:39]
  ds_read_b128 a[40:43], v9 offset:4096
  v_mfma_f32_16x16x32_bf16 v[52:55], a[20:23], a[4:7], v[52:55]
  ds_read_b128 a[44:47], v9 offset:6144
  v_mfma_f32_16x16x32_bf16 v[68:71], a[20:23], a[8:11], v[68:71]
  ds_read_b64_tr_b16 a[52:53], v15 offset:8192
  v_mfma_f32_16x16x32_bf16 v[84:87], a[20:23], a[12:15], v[84:87]
  ds_read_b64_tr_b16 a[54:55], v15 offset:9216
  s_waitcnt lgkmcnt(10)
  v_mfma_f32_16x16x32_bf16 v[40:43], a[24:27], a[0:3], v[40:43]
  ds_read_b64_tr_b16 a[56:57], v16 offset:8192
  v_mfma_f32_16x16x32_bf16 v[56:59], a[24:27], a[4:7], v[56:59]
  ds_read_b64_tr_b16 a[58:59], v16 offset:9216
  v_mfma_f32_16x16x32_bf16 v[72:75], a[24:27], a[8:11], v[72:75]
  ds_read_b64_tr_b16 a[60:61], v17 offset:8192
  v_mfma_f32_16x16x32_bf16 v[88:91], a[24:27], a[12:15], v[88:91]
  ds_read_b64_tr_b16 a[62:63], v17 offset:9216
  s_waitcnt lgkmcnt(12)
  v_mfma_f32_16x16x32_bf16 v[44:47], a[28:31], a[0:3], v[44:47]
  v_mfma_f32_16x16x32_bf16 v[60:63], a[28:31], a[4:7], v[60:63]
  v_mfma_f32_16x16x32_bf16 v[76:79], a[28:31], a[8:11], v[76:79]
  v_mfma_f32_16x16x32_bf16 v[92:95], a[28:31], a[12:15], v[92:95]
  s_waitcnt lgkmcnt(9)
  v_mfma_f32_16x16x32_bf16 v[32:35], a[48:51], a[32:35], v[32:35]
  s_waitcnt lgkmcnt(8)
  v_mfma_f32_16x16x32_bf16 v[48:51], a[48:51], a[36:39], v[48:51]
  s_waitcnt lgkmcnt(7)
  v_mfma_f32_16x16x32_bf16 v[64:67], a[48:51], a[40:43], v[64:67]
  s_waitcnt lgkmcnt(6)
  v_mfma_f32_16x16x32_bf16 v[80:83], a[48:51], a[44:47], v[80:83]
  s_waitcnt lgkmcnt(0)
  s_barrier
  ds_read_b64_tr_b16 a[16:17], v14 offset:32768
  v_mfma_f32_16x16x32_bf16 v[36:39], a[52:55], a[32:35], v[36:39]
  ds_read_b64_tr_b16 a[18:19], v14 offset:33792
  v_mfma_f32_16x16x32_bf16 v[52:55], a[52:55], a[36:39], v[52:55]
  ds_read_b128 a[0:3], v8 offset:32768
  v_mfma_f32_16x16x32_bf16 v[68:71], a[52:55], a[40:43], v[68:71]
  ds_read_b128 a[4:7], v8 offset:34816
  v_mfma_f32_16x16x32_bf16 v[84:87], a[52:55], a[44:47], v[84:87]
  ds_read_b128 a[8:11], v8 offset:36864
  v_mfma_f32_16x16x32_bf16 v[40:43], a[56:59], a[32:35], v[40:43]
  ds_read_b128 a[12:15], v8 offset:38912
  v_mfma_f32_16x16x32_bf16 v[56:59], a[56:59], a[36:39], v[56:59]
  ds_read_b64_tr_b16 a[20:21], v15 offset:32768
  v_mfma_f32_16x16x32_bf16 v[72:75], a[56:59], a[40:43], v[72:75]
  ds_read_b64_tr_b16 a[22:23], v15 offset:33792
  v_mfma_f32_16x16x32_bf16 v[88:91], a[56:59], a[44:47], v[88:91]
  ds_read_b64_tr_b16 a[24:25], v16 offset:32768
  v_mfma_f32_16x16x32_bf16 v[44:47], a[60:63], a[32:35], v[44:47]
  ds_read_b64_tr_b16 a[26:27], v16 offset:33792
  v_mfma_f32_16x16x32_bf16 v[60:63], a[60:63], a[36:39], v[60:63]
  ds_read_b64_tr_b16 a[28:29], v17 offset:32768
  v_mfma_f32_16x16x32_bf16 v[76:79], a[60:63], a[40:43], v[76:79]
  ds_read_b64_tr_b16 a[30:31], v17 offset:33792
  v_mfma_f32_16x16x32_bf16 v[92:95], a[60:63], a[44:47], v[92:95]
  s_waitcnt lgkmcnt(9)
  v_mfma_f32_16x16x32_bf16 v[32:35], a[16:19], a[0:3], v[32:35]
  ds_read_b64_tr_b16 a[48:49], v14 offset:40960
  s_waitcnt lgkmcnt(9)
  v_mfma_f32_16x16x32_bf16 v[48:51], a[16:19], a[4:7], v[48:51]
  ds_read_b64_tr_b16 a[50:51], v14 offset:41984
  s_waitcnt lgkmcnt(9)
  v_mfma_f32_16x16x32_bf16 v[64:67], a[16:19], a[8:11], v[64:67]
  ds_read_b128 a[32:35], v9 offset:32768
  s_waitcnt lgkmcnt(9)
  v_mfma_f32_16x16x32_bf16 v[80:83], a[16:19], a[12:15], v[80:83]
  ds_read_b128 a[36:39], v9 offset:34816
  s_waitcnt lgkmcnt(8)
  v_mfma_f32_16x16x32_bf16 v[36:39], a[20:23], a[0:3], v[36:39]
  ds_read_b128 a[40:43], v9 offset:36864
  v_mfma_f32_16x16x32_bf16 v[52:55], a[20:23], a[4:7], v[52:55]
  ds_read_b128 a[44:47], v9 offset:38912
  v_mfma_f32_16x16x32_bf16 v[68:71], a[20:23], a[8:11], v[68:71]
  ds_read_b64_tr_b16 a[52:53], v15 offset:40960
  v_mfma_f32_16x16x32_bf16 v[84:87], a[20:23], a[12:15], v[84:87]
  ds_read_b64_tr_b16 a[54:55], v15 offset:41984
  s_waitcnt lgkmcnt(10)
  v_mfma_f32_16x16x32_bf16 v[40:43], a[24:27], a[0:3], v[40:43]
  ds_read_b64_tr_b16 a[56:57], v16 offset:40960
  v_mfma_f32_16x16x32_bf16 v[56:59], a[24:27], a[4:7], v[56:59]
  ds_read_b64_tr_b16 a[58:59], v16 offset:41984
  v_mfma_f32_16x16x32_bf16 v[72:75], a[24:27], a[8:11], v[72:75]
  ds_read_b64_tr_b16 a[60:61], v17 offset:40960
  v_mfma_f32_16x16x32_bf16 v[88:91], a[24:27], a[12:15], v[88:91]
  ds_read_b64_tr_b16 a[62:63], v17 offset:41984
  s_waitcnt lgkmcnt(12)
  v_mfma_f32_16x16x32_bf16 v[44:47], a[28:31], a[0:3], v[44:47]
  v_mfma_f32_16x16x32_bf16 v[60:63], a[28:31], a[4:7], v[60:63]
  v_mfma_f32_16x16x32_bf16 v[76:79], a[28:31], a[8:11], v[76:79]
  v_mfma_f32_16x16x32_bf16 v[92:95], a[28:31], a[12:15], v[92:95]
  s_waitcnt lgkmcnt(9)
  v_mfma_f32_16x16x32_bf16 v[32:35], a[48:51], a[32:35], v[32:35]
  s_waitcnt lgkmcnt(8)
  v_mfma_f32_16x16x32_bf16 v[48:51], a[48:51], a[36:39], v[48:51]
  s_waitcnt lgkmcnt(7)
  v_mfma_f32_16x16x32_bf16 v[64:67], a[48:51], a[40:43], v[64:67]
  s_waitcnt lgkmcnt(6)
  v_mfma_f32_16x16x32_bf16 v[80:83], a[48:51], a[44:47], v[80:83]
  s_waitcnt lgkmcnt(0)
  s_barrier
  ds_read_b64_tr_b16 a[16:17], v10 offset:0
  v_mfma_f32_16x16x32_bf16 v[36:39], a[52:55], a[32:35], v[36:39]
  ds_read_b64_tr_b16 a[18:19], v10 offset:1024
  v_mfma_f32_16x16x32_bf16 v[52:55], a[52:55], a[36:39], v[52:55]
  ds_read_b128 a[0:3], v6 offset:0
  v_mfma_f32_16x16x32_bf16 v[68:71], a[52:55], a[40:43], v[68:71]
  ds_read_b128 a[4:7], v6 offset:2048
  v_mfma_f32_16x16x32_bf16 v[84:87], a[52:55], a[44:47], v[84:87]
  ds_read_b128 a[8:11], v6 offset:4096
  v_mfma_f32_16x16x32_bf16 v[40:43], a[56:59], a[32:35], v[40:43]
  ds_read_b128 a[12:15], v6 offset:6144
  v_mfma_f32_16x16x32_bf16 v[56:59], a[56:59], a[36:39], v[56:59]
  ds_read_b64_tr_b16 a[20:21], v11 offset:0
  v_mfma_f32_16x16x32_bf16 v[72:75], a[56:59], a[40:43], v[72:75]
  ds_read_b64_tr_b16 a[22:23], v11 offset:1024
  v_mfma_f32_16x16x32_bf16 v[88:91], a[56:59], a[44:47], v[88:91]
  ds_read_b64_tr_b16 a[24:25], v12 offset:0
  v_mfma_f32_16x16x32_bf16 v[44:47], a[60:63], a[32:35], v[44:47]
  ds_read_b64_tr_b16 a[26:27], v12 offset:1024
  v_mfma_f32_16x16x32_bf16 v[60:63], a[60:63], a[36:39], v[60:63]
  ds_read_b64_tr_b16 a[28:29], v13 offset:0
  v_mfma_f32_16x16x32_bf16 v[76:79], a[60:63], a[40:43], v[76:79]
  ds_read_b64_tr_b16 a[30:31], v13 offset:1024
  v_mfma_f32_16x16x32_bf16 v[92:95], a[60:63], a[44:47], v[92:95]
  s_sub_u32 s32, s32, 1
  s_cmp_lg_u32 s32, 0
  s_cbranch_scc1 recurrent_scan__ssm_conv_h3__mixer_s_mlp__prompt_kernel_cm3
  s_waitcnt lgkmcnt(9)
  v_mfma_f32_16x16x32_bf16 v[32:35], a[16:19], a[0:3], v[32:35]
  ds_read_b64_tr_b16 a[48:49], v10 offset:8192
  s_waitcnt lgkmcnt(9)
  v_mfma_f32_16x16x32_bf16 v[48:51], a[16:19], a[4:7], v[48:51]
  ds_read_b64_tr_b16 a[50:51], v10 offset:9216
  s_waitcnt lgkmcnt(9)
  v_mfma_f32_16x16x32_bf16 v[64:67], a[16:19], a[8:11], v[64:67]
  ds_read_b128 a[32:35], v7 offset:0
  s_waitcnt lgkmcnt(9)
  v_mfma_f32_16x16x32_bf16 v[80:83], a[16:19], a[12:15], v[80:83]
  ds_read_b128 a[36:39], v7 offset:2048
  s_waitcnt lgkmcnt(8)
  v_mfma_f32_16x16x32_bf16 v[36:39], a[20:23], a[0:3], v[36:39]
  ds_read_b128 a[40:43], v7 offset:4096
  v_mfma_f32_16x16x32_bf16 v[52:55], a[20:23], a[4:7], v[52:55]
  ds_read_b128 a[44:47], v7 offset:6144
  v_mfma_f32_16x16x32_bf16 v[68:71], a[20:23], a[8:11], v[68:71]
  ds_read_b64_tr_b16 a[52:53], v11 offset:8192
  v_mfma_f32_16x16x32_bf16 v[84:87], a[20:23], a[12:15], v[84:87]
  ds_read_b64_tr_b16 a[54:55], v11 offset:9216
  s_waitcnt lgkmcnt(10)
  v_mfma_f32_16x16x32_bf16 v[40:43], a[24:27], a[0:3], v[40:43]
  ds_read_b64_tr_b16 a[56:57], v12 offset:8192
  v_mfma_f32_16x16x32_bf16 v[56:59], a[24:27], a[4:7], v[56:59]
  ds_read_b64_tr_b16 a[58:59], v12 offset:9216
  v_mfma_f32_16x16x32_bf16 v[72:75], a[24:27], a[8:11], v[72:75]
  ds_read_b64_tr_b16 a[60:61], v13 offset:8192
  v_mfma_f32_16x16x32_bf16 v[88:91], a[24:27], a[12:15], v[88:91]
  ds_read_b64_tr_b16 a[62:63], v13 offset:9216
  s_waitcnt lgkmcnt(12)
  v_mfma_f32_16x16x32_bf16 v[44:47], a[28:31], a[0:3], v[44:47]
  v_mfma_f32_16x16x32_bf16 v[60:63], a[28:31], a[4:7], v[60:63]
  v_mfma_f32_16x16x32_bf16 v[76:79], a[28:31], a[8:11], v[76:79]
  v_mfma_f32_16x16x32_bf16 v[92:95], a[28:31], a[12:15], v[92:95]
  s_waitcnt lgkmcnt(9)
  v_mfma_f32_16x16x32_bf16 v[32:35], a[48:51], a[32:35], v[32:35]
  s_waitcnt lgkmcnt(8)
  v_mfma_f32_16x16x32_bf16 v[48:51], a[48:51], a[36:39], v[48:51]
  s_waitcnt lgkmcnt(7)
  v_mfma_f32_16x16x32_bf16 v[64:67], a[48:51], a[40:43], v[64:67]
  s_waitcnt lgkmcnt(6)
  v_mfma_f32_16x16x32_bf16 v[80:83], a[48:51], a[44:47], v[80:83]
  s_waitcnt lgkmcnt(0)
  s_barrier
  ds_read_b64_tr_b16 a[16:17], v10 offset:32768
  v_mfma_f32_16x16x32_bf16 v[36:39], a[52:55], a[32:35], v[36:39]
  ds_read_b64_tr_b16 a[18:19], v10 offset:33792
  v_mfma_f32_16x16x32_bf16 v[52:55], a[52:55], a[36:39], v[52:55]
  ds_read_b128 a[0:3], v6 offset:32768
  v_mfma_f32_16x16x32_bf16 v[68:71], a[52:55], a[40:43], v[68:71]
  ds_read_b128 a[4:7], v6 offset:34816
  v_mfma_f32_16x16x32_bf16 v[84:87], a[52:55], a[44:47], v[84:87]
  ds_read_b128 a[8:11], v6 offset:36864
  v_mfma_f32_16x16x32_bf16 v[40:43], a[56:59], a[32:35], v[40:43]
  ds_read_b128 a[12:15], v6 offset:38912
  v_mfma_f32_16x16x32_bf16 v[56:59], a[56:59], a[36:39], v[56:59]
  ds_read_b64_tr_b16 a[20:21], v11 offset:32768
  v_mfma_f32_16x16x32_bf16 v[72:75], a[56:59], a[40:43], v[72:75]
  ds_read_b64_tr_b16 a[22:23], v11 offset:33792
  v_mfma_f32_16x16x32_bf16 v[88:91], a[56:59], a[44:47], v[88:91]
  ds_read_b64_tr_b16 a[24:25], v12 offset:32768
  v_mfma_f32_16x16x32_bf16 v[44:47], a[60:63], a[32:35], v[44:47]
  ds_read_b64_tr_b16 a[26:27], v12 offset:33792
  v_mfma_f32_16x16x32_bf16 v[60:63], a[60:63], a[36:39], v[60:63]
  ds_read_b64_tr_b16 a[28:29], v13 offset:32768
  v_mfma_f32_16x16x32_bf16 v[76:79], a[60:63], a[40:43], v[76:79]
  ds_read_b64_tr_b16 a[30:31], v13 offset:33792
  v_mfma_f32_16x16x32_bf16 v[92:95], a[60:63], a[44:47], v[92:95]
  s_waitcnt lgkmcnt(9)
  v_mfma_f32_16x16x32_bf16 v[32:35], a[16:19], a[0:3], v[32:35]
  ds_read_b64_tr_b16 a[48:49], v10 offset:40960
  s_waitcnt lgkmcnt(9)
  v_mfma_f32_16x16x32_bf16 v[48:51], a[16:19], a[4:7], v[48:51]
  ds_read_b64_tr_b16 a[50:51], v10 offset:41984
  s_waitcnt lgkmcnt(9)
  v_mfma_f32_16x16x32_bf16 v[64:67], a[16:19], a[8:11], v[64:67]
  ds_read_b128 a[32:35], v7 offset:32768
  s_waitcnt lgkmcnt(9)
  v_mfma_f32_16x16x32_bf16 v[80:83], a[16:19], a[12:15], v[80:83]
  ds_read_b128 a[36:39], v7 offset:34816
  s_waitcnt lgkmcnt(8)
  v_mfma_f32_16x16x32_bf16 v[36:39], a[20:23], a[0:3], v[36:39]
  ds_read_b128 a[40:43], v7 offset:36864
  v_mfma_f32_16x16x32_bf16 v[52:55], a[20:23], a[4:7], v[52:55]
  ds_read_b128 a[44:47], v7 offset:38912
  v_mfma_f32_16x16x32_bf16 v[68:71], a[20:23], a[8:11], v[68:71]
  ds_read_b64_tr_b16 a[52:53], v11 offset:40960
  v_mfma_f32_16x16x32_bf16 v[84:87], a[20:23], a[12:15], v[84:87]
  ds_read_b64_tr_b16 a[54:55], v11 offset:41984
  s_waitcnt lgkmcnt(10)
  v_mfma_f32_16x16x32_bf16 v[40:43], a[24:27], a[0:3], v[40:43]
  ds_read_b64_tr_b16 a[56:57], v12 offset:40960
  v_mfma_f32_16x16x32_bf16 v[56:59], a[24:27], a[4:7], v[56:59]
  ds_read_b64_tr_b16 a[58:59], v12 offset:41984
  v_mfma_f32_16x16x32_bf16 v[72:75], a[24:27], a[8:11], v[72:75]
  ds_read_b64_tr_b16 a[60:61], v13 offset:40960
  v_mfma_f32_16x16x32_bf16 v[88:91], a[24:27], a[12:15], v[88:91]
  ds_read_b64_tr_b16 a[62:63], v13 offset:41984
  s_waitcnt lgkmcnt(12)
  v_mfma_f32_16x16x32_bf16 v[44:47], a[28:31], a[0:3], v[44:47]
  v_mfma_f32_16x16x32_bf16 v[60:63], a[28:31], a[4:7], v[60:63]
  v_mfma_f32_16x16x32_bf16 v[76:79], a[28:31], a[8:11], v[76:79]
  v_mfma_f32_16x16x32_bf16 v[92:95], a[28:31], a[12:15], v[92:95]
  s_waitcnt lgkmcnt(9)
  v_mfma_f32_16x16x32_bf16 v[32:35], a[48:51], a[32:35], v[32:35]
  s_waitcnt lgkmcnt(8)
  v_mfma_f32_16x16x32_bf16 v[48:51], a[48:51], a[36:39], v[48:51]
  s_waitcnt lgkmcnt(7)
  v_mfma_f32_16x16x32_bf16 v[64:67], a[48:51], a[40:43], v[64:67]
  s_waitcnt lgkmcnt(6)
  v_mfma_f32_16x16x32_bf16 v[80:83], a[48:51], a[44:47], v[80:83]
  s_waitcnt lgkmcnt(0)
  s_barrier
  ds_read_b64_tr_b16 a[16:17], v14 offset:0
  v_mfma_f32_16x16x32_bf16 v[36:39], a[52:55], a[32:35], v[36:39]
  ds_read_b64_tr_b16 a[18:19], v14 offset:1024
  v_mfma_f32_16x16x32_bf16 v[52:55], a[52:55], a[36:39], v[52:55]
  ds_read_b128 a[0:3], v8 offset:0
  v_mfma_f32_16x16x32_bf16 v[68:71], a[52:55], a[40:43], v[68:71]
  ds_read_b128 a[4:7], v8 offset:2048
  v_mfma_f32_16x16x32_bf16 v[84:87], a[52:55], a[44:47], v[84:87]
  ds_read_b128 a[8:11], v8 offset:4096
  v_mfma_f32_16x16x32_bf16 v[40:43], a[56:59], a[32:35], v[40:43]
  ds_read_b128 a[12:15], v8 offset:6144
  v_mfma_f32_16x16x32_bf16 v[56:59], a[56:59], a[36:39], v[56:59]
  ds_read_b64_tr_b16 a[20:21], v15 offset:0
  v_mfma_f32_16x16x32_bf16 v[72:75], a[56:59], a[40:43], v[72:75]
  ds_read_b64_tr_b16 a[22:23], v15 offset:1024
  v_mfma_f32_16x16x32_bf16 v[88:91], a[56:59], a[44:47], v[88:91]
  ds_read_b64_tr_b16 a[24:25], v16 offset:0
  v_mfma_f32_16x16x32_bf16 v[44:47], a[60:63], a[32:35], v[44:47]
  ds_read_b64_tr_b16 a[26:27], v16 offset:1024
  v_mfma_f32_16x16x32_bf16 v[60:63], a[60:63], a[36:39], v[60:63]
  ds_read_b64_tr_b16 a[28:29], v17 offset:0
  v_mfma_f32_16x16x32_bf16 v[76:79], a[60:63], a[40:43], v[76:79]
  ds_read_b64_tr_b16 a[30:31], v17 offset:1024
  v_mfma_f32_16x16x32_bf16 v[92:95], a[60:63], a[44:47], v[92:95]
  s_waitcnt lgkmcnt(9)
  v_mfma_f32_16x16x32_bf16 v[32:35], a[16:19], a[0:3], v[32:35]
  ds_read_b64_tr_b16 a[48:49], v14 offset:8192
  s_waitcnt lgkmcnt(9)
  v_mfma_f32_16x16x32_bf16 v[48:51], a[16:19], a[4:7], v[48:51]
  ds_read_b64_tr_b16 a[50:51], v14 offset:9216
  s_waitcnt lgkmcnt(9)
  v_mfma_f32_16x16x32_bf16 v[64:67], a[16:19], a[8:11], v[64:67]
  ds_read_b128 a[32:35], v9 offset:0
  s_waitcnt lgkmcnt(9)
  v_mfma_f32_16x16x32_bf16 v[80:83], a[16:19], a[12:15], v[80:83]
  ds_read_b128 a[36:39], v9 offset:2048
  s_waitcnt lgkmcnt(8)
  v_mfma_f32_16x16x32_bf16 v[36:39], a[20:23], a[0:3], v[36:39]
  ds_read_b128 a[40:43], v9 offset:4096
  v_mfma_f32_16x16x32_bf16 v[52:55], a[20:23], a[4:7], v[52:55]
  ds_read_b128 a[44:47], v9 offset:6144
  v_mfma_f32_16x16x32_bf16 v[68:71], a[20:23], a[8:11], v[68:71]
  ds_read_b64_tr_b16 a[52:53], v15 offset:8192
  v_mfma_f32_16x16x32_bf16 v[84:87], a[20:23], a[12:15], v[84:87]
  ds_read_b64_tr_b16 a[54:55], v15 offset:9216
  s_waitcnt lgkmcnt(10)
  v_mfma_f32_16x16x32_bf16 v[40:43], a[24:27], a[0:3], v[40:43]
  ds_read_b64_tr_b16 a[56:57], v16 offset:8192
  v_mfma_f32_16x16x32_bf16 v[56:59], a[24:27], a[4:7], v[56:59]
  ds_read_b64_tr_b16 a[58:59], v16 offset:9216
  v_mfma_f32_16x16x32_bf16 v[72:75], a[24:27], a[8:11], v[72:75]
  ds_read_b64_tr_b16 a[60:61], v17 offset:8192
  v_mfma_f32_16x16x32_bf16 v[88:91], a[24:27], a[12:15], v[88:91]
  ds_read_b64_tr_b16 a[62:63], v17 offset:9216
  s_waitcnt lgkmcnt(12)
  v_mfma_f32_16x16x32_bf16 v[44:47], a[28:31], a[0:3], v[44:47]
  v_mfma_f32_16x16x32_bf16 v[60:63], a[28:31], a[4:7], v[60:63]
  v_mfma_f32_16x16x32_bf16 v[76:79], a[28:31], a[8:11], v[76:79]
  v_mfma_f32_16x16x32_bf16 v[92:95], a[28:31], a[12:15], v[92:95]
  s_waitcnt lgkmcnt(9)
  v_mfma_f32_16x16x32_bf16 v[32:35], a[48:51], a[32:35], v[32:35]
  s_waitcnt lgkmcnt(8)
  v_mfma_f32_16x16x32_bf16 v[48:51], a[48:51], a[36:39], v[48:51]
  s_waitcnt lgkmcnt(7)
  v_mfma_f32_16x16x32_bf16 v[64:67], a[48:51], a[40:43], v[64:67]
  s_waitcnt lgkmcnt(6)
  v_mfma_f32_16x16x32_bf16 v[80:83], a[48:51], a[44:47], v[80:83]
  s_waitcnt lgkmcnt(0)
  s_barrier
  ds_read_b64_tr_b16 a[16:17], v14 offset:32768
  v_mfma_f32_16x16x32_bf16 v[36:39], a[52:55], a[32:35], v[36:39]
  ds_read_b64_tr_b16 a[18:19], v14 offset:33792
  v_mfma_f32_16x16x32_bf16 v[52:55], a[52:55], a[36:39], v[52:55]
  ds_read_b128 a[0:3], v8 offset:32768
  v_mfma_f32_16x16x32_bf16 v[68:71], a[52:55], a[40:43], v[68:71]
  ds_read_b128 a[4:7], v8 offset:34816
  v_mfma_f32_16x16x32_bf16 v[84:87], a[52:55], a[44:47], v[84:87]
  ds_read_b128 a[8:11], v8 offset:36864
  v_mfma_f32_16x16x32_bf16 v[40:43], a[56:59], a[32:35], v[40:43]
  ds_read_b128 a[12:15], v8 offset:38912
  v_mfma_f32_16x16x32_bf16 v[56:59], a[56:59], a[36:39], v[56:59]
  ds_read_b64_tr_b16 a[20:21], v15 offset:32768
  v_mfma_f32_16x16x32_bf16 v[72:75], a[56:59], a[40:43], v[72:75]
  ds_read_b64_tr_b16 a[22:23], v15 offset:33792
  v_mfma_f32_16x16x32_bf16 v[88:91], a[56:59], a[44:47], v[88:91]
  ds_read_b64_tr_b16 a[24:25], v16 offset:32768
  v_mfma_f32_16x16x32_bf16 v[44:47], a[60:63], a[32:35], v[44:47]
  ds_read_b64_tr_b16 a[26:27], v16 offset:33792
  v_mfma_f32_16x16x32_bf16 v[60:63], a[60:63], a[36:39], v[60:63]
  ds_read_b64_tr_b16 a[28:29], v17 offset:32768
  v_mfma_f32_16x16x32_bf16 v[76:79], a[60:63], a[40:43], v[76:79]
  ds_read_b64_tr_b16 a[30:31], v17 offset:33792
  v_mfma_f32_16x16x32_bf16 v[92:95], a[60:63], a[44:47], v[92:95]
  s_waitcnt lgkmcnt(9)
  v_mfma_f32_16x16x32_bf16 v[32:35], a[16:19], a[0:3], v[32:35]
  ds_read_b64_tr_b16 a[48:49], v14 offset:40960
  s_waitcnt lgkmcnt(9)
  v_mfma_f32_16x16x32_bf16 v[48:51], a[16:19], a[4:7], v[48:51]
  ds_read_b64_tr_b16 a[50:51], v14 offset:41984
  s_waitcnt lgkmcnt(9)
  v_mfma_f32_16x16x32_bf16 v[64:67], a[16:19], a[8:11], v[64:67]
  ds_read_b128 a[32:35], v9 offset:32768
  s_waitcnt lgkmcnt(9)
  v_mfma_f32_16x16x32_bf16 v[80:83], a[16:19], a[12:15], v[80:83]
  ds_read_b128 a[36:39], v9 offset:34816
  s_waitcnt lgkmcnt(8)
  v_mfma_f32_16x16x32_bf16 v[36:39], a[20:23], a[0:3], v[36:39]
  ds_read_b128 a[40:43], v9 offset:36864
  v_mfma_f32_16x16x32_bf16 v[52:55], a[20:23], a[4:7], v[52:55]
  ds_read_b128 a[44:47], v9 offset:38912
  v_mfma_f32_16x16x32_bf16 v[68:71], a[20:23], a[8:11], v[68:71]
  ds_read_b64_tr_b16 a[52:53], v15 offset:40960
  v_mfma_f32_16x16x32_bf16 v[84:87], a[20:23], a[12:15], v[84:87]
  ds_read_b64_tr_b16 a[54:55], v15 offset:41984
  s_waitcnt lgkmcnt(10)
  v_mfma_f32_16x16x32_bf16 v[40:43], a[24:27], a[0:3], v[40:43]
  ds_read_b64_tr_b16 a[56:57], v16 offset:40960
  v_mfma_f32_16x16x32_bf16 v[56:59], a[24:27], a[4:7], v[56:59]
  ds_read_b64_tr_b16 a[58:59], v16 offset:41984
  v_mfma_f32_16x16x32_bf16 v[72:75], a[24:27], a[8:11], v[72:75]
  ds_read_b64_tr_b16 a[60:61], v17 offset:40960
  v_mfma_f32_16x16x32_bf16 v[88:91], a[24:27], a[12:15], v[88:91]
  ds_read_b64_tr_b16 a[62:63], v17 offset:41984
  s_waitcnt lgkmcnt(12)
  v_mfma_f32_16x16x32_bf16 v[44:47], a[28:31], a[0:3], v[44:47]
  v_mfma_f32_16x16x32_bf16 v[60:63], a[28:31], a[4:7], v[60:63]
  v_mfma_f32_16x16x32_bf16 v[76:79], a[28:31], a[8:11], v[76:79]
  v_mfma_f32_16x16x32_bf16 v[92:95], a[28:31], a[12:15], v[92:95]
  s_waitcnt lgkmcnt(9)
  v_mfma_f32_16x16x32_bf16 v[32:35], a[48:51], a[32:35], v[32:35]
  s_waitcnt lgkmcnt(8)
  v_mfma_f32_16x16x32_bf16 v[48:51], a[48:51], a[36:39], v[48:51]
  s_waitcnt lgkmcnt(7)
  v_mfma_f32_16x16x32_bf16 v[64:67], a[48:51], a[40:43], v[64:67]
  s_waitcnt lgkmcnt(6)
  v_mfma_f32_16x16x32_bf16 v[80:83], a[48:51], a[44:47], v[80:83]
  s_waitcnt lgkmcnt(4)
  v_mfma_f32_16x16x32_bf16 v[36:39], a[52:55], a[32:35], v[36:39]
  v_mfma_f32_16x16x32_bf16 v[52:55], a[52:55], a[36:39], v[52:55]
  v_mfma_f32_16x16x32_bf16 v[68:71], a[52:55], a[40:43], v[68:71]
  v_mfma_f32_16x16x32_bf16 v[84:87], a[52:55], a[44:47], v[84:87]
  s_waitcnt lgkmcnt(2)
  v_mfma_f32_16x16x32_bf16 v[40:43], a[56:59], a[32:35], v[40:43]
  v_mfma_f32_16x16x32_bf16 v[56:59], a[56:59], a[36:39], v[56:59]
  v_mfma_f32_16x16x32_bf16 v[72:75], a[56:59], a[40:43], v[72:75]
  v_mfma_f32_16x16x32_bf16 v[88:91], a[56:59], a[44:47], v[88:91]
  s_waitcnt lgkmcnt(0)
  v_mfma_f32_16x16x32_bf16 v[44:47], a[60:63], a[32:35], v[44:47]
  v_mfma_f32_16x16x32_bf16 v[60:63], a[60:63], a[36:39], v[60:63]
  v_mfma_f32_16x16x32_bf16 v[76:79], a[60:63], a[40:43], v[76:79]
  v_mfma_f32_16x16x32_bf16 v[92:95], a[60:63], a[44:47], v[92:95]
  v_and_b32 v4, 15, v1
  s_lshl_b32 s36, s40, 9
  s_add_u32 s36, s36, 131072
  v_lshl_add_u32 v4, v4, 3, s36
  v_lshrrev_b32 v5, 4, v1
  s_lshl_b32 s36, s41, 7
  s_add_u32 s36, s36, 132096
  v_lshl_add_u32 v5, v5, 4, s36
  s_mov_b32 s44, 0xbdd2d3e8
  s_mov_b32 s45, 0xbdd2d3e8
  s_mov_b32 s48, 1.0
  s_mov_b32 s49, 1.0
  v_mov_b32 v2, 0xc0135761
  v_mov_b32 v3, 0xc0135761
  s_barrier
  ds_read_b64 v[20:21], v4 offset:0
  ds_read_b64 v[22:23], v4 offset:128
  ds_read_b64 v[24:25], v4 offset:256
  ds_read_b64 v[26:27], v4 offset:384
  ds_read_b128 v[112:115], v5 offset:0
  ds_read_b128 v[116:119], v5 offset:64
  ds_read_b128 v[120:123], v5 offset:256
  ds_read_b128 v[124:127], v5 offset:320
  s_waitcnt lgkmcnt(0)
  v_pk_mul_f32 v[96:97], v[112:113], v[20:21] op_sel:[0,1] op_sel_hi:[1,1]
  v_pk_mul_f32 v[98:99], v[114:115], v[20:21] op_sel:[0,1] op_sel_hi:[1,1]
  v_pk_fma_f32 v[32:33], v[32:33], v[20:21], v[96:97] op_sel:[0,0,0] op_sel_hi:[1,0,1]
  v_pk_fma_f32 v[34:35], v[34:35], v[20:21], v[98:99] op_sel:[0,0,0] op_sel_hi:[1,0,1]
  v_pk_mul_f32 v[96:97], v[116:117], v[20:21] op_sel:[0,1] op_sel_hi:[1,1]
  v_pk_mul_f32 v[98:99], v[118:119], v[20:21] op_sel:[0,1] op_sel_hi:[1,1]
  v_pk_fma_f32 v[36:37], v[36:37], v[20:21], v[96:97] op_sel:[0,0,0] op_sel_hi:[1,0,1]
  v_pk_fma_f32 v[38:39], v[38:39], v[20:21], v[98:99] op_sel:[0,0,0] op_sel_hi:[1,0,1]
  v_pk_mul_f32 v[96:97], v[32:33], v[32:33]
  v_pk_mul_f32 v[98:99], v[34:35], v[34:35]
  v_pk_mul_f32 v[100:101], v[36:37], v[36:37]
  v_pk_mul_f32 v[102:103], v[38:39], v[38:39]
  v_pk_fma_f32 v[96:97], v[96:97], s[44:45], v[2:3]
  v_pk_fma_f32 v[98:99], v[98:99], s[44:45], v[2:3]
  v_pk_fma_f32 v[100:101], v[100:101], s[44:45], v[2:3]
  v_pk_fma_f32 v[102:103], v[102:103], s[44:45], v[2:3]
  v_pk_mul_f32 v[96:97], v[96:97], v[32:33]
  v_pk_mul_f32 v[98:99], v[98:99], v[34:35]
  v_pk_mul_f32 v[100:101], v[100:101], v[36:37]
  v_pk_mul_f32 v[102:103], v[102:103], v[38:39]
  v_exp_f32 v96, v96
  v_exp_f32 v97, v97
  v_exp_f32 v98, v98
  v_exp_f32 v99, v99
  v_exp_f32 v100, v100
  v_exp_f32 v101, v101
  v_exp_f32 v102, v102
  v_exp_f32 v103, v103
  v_pk_add_f32 v[96:97], v[96:97], s[48:49]
  v_pk_add_f32 v[98:99], v[98:99], s[48:49]
  v_pk_add_f32 v[100:101], v[100:101], s[48:49]
  v_pk_add_f32 v[102:103], v[102:103], s[48:49]
  v_rcp_f32 v96, v96
  v_rcp_f32 v97, v97
  v_rcp_f32 v98, v98
  v_rcp_f32 v99, v99
  v_rcp_f32 v100, v100
  v_rcp_f32 v101, v101
  v_rcp_f32 v102, v102
  v_rcp_f32 v103, v103
  v_pk_mul_f32 v[32:33], v[32:33], v[96:97]
  v_pk_mul_f32 v[34:35], v[34:35], v[98:99]
  v_pk_mul_f32 v[36:37], v[36:37], v[100:101]
  v_pk_mul_f32 v[38:39], v[38:39], v[102:103]
  v_cvt_pk_bf16_f32 v104, v32, v33
  v_cvt_pk_bf16_f32 v105, v34, v35
  v_cvt_pk_bf16_f32 v106, v36, v37
  v_cvt_pk_bf16_f32 v107, v38, v39
  s_nop 0
  v_permlane16_swap_b32 v104, v106
  v_permlane16_swap_b32_e64 v105, v107
  buffer_store_dwordx4 v[104:107], v28, s[4:7], s38 offen offset:0 sc1
  ds_write_b128 v30, v[104:107] offset:0
  v_pk_mul_f32 v[96:97], v[112:113], v[22:23] op_sel:[0,1] op_sel_hi:[1,1]
  v_pk_mul_f32 v[98:99], v[114:115], v[22:23] op_sel:[0,1] op_sel_hi:[1,1]
  v_pk_fma_f32 v[48:49], v[48:49], v[22:23], v[96:97] op_sel:[0,0,0] op_sel_hi:[1,0,1]
  v_pk_fma_f32 v[50:51], v[50:51], v[22:23], v[98:99] op_sel:[0,0,0] op_sel_hi:[1,0,1]
  v_pk_mul_f32 v[96:97], v[116:117], v[22:23] op_sel:[0,1] op_sel_hi:[1,1]
  v_pk_mul_f32 v[98:99], v[118:119], v[22:23] op_sel:[0,1] op_sel_hi:[1,1]
  v_pk_fma_f32 v[52:53], v[52:53], v[22:23], v[96:97] op_sel:[0,0,0] op_sel_hi:[1,0,1]
  v_pk_fma_f32 v[54:55], v[54:55], v[22:23], v[98:99] op_sel:[0,0,0] op_sel_hi:[1,0,1]
  v_pk_mul_f32 v[96:97], v[48:49], v[48:49]
  v_pk_mul_f32 v[98:99], v[50:51], v[50:51]
  v_pk_mul_f32 v[100:101], v[52:53], v[52:53]
  v_pk_mul_f32 v[102:103], v[54:55], v[54:55]
  v_pk_fma_f32 v[96:97], v[96:97], s[44:45], v[2:3]
  v_pk_fma_f32 v[98:99], v[98:99], s[44:45], v[2:3]
  v_pk_fma_f32 v[100:101], v[100:101], s[44:45], v[2:3]
  v_pk_fma_f32 v[102:103], v[102:103], s[44:45], v[2:3]
  v_pk_mul_f32 v[96:97], v[96:97], v[48:49]
  v_pk_mul_f32 v[98:99], v[98:99], v[50:51]
  v_pk_mul_f32 v[100:101], v[100:101], v[52:53]
  v_pk_mul_f32 v[102:103], v[102:103], v[54:55]
  v_exp_f32 v96, v96
  v_exp_f32 v97, v97
  v_exp_f32 v98, v98
  v_exp_f32 v99, v99
  v_exp_f32 v100, v100
  v_exp_f32 v101, v101
  v_exp_f32 v102, v102
  v_exp_f32 v103, v103
  v_pk_add_f32 v[96:97], v[96:97], s[48:49]
  v_pk_add_f32 v[98:99], v[98:99], s[48:49]
  v_pk_add_f32 v[100:101], v[100:101], s[48:49]
  v_pk_add_f32 v[102:103], v[102:103], s[48:49]
  v_rcp_f32 v96, v96
  v_rcp_f32 v97, v97
  v_rcp_f32 v98, v98
  v_rcp_f32 v99, v99
  v_rcp_f32 v100, v100
  v_rcp_f32 v101, v101
  v_rcp_f32 v102, v102
  v_rcp_f32 v103, v103
  v_pk_mul_f32 v[48:49], v[48:49], v[96:97]
  v_pk_mul_f32 v[50:51], v[50:51], v[98:99]
  v_pk_mul_f32 v[52:53], v[52:53], v[100:101]
  v_pk_mul_f32 v[54:55], v[54:55], v[102:103]
  v_cvt_pk_bf16_f32 v108, v48, v49
  v_cvt_pk_bf16_f32 v109, v50, v51
  v_cvt_pk_bf16_f32 v110, v52, v53
  v_cvt_pk_bf16_f32 v111, v54, v55
  s_nop 0
  v_permlane16_swap_b32 v108, v110
  v_permlane16_swap_b32_e64 v109, v111
  buffer_store_dwordx4 v[108:111], v28, s[4:7], s38 offen offset:256 sc1
  ds_write_b128 v30, v[108:111] offset:256
  v_pk_mul_f32 v[96:97], v[112:113], v[24:25] op_sel:[0,1] op_sel_hi:[1,1]
  v_pk_mul_f32 v[98:99], v[114:115], v[24:25] op_sel:[0,1] op_sel_hi:[1,1]
  v_pk_fma_f32 v[64:65], v[64:65], v[24:25], v[96:97] op_sel:[0,0,0] op_sel_hi:[1,0,1]
  v_pk_fma_f32 v[66:67], v[66:67], v[24:25], v[98:99] op_sel:[0,0,0] op_sel_hi:[1,0,1]
  v_pk_mul_f32 v[96:97], v[116:117], v[24:25] op_sel:[0,1] op_sel_hi:[1,1]
  v_pk_mul_f32 v[98:99], v[118:119], v[24:25] op_sel:[0,1] op_sel_hi:[1,1]
  v_pk_fma_f32 v[68:69], v[68:69], v[24:25], v[96:97] op_sel:[0,0,0] op_sel_hi:[1,0,1]
  v_pk_fma_f32 v[70:71], v[70:71], v[24:25], v[98:99] op_sel:[0,0,0] op_sel_hi:[1,0,1]
  v_pk_mul_f32 v[96:97], v[64:65], v[64:65]
  v_pk_mul_f32 v[98:99], v[66:67], v[66:67]
  v_pk_mul_f32 v[100:101], v[68:69], v[68:69]
  v_pk_mul_f32 v[102:103], v[70:71], v[70:71]
  v_pk_fma_f32 v[96:97], v[96:97], s[44:45], v[2:3]
  v_pk_fma_f32 v[98:99], v[98:99], s[44:45], v[2:3]
  v_pk_fma_f32 v[100:101], v[100:101], s[44:45], v[2:3]
  v_pk_fma_f32 v[102:103], v[102:103], s[44:45], v[2:3]
  v_pk_mul_f32 v[96:97], v[96:97], v[64:65]
  v_pk_mul_f32 v[98:99], v[98:99], v[66:67]
  v_pk_mul_f32 v[100:101], v[100:101], v[68:69]
  v_pk_mul_f32 v[102:103], v[102:103], v[70:71]
  v_exp_f32 v96, v96
  v_exp_f32 v97, v97
  v_exp_f32 v98, v98
  v_exp_f32 v99, v99
  v_exp_f32 v100, v100
  v_exp_f32 v101, v101
  v_exp_f32 v102, v102
  v_exp_f32 v103, v103
  v_pk_add_f32 v[96:97], v[96:97], s[48:49]
  v_pk_add_f32 v[98:99], v[98:99], s[48:49]
  v_pk_add_f32 v[100:101], v[100:101], s[48:49]
  v_pk_add_f32 v[102:103], v[102:103], s[48:49]
  v_rcp_f32 v96, v96
  v_rcp_f32 v97, v97
  v_rcp_f32 v98, v98
  v_rcp_f32 v99, v99
  v_rcp_f32 v100, v100
  v_rcp_f32 v101, v101
  v_rcp_f32 v102, v102
  v_rcp_f32 v103, v103
  v_pk_mul_f32 v[64:65], v[64:65], v[96:97]
  v_pk_mul_f32 v[66:67], v[66:67], v[98:99]
  v_pk_mul_f32 v[68:69], v[68:69], v[100:101]
  v_pk_mul_f32 v[70:71], v[70:71], v[102:103]
  v_cvt_pk_bf16_f32 v104, v64, v65
  v_cvt_pk_bf16_f32 v105, v66, v67
  v_cvt_pk_bf16_f32 v106, v68, v69
  v_cvt_pk_bf16_f32 v107, v70, v71
  s_nop 0
  v_permlane16_swap_b32 v104, v106
  v_permlane16_swap_b32_e64 v105, v107
  buffer_store_dwordx4 v[104:107], v28, s[4:7], s38 offen offset:512 sc1
  ds_write_b128 v30, v[104:107] offset:512
  v_pk_mul_f32 v[96:97], v[112:113], v[26:27] op_sel:[0,1] op_sel_hi:[1,1]
  v_pk_mul_f32 v[98:99], v[114:115], v[26:27] op_sel:[0,1] op_sel_hi:[1,1]
  v_pk_fma_f32 v[80:81], v[80:81], v[26:27], v[96:97] op_sel:[0,0,0] op_sel_hi:[1,0,1]
  v_pk_fma_f32 v[82:83], v[82:83], v[26:27], v[98:99] op_sel:[0,0,0] op_sel_hi:[1,0,1]
  v_pk_mul_f32 v[96:97], v[116:117], v[26:27] op_sel:[0,1] op_sel_hi:[1,1]
  v_pk_mul_f32 v[98:99], v[118:119], v[26:27] op_sel:[0,1] op_sel_hi:[1,1]
  v_pk_fma_f32 v[84:85], v[84:85], v[26:27], v[96:97] op_sel:[0,0,0] op_sel_hi:[1,0,1]
  v_pk_fma_f32 v[86:87], v[86:87], v[26:27], v[98:99] op_sel:[0,0,0] op_sel_hi:[1,0,1]
  v_pk_mul_f32 v[96:97], v[80:81], v[80:81]
  v_pk_mul_f32 v[98:99], v[82:83], v[82:83]
  v_pk_mul_f32 v[100:101], v[84:85], v[84:85]
  v_pk_mul_f32 v[102:103], v[86:87], v[86:87]
  v_pk_fma_f32 v[96:97], v[96:97], s[44:45], v[2:3]
  v_pk_fma_f32 v[98:99], v[98:99], s[44:45], v[2:3]
  v_pk_fma_f32 v[100:101], v[100:101], s[44:45], v[2:3]
  v_pk_fma_f32 v[102:103], v[102:103], s[44:45], v[2:3]
  v_pk_mul_f32 v[96:97], v[96:97], v[80:81]
  v_pk_mul_f32 v[98:99], v[98:99], v[82:83]
  v_pk_mul_f32 v[100:101], v[100:101], v[84:85]
  v_pk_mul_f32 v[102:103], v[102:103], v[86:87]
  v_exp_f32 v96, v96
  v_exp_f32 v97, v97
  v_exp_f32 v98, v98
  v_exp_f32 v99, v99
  v_exp_f32 v100, v100
  v_exp_f32 v101, v101
  v_exp_f32 v102, v102
  v_exp_f32 v103, v103
  v_pk_add_f32 v[96:97], v[96:97], s[48:49]
  v_pk_add_f32 v[98:99], v[98:99], s[48:49]
  v_pk_add_f32 v[100:101], v[100:101], s[48:49]
  v_pk_add_f32 v[102:103], v[102:103], s[48:49]
  v_rcp_f32 v96, v96
  v_rcp_f32 v97, v97
  v_rcp_f32 v98, v98
  v_rcp_f32 v99, v99
  v_rcp_f32 v100, v100
  v_rcp_f32 v101, v101
  v_rcp_f32 v102, v102
  v_rcp_f32 v103, v103
  v_pk_mul_f32 v[80:81], v[80:81], v[96:97]
  v_pk_mul_f32 v[82:83], v[82:83], v[98:99]
  v_pk_mul_f32 v[84:85], v[84:85], v[100:101]
  v_pk_mul_f32 v[86:87], v[86:87], v[102:103]
  v_cvt_pk_bf16_f32 v108, v80, v81
  v_cvt_pk_bf16_f32 v109, v82, v83
  v_cvt_pk_bf16_f32 v110, v84, v85
  v_cvt_pk_bf16_f32 v111, v86, v87
  s_nop 0
  v_permlane16_swap_b32 v108, v110
  v_permlane16_swap_b32_e64 v109, v111
  buffer_store_dwordx4 v[108:111], v28, s[4:7], s38 offen offset:768 sc1
  ds_write_b128 v30, v[108:111] offset:768
  v_pk_mul_f32 v[96:97], v[120:121], v[20:21] op_sel:[0,1] op_sel_hi:[1,1]
  v_pk_mul_f32 v[98:99], v[122:123], v[20:21] op_sel:[0,1] op_sel_hi:[1,1]
  v_pk_fma_f32 v[40:41], v[40:41], v[20:21], v[96:97] op_sel:[0,0,0] op_sel_hi:[1,0,1]
  v_pk_fma_f32 v[42:43], v[42:43], v[20:21], v[98:99] op_sel:[0,0,0] op_sel_hi:[1,0,1]
  v_pk_mul_f32 v[96:97], v[124:125], v[20:21] op_sel:[0,1] op_sel_hi:[1,1]
  v_pk_mul_f32 v[98:99], v[126:127], v[20:21] op_sel:[0,1] op_sel_hi:[1,1]
  v_pk_fma_f32 v[44:45], v[44:45], v[20:21], v[96:97] op_sel:[0,0,0] op_sel_hi:[1,0,1]
  v_pk_fma_f32 v[46:47], v[46:47], v[20:21], v[98:99] op_sel:[0,0,0] op_sel_hi:[1,0,1]
  v_pk_mul_f32 v[96:97], v[40:41], v[40:41]
  v_pk_mul_f32 v[98:99], v[42:43], v[42:43]
  v_pk_mul_f32 v[100:101], v[44:45], v[44:45]
  v_pk_mul_f32 v[102:103], v[46:47], v[46:47]
  v_pk_fma_f32 v[96:97], v[96:97], s[44:45], v[2:3]
  v_pk_fma_f32 v[98:99], v[98:99], s[44:45], v[2:3]
  v_pk_fma_f32 v[100:101], v[100:101], s[44:45], v[2:3]
  v_pk_fma_f32 v[102:103], v[102:103], s[44:45], v[2:3]
  v_pk_mul_f32 v[96:97], v[96:97], v[40:41]
  v_pk_mul_f32 v[98:99], v[98:99], v[42:43]
  v_pk_mul_f32 v[100:101], v[100:101], v[44:45]
  v_pk_mul_f32 v[102:103], v[102:103], v[46:47]
  v_exp_f32 v96, v96
  v_exp_f32 v97, v97
  v_exp_f32 v98, v98
  v_exp_f32 v99, v99
  v_exp_f32 v100, v100
  v_exp_f32 v101, v101
  v_exp_f32 v102, v102
  v_exp_f32 v103, v103
  v_pk_add_f32 v[96:97], v[96:97], s[48:49]
  v_pk_add_f32 v[98:99], v[98:99], s[48:49]
  v_pk_add_f32 v[100:101], v[100:101], s[48:49]
  v_pk_add_f32 v[102:103], v[102:103], s[48:49]
  v_rcp_f32 v96, v96
  v_rcp_f32 v97, v97
  v_rcp_f32 v98, v98
  v_rcp_f32 v99, v99
  v_rcp_f32 v100, v100
  v_rcp_f32 v101, v101
  v_rcp_f32 v102, v102
  v_rcp_f32 v103, v103
  v_pk_mul_f32 v[40:41], v[40:41], v[96:97]
  v_pk_mul_f32 v[42:43], v[42:43], v[98:99]
  v_pk_mul_f32 v[44:45], v[44:45], v[100:101]
  v_pk_mul_f32 v[46:47], v[46:47], v[102:103]
  v_cvt_pk_bf16_f32 v104, v40, v41
  v_cvt_pk_bf16_f32 v105, v42, v43
  v_cvt_pk_bf16_f32 v106, v44, v45
  v_cvt_pk_bf16_f32 v107, v46, v47
  s_nop 0
  v_permlane16_swap_b32 v104, v106
  v_permlane16_swap_b32_e64 v105, v107
  buffer_store_dwordx4 v[104:107], v29, s[4:7], s38 offen offset:0 sc1
  ds_write_b128 v30, v[104:107] offset:32768
  v_pk_mul_f32 v[96:97], v[120:121], v[22:23] op_sel:[0,1] op_sel_hi:[1,1]
  v_pk_mul_f32 v[98:99], v[122:123], v[22:23] op_sel:[0,1] op_sel_hi:[1,1]
  v_pk_fma_f32 v[56:57], v[56:57], v[22:23], v[96:97] op_sel:[0,0,0] op_sel_hi:[1,0,1]
  v_pk_fma_f32 v[58:59], v[58:59], v[22:23], v[98:99] op_sel:[0,0,0] op_sel_hi:[1,0,1]
  v_pk_mul_f32 v[96:97], v[124:125], v[22:23] op_sel:[0,1] op_sel_hi:[1,1]
  v_pk_mul_f32 v[98:99], v[126:127], v[22:23] op_sel:[0,1] op_sel_hi:[1,1]
  v_pk_fma_f32 v[60:61], v[60:61], v[22:23], v[96:97] op_sel:[0,0,0] op_sel_hi:[1,0,1]
  v_pk_fma_f32 v[62:63], v[62:63], v[22:23], v[98:99] op_sel:[0,0,0] op_sel_hi:[1,0,1]
  v_pk_mul_f32 v[96:97], v[56:57], v[56:57]
  v_pk_mul_f32 v[98:99], v[58:59], v[58:59]
  v_pk_mul_f32 v[100:101], v[60:61], v[60:61]
  v_pk_mul_f32 v[102:103], v[62:63], v[62:63]
  v_pk_fma_f32 v[96:97], v[96:97], s[44:45], v[2:3]
  v_pk_fma_f32 v[98:99], v[98:99], s[44:45], v[2:3]
  v_pk_fma_f32 v[100:101], v[100:101], s[44:45], v[2:3]
  v_pk_fma_f32 v[102:103], v[102:103], s[44:45], v[2:3]
  v_pk_mul_f32 v[96:97], v[96:97], v[56:57]
  v_pk_mul_f32 v[98:99], v[98:99], v[58:59]
  v_pk_mul_f32 v[100:101], v[100:101], v[60:61]
  v_pk_mul_f32 v[102:103], v[102:103], v[62:63]
  v_exp_f32 v96, v96
  v_exp_f32 v97, v97
  v_exp_f32 v98, v98
  v_exp_f32 v99, v99
  v_exp_f32 v100, v100
  v_exp_f32 v101, v101
  v_exp_f32 v102, v102
  v_exp_f32 v103, v103
  v_pk_add_f32 v[96:97], v[96:97], s[48:49]
  v_pk_add_f32 v[98:99], v[98:99], s[48:49]
  v_pk_add_f32 v[100:101], v[100:101], s[48:49]
  v_pk_add_f32 v[102:103], v[102:103], s[48:49]
  v_rcp_f32 v96, v96
  v_rcp_f32 v97, v97
  v_rcp_f32 v98, v98
  v_rcp_f32 v99, v99
  v_rcp_f32 v100, v100
  v_rcp_f32 v101, v101
  v_rcp_f32 v102, v102
  v_rcp_f32 v103, v103
  v_pk_mul_f32 v[56:57], v[56:57], v[96:97]
  v_pk_mul_f32 v[58:59], v[58:59], v[98:99]
  v_pk_mul_f32 v[60:61], v[60:61], v[100:101]
  v_pk_mul_f32 v[62:63], v[62:63], v[102:103]
  v_cvt_pk_bf16_f32 v108, v56, v57
  v_cvt_pk_bf16_f32 v109, v58, v59
  v_cvt_pk_bf16_f32 v110, v60, v61
  v_cvt_pk_bf16_f32 v111, v62, v63
  s_nop 0
  v_permlane16_swap_b32 v108, v110
  v_permlane16_swap_b32 v109, v111
  buffer_store_dwordx4 v[108:111], v29, s[4:7], s38 offen offset:256 sc1
  ds_write_b128 v30, v[108:111] offset:33024
  s_waitcnt vmcnt(2)
  s_barrier
  s_nop 0
  v_pk_mul_f32 v[96:97], v[120:121], v[24:25] op_sel:[0,1] op_sel_hi:[1,1]
  v_pk_mul_f32 v[98:99], v[122:123], v[24:25] op_sel:[0,1] op_sel_hi:[1,1]
  v_pk_fma_f32 v[72:73], v[72:73], v[24:25], v[96:97] op_sel:[0,0,0] op_sel_hi:[1,0,1]
  v_pk_fma_f32 v[74:75], v[74:75], v[24:25], v[98:99] op_sel:[0,0,0] op_sel_hi:[1,0,1]
  v_pk_mul_f32 v[96:97], v[124:125], v[24:25] op_sel:[0,1] op_sel_hi:[1,1]
  v_pk_mul_f32 v[98:99], v[126:127], v[24:25] op_sel:[0,1] op_sel_hi:[1,1]
  v_pk_fma_f32 v[76:77], v[76:77], v[24:25], v[96:97] op_sel:[0,0,0] op_sel_hi:[1,0,1]
  v_pk_fma_f32 v[78:79], v[78:79], v[24:25], v[98:99] op_sel:[0,0,0] op_sel_hi:[1,0,1]
  v_pk_mul_f32 v[96:97], v[72:73], v[72:73]
  v_pk_mul_f32 v[98:99], v[74:75], v[74:75]
  v_pk_mul_f32 v[100:101], v[76:77], v[76:77]
  v_pk_mul_f32 v[102:103], v[78:79], v[78:79]
  v_pk_fma_f32 v[96:97], v[96:97], s[44:45], v[2:3]
  v_pk_fma_f32 v[98:99], v[98:99], s[44:45], v[2:3]
  v_pk_fma_f32 v[100:101], v[100:101], s[44:45], v[2:3]
  v_pk_fma_f32 v[102:103], v[102:103], s[44:45], v[2:3]
  v_pk_mul_f32 v[96:97], v[96:97], v[72:73]
  v_pk_mul_f32 v[98:99], v[98:99], v[74:75]
  v_pk_mul_f32 v[100:101], v[100:101], v[76:77]
  v_pk_mul_f32 v[102:103], v[102:103], v[78:79]
  v_exp_f32 v96, v96
  v_exp_f32 v97, v97
  v_exp_f32 v98, v98
  v_exp_f32 v99, v99
  v_exp_f32 v100, v100
  v_exp_f32 v101, v101
  v_exp_f32 v102, v102
  v_exp_f32 v103, v103
  v_pk_add_f32 v[96:97], v[96:97], s[48:49]
  v_pk_add_f32 v[98:99], v[98:99], s[48:49]
  v_pk_add_f32 v[100:101], v[100:101], s[48:49]
  v_pk_add_f32 v[102:103], v[102:103], s[48:49]
  v_rcp_f32 v96, v96
  v_rcp_f32 v97, v97
  v_rcp_f32 v98, v98
  v_rcp_f32 v99, v99
  v_rcp_f32 v100, v100
  v_rcp_f32 v101, v101
  v_rcp_f32 v102, v102
  v_rcp_f32 v103, v103
  v_pk_mul_f32 v[72:73], v[72:73], v[96:97]
  v_pk_mul_f32 v[74:75], v[74:75], v[98:99]
  v_pk_mul_f32 v[76:77], v[76:77], v[100:101]
  v_pk_mul_f32 v[78:79], v[78:79], v[102:103]
  v_cvt_pk_bf16_f32 v104, v72, v73
  v_cvt_pk_bf16_f32 v105, v74, v75
  v_cvt_pk_bf16_f32 v106, v76, v77
  v_cvt_pk_bf16_f32 v107, v78, v79
  s_nop 0
  v_permlane16_swap_b32 v104, v106
  v_permlane16_swap_b32_e64 v105, v107
  buffer_store_dwordx4 v[104:107], v29, s[4:7], s38 offen offset:512 sc1
  ds_write_b128 v30, v[104:107] offset:33280
  v_pk_mul_f32 v[96:97], v[120:121], v[26:27] op_sel:[0,1] op_sel_hi:[1,1]
  v_pk_mul_f32 v[98:99], v[122:123], v[26:27] op_sel:[0,1] op_sel_hi:[1,1]
  v_pk_fma_f32 v[88:89], v[88:89], v[26:27], v[96:97] op_sel:[0,0,0] op_sel_hi:[1,0,1]
  v_pk_fma_f32 v[90:91], v[90:91], v[26:27], v[98:99] op_sel:[0,0,0] op_sel_hi:[1,0,1]
  v_pk_mul_f32 v[96:97], v[124:125], v[26:27] op_sel:[0,1] op_sel_hi:[1,1]
  v_pk_mul_f32 v[98:99], v[126:127], v[26:27] op_sel:[0,1] op_sel_hi:[1,1]
  v_pk_fma_f32 v[92:93], v[92:93], v[26:27], v[96:97] op_sel:[0,0,0] op_sel_hi:[1,0,1]
  v_pk_fma_f32 v[94:95], v[94:95], v[26:27], v[98:99] op_sel:[0,0,0] op_sel_hi:[1,0,1]
  v_pk_mul_f32 v[96:97], v[88:89], v[88:89]
  v_pk_mul_f32 v[98:99], v[90:91], v[90:91]
  v_pk_mul_f32 v[100:101], v[92:93], v[92:93]
  v_pk_mul_f32 v[102:103], v[94:95], v[94:95]
  v_pk_fma_f32 v[96:97], v[96:97], s[44:45], v[2:3]
  v_pk_fma_f32 v[98:99], v[98:99], s[44:45], v[2:3]
  v_pk_fma_f32 v[100:101], v[100:101], s[44:45], v[2:3]
  v_pk_fma_f32 v[102:103], v[102:103], s[44:45], v[2:3]
  v_pk_mul_f32 v[96:97], v[96:97], v[88:89]
  v_pk_mul_f32 v[98:99], v[98:99], v[90:91]
  v_pk_mul_f32 v[100:101], v[100:101], v[92:93]
  v_pk_mul_f32 v[102:103], v[102:103], v[94:95]
  v_exp_f32 v96, v96
  v_exp_f32 v97, v97
  v_exp_f32 v98, v98
  v_exp_f32 v99, v99
  v_exp_f32 v100, v100
  v_exp_f32 v101, v101
  v_exp_f32 v102, v102
  v_exp_f32 v103, v103
  v_pk_add_f32 v[96:97], v[96:97], s[48:49]
  v_pk_add_f32 v[98:99], v[98:99], s[48:49]
  v_pk_add_f32 v[100:101], v[100:101], s[48:49]
  v_pk_add_f32 v[102:103], v[102:103], s[48:49]
  v_rcp_f32 v96, v96
  v_rcp_f32 v97, v97
  v_rcp_f32 v98, v98
  v_rcp_f32 v99, v99
  v_rcp_f32 v100, v100
  v_rcp_f32 v101, v101
  v_rcp_f32 v102, v102
  v_rcp_f32 v103, v103
  v_pk_mul_f32 v[88:89], v[88:89], v[96:97]
  v_pk_mul_f32 v[90:91], v[90:91], v[98:99]
  v_pk_mul_f32 v[92:93], v[92:93], v[100:101]
  v_pk_mul_f32 v[94:95], v[94:95], v[102:103]
  v_cvt_pk_bf16_f32 v108, v88, v89
  v_cvt_pk_bf16_f32 v109, v90, v91
  v_cvt_pk_bf16_f32 v110, v92, v93
  v_cvt_pk_bf16_f32 v111, v94, v95
  s_nop 0
  v_permlane16_swap_b32 v108, v110
  v_permlane16_swap_b32 v109, v111
  buffer_store_dwordx4 v[108:111], v29, s[4:7], s38 offen offset:768 sc1
  ds_write_b128 v30, v[108:111] offset:33536
  s_mul_i32 s30, s34, 262144
  s_lshl_b32 s31, s35, 8
  s_lshl_b32 s87, s34, 3
  s_add_u32 s87, s87, s35
  s_lshl_b32 s87, s87, 7
  s_add_u32 s87, s87, 39911424
  v_and_b32 v2, 15, v1
  v_lshrrev_b32 v3, 4, v1
  v_lshlrev_b32 v3, 11, v3
  v_lshl_add_u32 v3, v2, 4, v3
  s_lshl_b32 s36, s40, 10
  v_add_u32 v6, s36, v3
  v_add_u32 v7, 8192, v6
  v_add_u32 v8, 65536, v6
  v_add_u32 v9, 65536, v7
  s_mov_b32 s44, 0x3f803f80
  s_waitcnt lgkmcnt(0)
  s_barrier
  ds_read_b64_tr_b16 a[16:17], v10 offset:0
  ds_read_b64_tr_b16 a[18:19], v10 offset:1024
  ds_read_b128 a[0:3], v6 offset:0
  ds_read_b128 a[4:7], v6 offset:256
  ds_read_b128 a[8:11], v6 offset:512
  ds_read_b128 a[12:15], v6 offset:768
  ds_read_b64_tr_b16 a[20:21], v11 offset:0
  ds_read_b64_tr_b16 a[22:23], v11 offset:1024
  ds_read_b64_tr_b16 a[24:25], v12 offset:0
  ds_read_b64_tr_b16 a[26:27], v12 offset:1024
  ds_read_b64_tr_b16 a[28:29], v13 offset:0
  ds_read_b64_tr_b16 a[30:31], v13 offset:1024
  s_waitcnt lgkmcnt(9)
  v_mfma_f32_16x16x32_bf16 v[32:35], a[16:19], a[0:3], 0
  ds_read_b64_tr_b16 a[48:49], v10 offset:8192
  v_and_b32 v2, 15, v1
  s_waitcnt lgkmcnt(9)
  v_mfma_f32_16x16x32_bf16 v[48:51], a[16:19], a[4:7], 0
  ds_read_b64_tr_b16 a[50:51], v10 offset:9216
  v_lshrrev_b32 v3, 4, v1
  s_waitcnt lgkmcnt(9)
  v_mfma_f32_16x16x32_bf16 v[64:67], a[16:19], a[8:11], 0
  ds_read_b128 a[32:35], v7 offset:0
  v_and_b32 v4, 1, v3
  s_waitcnt lgkmcnt(9)
  v_mfma_f32_16x16x32_bf16 v[80:83], a[16:19], a[12:15], 0
  ds_read_b128 a[36:39], v7 offset:256
  v_lshrrev_b32 v3, 1, v3
  s_waitcnt lgkmcnt(8)
  v_mfma_f32_16x16x32_bf16 v[36:39], a[20:23], a[0:3], 0
  ds_read_b128 a[40:43], v7 offset:512
  v_lshl_or_b32 v3, v4, 1, v3
  v_mfma_f32_16x16x32_bf16 v[52:55], a[20:23], a[4:7], 0
  ds_read_b128 a[44:47], v7 offset:768
  v_lshlrev_b32 v19, 3, v2
  v_mfma_f32_16x16x32_bf16 v[68:71], a[20:23], a[8:11], 0
  ds_read_b64_tr_b16 a[52:53], v11 offset:8192
  s_lshl_b32 s36, s34, 1
  v_mfma_f32_16x16x32_bf16 v[84:87], a[20:23], a[12:15], 0
  ds_read_b64_tr_b16 a[54:55], v11 offset:9216
  s_add_u32 s36, s36, s40
  s_waitcnt lgkmcnt(10)
  v_mfma_f32_16x16x32_bf16 v[40:43], a[24:27], a[0:3], 0
  ds_read_b64_tr_b16 a[56:57], v12 offset:8192
  s_lshl_b32 s37, s35, 1
  v_mfma_f32_16x16x32_bf16 v[56:59], a[24:27], a[4:7], 0
  ds_read_b64_tr_b16 a[58:59], v12 offset:9216
  s_add_u32 s37, s37, s41
  v_mfma_f32_16x16x32_bf16 v[72:75], a[24:27], a[8:11], 0
  ds_read_b64_tr_b16 a[60:61], v13 offset:8192
  s_lshl_b32 s51, s36, 9
  v_mfma_f32_16x16x32_bf16 v[88:91], a[24:27], a[12:15], 0
  ds_read_b64_tr_b16 a[62:63], v13 offset:9216
  s_add_u32 s52, s51, 36700160
  s_waitcnt lgkmcnt(12)
  v_mfma_f32_16x16x32_bf16 v[44:47], a[28:31], a[0:3], 0
  s_lshl_b32 s53, s37, 14
  v_mfma_f32_16x16x32_bf16 v[60:63], a[28:31], a[4:7], 0
  s_add_u32 s53, s53, s51
  v_mfma_f32_16x16x32_bf16 v[76:79], a[28:31], a[8:11], 0
  s_add_u32 s53, s53, 37748736
  v_mfma_f32_16x16x32_bf16 v[92:95], a[28:31], a[12:15], 0
  s_lshl_b32 s54, s35, 2
  s_waitcnt lgkmcnt(9)
  v_mfma_f32_16x16x32_bf16 v[32:35], a[48:51], a[32:35], v[32:35]
  s_add_u32 s54, s54, s41
  s_waitcnt lgkmcnt(8)
  v_mfma_f32_16x16x32_bf16 v[48:51], a[48:51], a[36:39], v[48:51]
  s_lshl_b32 s54, s54, 13
  s_waitcnt lgkmcnt(7)
  v_mfma_f32_16x16x32_bf16 v[64:67], a[48:51], a[40:43], v[64:67]
  s_mul_i32 s51, s34, 262144
  s_waitcnt lgkmcnt(6)
  v_mfma_f32_16x16x32_bf16 v[80:83], a[48:51], a[44:47], v[80:83]
  s_waitcnt lgkmcnt(0)
  s_barrier
  ds_read_b64_tr_b16 a[16:17], v10 offset:32768
  s_add_u32 s54, s54, s51
  v_mfma_f32_16x16x32_bf16 v[36:39], a[52:55], a[32:35], v[36:39]
  ds_read_b64_tr_b16 a[18:19], v10 offset:33792
  s_lshl_b32 s51, s40, 10
  v_mfma_f32_16x16x32_bf16 v[52:55], a[52:55], a[36:39], v[52:55]
  ds_read_b128 a[0:3], v6 offset:32768
  s_add_u32 s54, s54, s51
  v_mfma_f32_16x16x32_bf16 v[68:71], a[52:55], a[40:43], v[68:71]
  ds_read_b128 a[4:7], v6 offset:33024
  s_add_u32 s54, s54, 16777216
  v_mfma_f32_16x16x32_bf16 v[84:87], a[52:55], a[44:47], v[84:87]
  ds_read_b128 a[8:11], v6 offset:33280
  v_lshlrev_b32 v3, 11, v3
  v_mfma_f32_16x16x32_bf16 v[40:43], a[56:59], a[32:35], v[40:43]
  ds_read_b128 a[12:15], v6 offset:33536
  v_lshl_add_u32 v28, v2, 4, v3
  v_mfma_f32_16x16x32_bf16 v[56:59], a[56:59], a[36:39], v[56:59]
  ds_read_b64_tr_b16 a[20:21], v11 offset:32768
  v_add_u32 v29, 16384, v28
  v_mfma_f32_16x16x32_bf16 v[72:75], a[56:59], a[40:43], v[72:75]
  ds_read_b64_tr_b16 a[22:23], v11 offset:33792
  v_lshrrev_b32 v3, 5, v1
  v_mfma_f32_16x16x32_bf16 v[88:91], a[56:59], a[44:47], v[88:91]
  ds_read_b64_tr_b16 a[24:25], v12 offset:32768
  s_lshl_b32 s51, s41, 2
  v_mfma_f32_16x16x32_bf16 v[44:47], a[60:63], a[32:35], v[44:47]
  ds_read_b64_tr_b16 a[26:27], v12 offset:33792
  v_add_u32 v3, s51, v3
  v_mfma_f32_16x16x32_bf16 v[60:63], a[60:63], a[36:39], v[60:63]
  ds_read_b64_tr_b16 a[28:29], v13 offset:32768
  v_xor_b32 v3, v3, v2
  v_mfma_f32_16x16x32_bf16 v[76:79], a[60:63], a[40:43], v[76:79]
  ds_read_b64_tr_b16 a[30:31], v13 offset:33792
  v_bfe_u32 v4, v1, 4, 1
  v_mfma_f32_16x16x32_bf16 v[92:95], a[60:63], a[44:47], v[92:95]
  v_lshlrev_b32 v4, 3, v4
  s_waitcnt lgkmcnt(9)
  v_mfma_f32_16x16x32_bf16 v[32:35], a[16:19], a[0:3], v[32:35]
  ds_read_b64_tr_b16 a[48:49], v10 offset:40960
  v_lshl_add_u32 v4, v2, 8, v4
  s_waitcnt lgkmcnt(9)
  v_mfma_f32_16x16x32_bf16 v[48:51], a[16:19], a[4:7], v[48:51]
  ds_read_b64_tr_b16 a[50:51], v10 offset:41984
  s_lshl_b32 s51, s40, 14
  s_waitcnt lgkmcnt(9)
  v_mfma_f32_16x16x32_bf16 v[64:67], a[16:19], a[8:11], v[64:67]
  ds_read_b128 a[32:35], v7 offset:32768
  s_add_u32 s51, s51, 131072
  s_waitcnt lgkmcnt(9)
  v_mfma_f32_16x16x32_bf16 v[80:83], a[16:19], a[12:15], v[80:83]
  ds_read_b128 a[36:39], v7 offset:33024
  v_add_u32 v4, s51, v4
  s_waitcnt lgkmcnt(8)
  v_mfma_f32_16x16x32_bf16 v[36:39], a[20:23], a[0:3], v[36:39]
  ds_read_b128 a[40:43], v7 offset:33280
  v_lshl_add_u32 v18, v3, 4, v4
  v_mfma_f32_16x16x32_bf16 v[52:55], a[20:23], a[4:7], v[52:55]
  ds_read_b128 a[44:47], v7 offset:33536
  v_xor_b32 v30, 32, v18
  v_mfma_f32_16x16x32_bf16 v[68:71], a[20:23], a[8:11], v[68:71]
  ds_read_b64_tr_b16 a[52:53], v11 offset:40960
  v_xor_b32 v31, 128, v18
  v_mfma_f32_16x16x32_bf16 v[84:87], a[20:23], a[12:15], v[84:87]
  ds_read_b64_tr_b16 a[54:55], v11 offset:41984
  v_xor_b32 v5, 160, v18
  s_waitcnt lgkmcnt(10)
  v_mfma_f32_16x16x32_bf16 v[40:43], a[24:27], a[0:3], v[40:43]
  ds_read_b64_tr_b16 a[56:57], v12 offset:40960
  buffer_load_dwordx2 v[20:21], v19, s[4:7], s52 offen offset:0 sc1
  v_mfma_f32_16x16x32_bf16 v[56:59], a[24:27], a[4:7], v[56:59]
  ds_read_b64_tr_b16 a[58:59], v12 offset:41984
  buffer_load_dwordx2 v[22:23], v19, s[4:7], s52 offen offset:128 sc1
  v_mfma_f32_16x16x32_bf16 v[72:75], a[24:27], a[8:11], v[72:75]
  ds_read_b64_tr_b16 a[60:61], v13 offset:40960
  buffer_load_dwordx2 v[24:25], v19, s[4:7], s52 offen offset:256 sc1
  v_mfma_f32_16x16x32_bf16 v[88:91], a[24:27], a[12:15], v[88:91]
  ds_read_b64_tr_b16 a[62:63], v13 offset:41984
  buffer_load_dwordx2 v[26:27], v19, s[4:7], s52 offen offset:384 sc1
  s_waitcnt lgkmcnt(12)
  v_mfma_f32_16x16x32_bf16 v[44:47], a[28:31], a[0:3], v[44:47]
  v_mfma_f32_16x16x32_bf16 v[60:63], a[28:31], a[4:7], v[60:63]
  v_mfma_f32_16x16x32_bf16 v[76:79], a[28:31], a[8:11], v[76:79]
  v_mfma_f32_16x16x32_bf16 v[92:95], a[28:31], a[12:15], v[92:95]
  s_waitcnt lgkmcnt(9)
  v_mfma_f32_16x16x32_bf16 v[32:35], a[48:51], a[32:35], v[32:35]
  s_waitcnt lgkmcnt(8)
  v_mfma_f32_16x16x32_bf16 v[48:51], a[48:51], a[36:39], v[48:51]
  s_waitcnt lgkmcnt(7)
  v_mfma_f32_16x16x32_bf16 v[64:67], a[48:51], a[40:43], v[64:67]
  s_waitcnt lgkmcnt(6)
  v_mfma_f32_16x16x32_bf16 v[80:83], a[48:51], a[44:47], v[80:83]
  s_waitcnt lgkmcnt(0)
  s_waitcnt vmcnt(0)
  s_barrier
  ds_read_b64_tr_b16 a[16:17], v14 offset:0
  v_mfma_f32_16x16x32_bf16 v[36:39], a[52:55], a[32:35], v[36:39]
  ds_read_b64_tr_b16 a[18:19], v14 offset:1024
  v_mfma_f32_16x16x32_bf16 v[52:55], a[52:55], a[36:39], v[52:55]
  ds_read_b128 a[0:3], v8 offset:0
  v_mfma_f32_16x16x32_bf16 v[68:71], a[52:55], a[40:43], v[68:71]
  ds_read_b128 a[4:7], v8 offset:256
  v_mfma_f32_16x16x32_bf16 v[84:87], a[52:55], a[44:47], v[84:87]
  ds_read_b128 a[8:11], v8 offset:512
  v_mfma_f32_16x16x32_bf16 v[40:43], a[56:59], a[32:35], v[40:43]
  ds_read_b128 a[12:15], v8 offset:768
  v_mfma_f32_16x16x32_bf16 v[56:59], a[56:59], a[36:39], v[56:59]
  ds_read_b64_tr_b16 a[20:21], v15 offset:0
  v_mfma_f32_16x16x32_bf16 v[72:75], a[56:59], a[40:43], v[72:75]
  ds_read_b64_tr_b16 a[22:23], v15 offset:1024
  v_mfma_f32_16x16x32_bf16 v[88:91], a[56:59], a[44:47], v[88:91]
  ds_read_b64_tr_b16 a[24:25], v16 offset:0
  v_mfma_f32_16x16x32_bf16 v[44:47], a[60:63], a[32:35], v[44:47]
  ds_read_b64_tr_b16 a[26:27], v16 offset:1024
  v_mfma_f32_16x16x32_bf16 v[60:63], a[60:63], a[36:39], v[60:63]
  ds_read_b64_tr_b16 a[28:29], v17 offset:0
  v_mfma_f32_16x16x32_bf16 v[76:79], a[60:63], a[40:43], v[76:79]
  ds_read_b64_tr_b16 a[30:31], v17 offset:1024
  v_mfma_f32_16x16x32_bf16 v[92:95], a[60:63], a[44:47], v[92:95]
  s_waitcnt lgkmcnt(9)
  v_mfma_f32_16x16x32_bf16 v[32:35], a[16:19], a[0:3], v[32:35]
  ds_read_b64_tr_b16 a[48:49], v14 offset:8192
  s_waitcnt lgkmcnt(9)
  v_mfma_f32_16x16x32_bf16 v[48:51], a[16:19], a[4:7], v[48:51]
  ds_read_b64_tr_b16 a[50:51], v14 offset:9216
  s_waitcnt lgkmcnt(9)
  v_mfma_f32_16x16x32_bf16 v[64:67], a[16:19], a[8:11], v[64:67]
  ds_read_b128 a[32:35], v9 offset:0
  s_waitcnt lgkmcnt(9)
  v_mfma_f32_16x16x32_bf16 v[80:83], a[16:19], a[12:15], v[80:83]
  ds_read_b128 a[36:39], v9 offset:256
  s_waitcnt lgkmcnt(8)
  v_mfma_f32_16x16x32_bf16 v[36:39], a[20:23], a[0:3], v[36:39]
  ds_read_b128 a[40:43], v9 offset:512
  v_mfma_f32_16x16x32_bf16 v[52:55], a[20:23], a[4:7], v[52:55]
  ds_read_b128 a[44:47], v9 offset:768
  v_mfma_f32_16x16x32_bf16 v[68:71], a[20:23], a[8:11], v[68:71]
  ds_read_b64_tr_b16 a[52:53], v15 offset:8192
  v_mfma_f32_16x16x32_bf16 v[84:87], a[20:23], a[12:15], v[84:87]
  ds_read_b64_tr_b16 a[54:55], v15 offset:9216
  s_waitcnt lgkmcnt(10)
  v_mfma_f32_16x16x32_bf16 v[40:43], a[24:27], a[0:3], v[40:43]
  ds_read_b64_tr_b16 a[56:57], v16 offset:8192
  v_mfma_f32_16x16x32_bf16 v[56:59], a[24:27], a[4:7], v[56:59]
  ds_read_b64_tr_b16 a[58:59], v16 offset:9216
  v_mfma_f32_16x16x32_bf16 v[72:75], a[24:27], a[8:11], v[72:75]
  ds_read_b64_tr_b16 a[60:61], v17 offset:8192
  v_mfma_f32_16x16x32_bf16 v[88:91], a[24:27], a[12:15], v[88:91]
  ds_read_b64_tr_b16 a[62:63], v17 offset:9216
  s_waitcnt lgkmcnt(12)
  v_mfma_f32_16x16x32_bf16 v[44:47], a[28:31], a[0:3], v[44:47]
  v_mfma_f32_16x16x32_bf16 v[60:63], a[28:31], a[4:7], v[60:63]
  v_mfma_f32_16x16x32_bf16 v[76:79], a[28:31], a[8:11], v[76:79]
  v_mfma_f32_16x16x32_bf16 v[92:95], a[28:31], a[12:15], v[92:95]
  s_waitcnt lgkmcnt(9)
  v_mfma_f32_16x16x32_bf16 v[32:35], a[48:51], a[32:35], v[32:35]
  s_waitcnt lgkmcnt(8)
  v_mfma_f32_16x16x32_bf16 v[48:51], a[48:51], a[36:39], v[48:51]
  s_waitcnt lgkmcnt(7)
  v_mfma_f32_16x16x32_bf16 v[64:67], a[48:51], a[40:43], v[64:67]
  s_waitcnt lgkmcnt(6)
  v_mfma_f32_16x16x32_bf16 v[80:83], a[48:51], a[44:47], v[80:83]
  s_waitcnt lgkmcnt(0)
  s_barrier
  ds_read_b64_tr_b16 a[16:17], v14 offset:32768
  v_mfma_f32_16x16x32_bf16 v[36:39], a[52:55], a[32:35], v[36:39]
  ds_read_b64_tr_b16 a[18:19], v14 offset:33792
  v_mfma_f32_16x16x32_bf16 v[52:55], a[52:55], a[36:39], v[52:55]
  ds_read_b128 a[0:3], v8 offset:32768
  v_mfma_f32_16x16x32_bf16 v[68:71], a[52:55], a[40:43], v[68:71]
  ds_read_b128 a[4:7], v8 offset:33024
  v_mfma_f32_16x16x32_bf16 v[84:87], a[52:55], a[44:47], v[84:87]
  ds_read_b128 a[8:11], v8 offset:33280
  v_mfma_f32_16x16x32_bf16 v[40:43], a[56:59], a[32:35], v[40:43]
  ds_read_b128 a[12:15], v8 offset:33536
  v_mfma_f32_16x16x32_bf16 v[56:59], a[56:59], a[36:39], v[56:59]
  ds_read_b64_tr_b16 a[20:21], v15 offset:32768
  v_mfma_f32_16x16x32_bf16 v[72:75], a[56:59], a[40:43], v[72:75]
  ds_read_b64_tr_b16 a[22:23], v15 offset:33792
  v_mfma_f32_16x16x32_bf16 v[88:91], a[56:59], a[44:47], v[88:91]
  ds_read_b64_tr_b16 a[24:25], v16 offset:32768
  v_mfma_f32_16x16x32_bf16 v[44:47], a[60:63], a[32:35], v[44:47]
  ds_read_b64_tr_b16 a[26:27], v16 offset:33792
  v_mfma_f32_16x16x32_bf16 v[60:63], a[60:63], a[36:39], v[60:63]
  ds_read_b64_tr_b16 a[28:29], v17 offset:32768
  v_mfma_f32_16x16x32_bf16 v[76:79], a[60:63], a[40:43], v[76:79]
  ds_read_b64_tr_b16 a[30:31], v17 offset:33792
  v_mfma_f32_16x16x32_bf16 v[92:95], a[60:63], a[44:47], v[92:95]
  s_waitcnt lgkmcnt(9)
  v_mfma_f32_16x16x32_bf16 v[32:35], a[16:19], a[0:3], v[32:35]
  ds_read_b64_tr_b16 a[48:49], v14 offset:40960
  s_waitcnt lgkmcnt(9)
  v_mfma_f32_16x16x32_bf16 v[48:51], a[16:19], a[4:7], v[48:51]
  ds_read_b64_tr_b16 a[50:51], v14 offset:41984
  s_waitcnt lgkmcnt(9)
  v_mfma_f32_16x16x32_bf16 v[64:67], a[16:19], a[8:11], v[64:67]
  ds_read_b128 a[32:35], v9 offset:32768
  s_waitcnt lgkmcnt(9)
  v_mfma_f32_16x16x32_bf16 v[80:83], a[16:19], a[12:15], v[80:83]
  ds_read_b128 a[36:39], v9 offset:33024
  s_waitcnt lgkmcnt(8)
  v_mfma_f32_16x16x32_bf16 v[36:39], a[20:23], a[0:3], v[36:39]
  ds_read_b128 a[40:43], v9 offset:33280
  v_mfma_f32_16x16x32_bf16 v[52:55], a[20:23], a[4:7], v[52:55]
  ds_read_b128 a[44:47], v9 offset:33536
  v_mfma_f32_16x16x32_bf16 v[68:71], a[20:23], a[8:11], v[68:71]
  ds_read_b64_tr_b16 a[52:53], v15 offset:40960
  v_mfma_f32_16x16x32_bf16 v[84:87], a[20:23], a[12:15], v[84:87]
  ds_read_b64_tr_b16 a[54:55], v15 offset:41984
  s_waitcnt lgkmcnt(10)
  v_mfma_f32_16x16x32_bf16 v[40:43], a[24:27], a[0:3], v[40:43]
  ds_read_b64_tr_b16 a[56:57], v16 offset:40960
  v_mfma_f32_16x16x32_bf16 v[56:59], a[24:27], a[4:7], v[56:59]
  ds_read_b64_tr_b16 a[58:59], v16 offset:41984
  v_mfma_f32_16x16x32_bf16 v[72:75], a[24:27], a[8:11], v[72:75]
  ds_read_b64_tr_b16 a[60:61], v17 offset:40960
  v_mfma_f32_16x16x32_bf16 v[88:91], a[24:27], a[12:15], v[88:91]
  ds_read_b64_tr_b16 a[62:63], v17 offset:41984
  s_waitcnt lgkmcnt(12)
  v_mfma_f32_16x16x32_bf16 v[44:47], a[28:31], a[0:3], v[44:47]
  v_mfma_f32_16x16x32_bf16 v[60:63], a[28:31], a[4:7], v[60:63]
  v_mfma_f32_16x16x32_bf16 v[76:79], a[28:31], a[8:11], v[76:79]
  v_mfma_f32_16x16x32_bf16 v[92:95], a[28:31], a[12:15], v[92:95]
  s_waitcnt lgkmcnt(9)
  v_mfma_f32_16x16x32_bf16 v[32:35], a[48:51], a[32:35], v[32:35]
  s_waitcnt lgkmcnt(8)
  v_mfma_f32_16x16x32_bf16 v[48:51], a[48:51], a[36:39], v[48:51]
  s_waitcnt lgkmcnt(7)
  v_mfma_f32_16x16x32_bf16 v[64:67], a[48:51], a[40:43], v[64:67]
  s_waitcnt lgkmcnt(6)
  v_mfma_f32_16x16x32_bf16 v[80:83], a[48:51], a[44:47], v[80:83]
  s_waitcnt lgkmcnt(0)
  s_barrier
  ds_read_b64_tr_b16 a[16:17], v10 offset:0
  v_mfma_f32_16x16x32_bf16 v[36:39], a[52:55], a[32:35], v[36:39]
  ds_read_b64_tr_b16 a[18:19], v10 offset:1024
  v_mfma_f32_16x16x32_bf16 v[52:55], a[52:55], a[36:39], v[52:55]
  ds_read_b128 a[0:3], v6 offset:0
  v_mfma_f32_16x16x32_bf16 v[68:71], a[52:55], a[40:43], v[68:71]
  ds_read_b128 a[4:7], v6 offset:256
  v_mfma_f32_16x16x32_bf16 v[84:87], a[52:55], a[44:47], v[84:87]
  ds_read_b128 a[8:11], v6 offset:512
  v_mfma_f32_16x16x32_bf16 v[40:43], a[56:59], a[32:35], v[40:43]
  ds_read_b128 a[12:15], v6 offset:768
  v_mfma_f32_16x16x32_bf16 v[56:59], a[56:59], a[36:39], v[56:59]
  ds_read_b64_tr_b16 a[20:21], v11 offset:0
  v_mfma_f32_16x16x32_bf16 v[72:75], a[56:59], a[40:43], v[72:75]
  ds_read_b64_tr_b16 a[22:23], v11 offset:1024
  v_mfma_f32_16x16x32_bf16 v[88:91], a[56:59], a[44:47], v[88:91]
  ds_read_b64_tr_b16 a[24:25], v12 offset:0
  v_mfma_f32_16x16x32_bf16 v[44:47], a[60:63], a[32:35], v[44:47]
  ds_read_b64_tr_b16 a[26:27], v12 offset:1024
  v_mfma_f32_16x16x32_bf16 v[60:63], a[60:63], a[36:39], v[60:63]
  ds_read_b64_tr_b16 a[28:29], v13 offset:0
  v_mfma_f32_16x16x32_bf16 v[76:79], a[60:63], a[40:43], v[76:79]
  ds_read_b64_tr_b16 a[30:31], v13 offset:1024
  v_mfma_f32_16x16x32_bf16 v[92:95], a[60:63], a[44:47], v[92:95]
  s_mov_b32 s32, 1
  .p2align 3
recurrent_scan__ssm_conv_h3__mixer_s_mlp__prompt_kernel_cm501:
  s_waitcnt lgkmcnt(9)
  v_mfma_f32_16x16x32_bf16 v[32:35], a[16:19], a[0:3], v[32:35]
  ds_read_b64_tr_b16 a[48:49], v10 offset:8192
  s_waitcnt lgkmcnt(9)
  v_mfma_f32_16x16x32_bf16 v[48:51], a[16:19], a[4:7], v[48:51]
  ds_read_b64_tr_b16 a[50:51], v10 offset:9216
  s_waitcnt lgkmcnt(9)
  v_mfma_f32_16x16x32_bf16 v[64:67], a[16:19], a[8:11], v[64:67]
  ds_read_b128 a[32:35], v7 offset:0
  s_waitcnt lgkmcnt(9)
  v_mfma_f32_16x16x32_bf16 v[80:83], a[16:19], a[12:15], v[80:83]
  ds_read_b128 a[36:39], v7 offset:256
  s_waitcnt lgkmcnt(8)
  v_mfma_f32_16x16x32_bf16 v[36:39], a[20:23], a[0:3], v[36:39]
  ds_read_b128 a[40:43], v7 offset:512
  v_mfma_f32_16x16x32_bf16 v[52:55], a[20:23], a[4:7], v[52:55]
  ds_read_b128 a[44:47], v7 offset:768
  v_mfma_f32_16x16x32_bf16 v[68:71], a[20:23], a[8:11], v[68:71]
  ds_read_b64_tr_b16 a[52:53], v11 offset:8192
  v_mfma_f32_16x16x32_bf16 v[84:87], a[20:23], a[12:15], v[84:87]
  ds_read_b64_tr_b16 a[54:55], v11 offset:9216
  s_waitcnt lgkmcnt(10)
  v_mfma_f32_16x16x32_bf16 v[40:43], a[24:27], a[0:3], v[40:43]
  ds_read_b64_tr_b16 a[56:57], v12 offset:8192
  v_mfma_f32_16x16x32_bf16 v[56:59], a[24:27], a[4:7], v[56:59]
  ds_read_b64_tr_b16 a[58:59], v12 offset:9216
  v_mfma_f32_16x16x32_bf16 v[72:75], a[24:27], a[8:11], v[72:75]
  ds_read_b64_tr_b16 a[60:61], v13 offset:8192
  v_mfma_f32_16x16x32_bf16 v[88:91], a[24:27], a[12:15], v[88:91]
  ds_read_b64_tr_b16 a[62:63], v13 offset:9216
  s_waitcnt lgkmcnt(12)
  v_mfma_f32_16x16x32_bf16 v[44:47], a[28:31], a[0:3], v[44:47]
  v_mfma_f32_16x16x32_bf16 v[60:63], a[28:31], a[4:7], v[60:63]
  v_mfma_f32_16x16x32_bf16 v[76:79], a[28:31], a[8:11], v[76:79]
  v_mfma_f32_16x16x32_bf16 v[92:95], a[28:31], a[12:15], v[92:95]
  s_waitcnt lgkmcnt(9)
  v_mfma_f32_16x16x32_bf16 v[32:35], a[48:51], a[32:35], v[32:35]
  s_waitcnt lgkmcnt(8)
  v_mfma_f32_16x16x32_bf16 v[48:51], a[48:51], a[36:39], v[48:51]
  s_waitcnt lgkmcnt(7)
  v_mfma_f32_16x16x32_bf16 v[64:67], a[48:51], a[40:43], v[64:67]
  s_waitcnt lgkmcnt(6)
  v_mfma_f32_16x16x32_bf16 v[80:83], a[48:51], a[44:47], v[80:83]
  s_waitcnt lgkmcnt(0)
  s_barrier
  ds_read_b64_tr_b16 a[16:17], v10 offset:32768
  v_mfma_f32_16x16x32_bf16 v[36:39], a[52:55], a[32:35], v[36:39]
  ds_read_b64_tr_b16 a[18:19], v10 offset:33792
  v_mfma_f32_16x16x32_bf16 v[52:55], a[52:55], a[36:39], v[52:55]
  ds_read_b128 a[0:3], v6 offset:32768
  v_mfma_f32_16x16x32_bf16 v[68:71], a[52:55], a[40:43], v[68:71]
  ds_read_b128 a[4:7], v6 offset:33024
  v_mfma_f32_16x16x32_bf16 v[84:87], a[52:55], a[44:47], v[84:87]
  ds_read_b128 a[8:11], v6 offset:33280
  v_mfma_f32_16x16x32_bf16 v[40:43], a[56:59], a[32:35], v[40:43]
  ds_read_b128 a[12:15], v6 offset:33536
  v_mfma_f32_16x16x32_bf16 v[56:59], a[56:59], a[36:39], v[56:59]
  ds_read_b64_tr_b16 a[20:21], v11 offset:32768
  v_mfma_f32_16x16x32_bf16 v[72:75], a[56:59], a[40:43], v[72:75]
  ds_read_b64_tr_b16 a[22:23], v11 offset:33792
  v_mfma_f32_16x16x32_bf16 v[88:91], a[56:59], a[44:47], v[88:91]
  ds_read_b64_tr_b16 a[24:25], v12 offset:32768
  v_mfma_f32_16x16x32_bf16 v[44:47], a[60:63], a[32:35], v[44:47]
  ds_read_b64_tr_b16 a[26:27], v12 offset:33792
  v_mfma_f32_16x16x32_bf16 v[60:63], a[60:63], a[36:39], v[60:63]
  ds_read_b64_tr_b16 a[28:29], v13 offset:32768
  v_mfma_f32_16x16x32_bf16 v[76:79], a[60:63], a[40:43], v[76:79]
  ds_read_b64_tr_b16 a[30:31], v13 offset:33792
  v_mfma_f32_16x16x32_bf16 v[92:95], a[60:63], a[44:47], v[92:95]
  s_waitcnt lgkmcnt(9)
  v_mfma_f32_16x16x32_bf16 v[32:35], a[16:19], a[0:3], v[32:35]
  ds_read_b64_tr_b16 a[48:49], v10 offset:40960
  s_waitcnt lgkmcnt(9)
  v_mfma_f32_16x16x32_bf16 v[48:51], a[16:19], a[4:7], v[48:51]
  ds_read_b64_tr_b16 a[50:51], v10 offset:41984
  s_waitcnt lgkmcnt(9)
  v_mfma_f32_16x16x32_bf16 v[64:67], a[16:19], a[8:11], v[64:67]
  ds_read_b128 a[32:35], v7 offset:32768
  s_waitcnt lgkmcnt(9)
  v_mfma_f32_16x16x32_bf16 v[80:83], a[16:19], a[12:15], v[80:83]
  ds_read_b128 a[36:39], v7 offset:33024
  s_waitcnt lgkmcnt(8)
  v_mfma_f32_16x16x32_bf16 v[36:39], a[20:23], a[0:3], v[36:39]
  ds_read_b128 a[40:43], v7 offset:33280
  v_mfma_f32_16x16x32_bf16 v[52:55], a[20:23], a[4:7], v[52:55]
  ds_read_b128 a[44:47], v7 offset:33536
  v_mfma_f32_16x16x32_bf16 v[68:71], a[20:23], a[8:11], v[68:71]
  ds_read_b64_tr_b16 a[52:53], v11 offset:40960
  v_mfma_f32_16x16x32_bf16 v[84:87], a[20:23], a[12:15], v[84:87]
  ds_read_b64_tr_b16 a[54:55], v11 offset:41984
  s_waitcnt lgkmcnt(10)
  v_mfma_f32_16x16x32_bf16 v[40:43], a[24:27], a[0:3], v[40:43]
  ds_read_b64_tr_b16 a[56:57], v12 offset:40960
  v_mfma_f32_16x16x32_bf16 v[56:59], a[24:27], a[4:7], v[56:59]
  ds_read_b64_tr_b16 a[58:59], v12 offset:41984
  v_mfma_f32_16x16x32_bf16 v[72:75], a[24:27], a[8:11], v[72:75]
  ds_read_b64_tr_b16 a[60:61], v13 offset:40960
  v_mfma_f32_16x16x32_bf16 v[88:91], a[24:27], a[12:15], v[88:91]
  ds_read_b64_tr_b16 a[62:63], v13 offset:41984
  s_waitcnt lgkmcnt(12)
  v_mfma_f32_16x16x32_bf16 v[44:47], a[28:31], a[0:3], v[44:47]
  v_mfma_f32_16x16x32_bf16 v[60:63], a[28:31], a[4:7], v[60:63]
  v_mfma_f32_16x16x32_bf16 v[76:79], a[28:31], a[8:11], v[76:79]
  v_mfma_f32_16x16x32_bf16 v[92:95], a[28:31], a[12:15], v[92:95]
  s_waitcnt lgkmcnt(9)
  v_mfma_f32_16x16x32_bf16 v[32:35], a[48:51], a[32:35], v[32:35]
  s_waitcnt lgkmcnt(8)
  v_mfma_f32_16x16x32_bf16 v[48:51], a[48:51], a[36:39], v[48:51]
  s_waitcnt lgkmcnt(7)
  v_mfma_f32_16x16x32_bf16 v[64:67], a[48:51], a[40:43], v[64:67]
  s_waitcnt lgkmcnt(6)
  v_mfma_f32_16x16x32_bf16 v[80:83], a[48:51], a[44:47], v[80:83]
  s_waitcnt lgkmcnt(0)
  s_barrier
  ds_read_b64_tr_b16 a[16:17], v14 offset:0
  v_mfma_f32_16x16x32_bf16 v[36:39], a[52:55], a[32:35], v[36:39]
  ds_read_b64_tr_b16 a[18:19], v14 offset:1024
  v_mfma_f32_16x16x32_bf16 v[52:55], a[52:55], a[36:39], v[52:55]
  ds_read_b128 a[0:3], v8 offset:0
  v_mfma_f32_16x16x32_bf16 v[68:71], a[52:55], a[40:43], v[68:71]
  ds_read_b128 a[4:7], v8 offset:256
  v_mfma_f32_16x16x32_bf16 v[84:87], a[52:55], a[44:47], v[84:87]
  ds_read_b128 a[8:11], v8 offset:512
  v_mfma_f32_16x16x32_bf16 v[40:43], a[56:59], a[32:35], v[40:43]
  ds_read_b128 a[12:15], v8 offset:768
  v_mfma_f32_16x16x32_bf16 v[56:59], a[56:59], a[36:39], v[56:59]
  ds_read_b64_tr_b16 a[20:21], v15 offset:0
  v_mfma_f32_16x16x32_bf16 v[72:75], a[56:59], a[40:43], v[72:75]
  ds_read_b64_tr_b16 a[22:23], v15 offset:1024
  v_mfma_f32_16x16x32_bf16 v[88:91], a[56:59], a[44:47], v[88:91]
  ds_read_b64_tr_b16 a[24:25], v16 offset:0
  v_mfma_f32_16x16x32_bf16 v[44:47], a[60:63], a[32:35], v[44:47]
  ds_read_b64_tr_b16 a[26:27], v16 offset:1024
  v_mfma_f32_16x16x32_bf16 v[60:63], a[60:63], a[36:39], v[60:63]
  ds_read_b64_tr_b16 a[28:29], v17 offset:0
  v_mfma_f32_16x16x32_bf16 v[76:79], a[60:63], a[40:43], v[76:79]
  ds_read_b64_tr_b16 a[30:31], v17 offset:1024
  v_mfma_f32_16x16x32_bf16 v[92:95], a[60:63], a[44:47], v[92:95]
  s_waitcnt lgkmcnt(9)
  v_mfma_f32_16x16x32_bf16 v[32:35], a[16:19], a[0:3], v[32:35]
  ds_read_b64_tr_b16 a[48:49], v14 offset:8192
  s_waitcnt lgkmcnt(9)
  v_mfma_f32_16x16x32_bf16 v[48:51], a[16:19], a[4:7], v[48:51]
  ds_read_b64_tr_b16 a[50:51], v14 offset:9216
  s_waitcnt lgkmcnt(9)
  v_mfma_f32_16x16x32_bf16 v[64:67], a[16:19], a[8:11], v[64:67]
  ds_read_b128 a[32:35], v9 offset:0
  s_waitcnt lgkmcnt(9)
  v_mfma_f32_16x16x32_bf16 v[80:83], a[16:19], a[12:15], v[80:83]
  ds_read_b128 a[36:39], v9 offset:256
  s_waitcnt lgkmcnt(8)
  v_mfma_f32_16x16x32_bf16 v[36:39], a[20:23], a[0:3], v[36:39]
  ds_read_b128 a[40:43], v9 offset:512
  v_mfma_f32_16x16x32_bf16 v[52:55], a[20:23], a[4:7], v[52:55]
  ds_read_b128 a[44:47], v9 offset:768
  v_mfma_f32_16x16x32_bf16 v[68:71], a[20:23], a[8:11], v[68:71]
  ds_read_b64_tr_b16 a[52:53], v15 offset:8192
  v_mfma_f32_16x16x32_bf16 v[84:87], a[20:23], a[12:15], v[84:87]
  ds_read_b64_tr_b16 a[54:55], v15 offset:9216
  s_waitcnt lgkmcnt(10)
  v_mfma_f32_16x16x32_bf16 v[40:43], a[24:27], a[0:3], v[40:43]
  ds_read_b64_tr_b16 a[56:57], v16 offset:8192
  v_mfma_f32_16x16x32_bf16 v[56:59], a[24:27], a[4:7], v[56:59]
  ds_read_b64_tr_b16 a[58:59], v16 offset:9216
  v_mfma_f32_16x16x32_bf16 v[72:75], a[24:27], a[8:11], v[72:75]
  ds_read_b64_tr_b16 a[60:61], v17 offset:8192
  v_mfma_f32_16x16x32_bf16 v[88:91], a[24:27], a[12:15], v[88:91]
  ds_read_b64_tr_b16 a[62:63], v17 offset:9216
  s_waitcnt lgkmcnt(12)
  v_mfma_f32_16x16x32_bf16 v[44:47], a[28:31], a[0:3], v[44:47]
  v_mfma_f32_16x16x32_bf16 v[60:63], a[28:31], a[4:7], v[60:63]
  v_mfma_f32_16x16x32_bf16 v[76:79], a[28:31], a[8:11], v[76:79]
  v_mfma_f32_16x16x32_bf16 v[92:95], a[28:31], a[12:15], v[92:95]
  s_waitcnt lgkmcnt(9)
  v_mfma_f32_16x16x32_bf16 v[32:35], a[48:51], a[32:35], v[32:35]
  s_waitcnt lgkmcnt(8)
  v_mfma_f32_16x16x32_bf16 v[48:51], a[48:51], a[36:39], v[48:51]
  s_waitcnt lgkmcnt(7)
  v_mfma_f32_16x16x32_bf16 v[64:67], a[48:51], a[40:43], v[64:67]
  s_waitcnt lgkmcnt(6)
  v_mfma_f32_16x16x32_bf16 v[80:83], a[48:51], a[44:47], v[80:83]
  s_waitcnt lgkmcnt(0)
  s_barrier
  ds_read_b64_tr_b16 a[16:17], v14 offset:32768
  v_mfma_f32_16x16x32_bf16 v[36:39], a[52:55], a[32:35], v[36:39]
  ds_read_b64_tr_b16 a[18:19], v14 offset:33792
  v_mfma_f32_16x16x32_bf16 v[52:55], a[52:55], a[36:39], v[52:55]
  ds_read_b128 a[0:3], v8 offset:32768
  v_mfma_f32_16x16x32_bf16 v[68:71], a[52:55], a[40:43], v[68:71]
  ds_read_b128 a[4:7], v8 offset:33024
  v_mfma_f32_16x16x32_bf16 v[84:87], a[52:55], a[44:47], v[84:87]
  ds_read_b128 a[8:11], v8 offset:33280
  v_mfma_f32_16x16x32_bf16 v[40:43], a[56:59], a[32:35], v[40:43]
  ds_read_b128 a[12:15], v8 offset:33536
  v_mfma_f32_16x16x32_bf16 v[56:59], a[56:59], a[36:39], v[56:59]
  ds_read_b64_tr_b16 a[20:21], v15 offset:32768
  v_mfma_f32_16x16x32_bf16 v[72:75], a[56:59], a[40:43], v[72:75]
  ds_read_b64_tr_b16 a[22:23], v15 offset:33792
  v_mfma_f32_16x16x32_bf16 v[88:91], a[56:59], a[44:47], v[88:91]
  ds_read_b64_tr_b16 a[24:25], v16 offset:32768
  v_mfma_f32_16x16x32_bf16 v[44:47], a[60:63], a[32:35], v[44:47]
  ds_read_b64_tr_b16 a[26:27], v16 offset:33792
  v_mfma_f32_16x16x32_bf16 v[60:63], a[60:63], a[36:39], v[60:63]
  ds_read_b64_tr_b16 a[28:29], v17 offset:32768
  v_mfma_f32_16x16x32_bf16 v[76:79], a[60:63], a[40:43], v[76:79]
  ds_read_b64_tr_b16 a[30:31], v17 offset:33792
  v_mfma_f32_16x16x32_bf16 v[92:95], a[60:63], a[44:47], v[92:95]
  s_waitcnt lgkmcnt(9)
  v_mfma_f32_16x16x32_bf16 v[32:35], a[16:19], a[0:3], v[32:35]
  ds_read_b64_tr_b16 a[48:49], v14 offset:40960
  s_waitcnt lgkmcnt(9)
  v_mfma_f32_16x16x32_bf16 v[48:51], a[16:19], a[4:7], v[48:51]
  ds_read_b64_tr_b16 a[50:51], v14 offset:41984
  s_waitcnt lgkmcnt(9)
  v_mfma_f32_16x16x32_bf16 v[64:67], a[16:19], a[8:11], v[64:67]
  ds_read_b128 a[32:35], v9 offset:32768
  s_waitcnt lgkmcnt(9)
  v_mfma_f32_16x16x32_bf16 v[80:83], a[16:19], a[12:15], v[80:83]
  ds_read_b128 a[36:39], v9 offset:33024
  s_waitcnt lgkmcnt(8)
  v_mfma_f32_16x16x32_bf16 v[36:39], a[20:23], a[0:3], v[36:39]
  ds_read_b128 a[40:43], v9 offset:33280
  v_mfma_f32_16x16x32_bf16 v[52:55], a[20:23], a[4:7], v[52:55]
  ds_read_b128 a[44:47], v9 offset:33536
  v_mfma_f32_16x16x32_bf16 v[68:71], a[20:23], a[8:11], v[68:71]
  ds_read_b64_tr_b16 a[52:53], v15 offset:40960
  v_mfma_f32_16x16x32_bf16 v[84:87], a[20:23], a[12:15], v[84:87]
  ds_read_b64_tr_b16 a[54:55], v15 offset:41984
  s_waitcnt lgkmcnt(10)
  v_mfma_f32_16x16x32_bf16 v[40:43], a[24:27], a[0:3], v[40:43]
  ds_read_b64_tr_b16 a[56:57], v16 offset:40960
  v_mfma_f32_16x16x32_bf16 v[56:59], a[24:27], a[4:7], v[56:59]
  ds_read_b64_tr_b16 a[58:59], v16 offset:41984
  v_mfma_f32_16x16x32_bf16 v[72:75], a[24:27], a[8:11], v[72:75]
  ds_read_b64_tr_b16 a[60:61], v17 offset:40960
  v_mfma_f32_16x16x32_bf16 v[88:91], a[24:27], a[12:15], v[88:91]
  ds_read_b64_tr_b16 a[62:63], v17 offset:41984
  s_waitcnt lgkmcnt(12)
  v_mfma_f32_16x16x32_bf16 v[44:47], a[28:31], a[0:3], v[44:47]
  v_mfma_f32_16x16x32_bf16 v[60:63], a[28:31], a[4:7], v[60:63]
  v_mfma_f32_16x16x32_bf16 v[76:79], a[28:31], a[8:11], v[76:79]
  v_mfma_f32_16x16x32_bf16 v[92:95], a[28:31], a[12:15], v[92:95]
  s_waitcnt lgkmcnt(9)
  v_mfma_f32_16x16x32_bf16 v[32:35], a[48:51], a[32:35], v[32:35]
  s_waitcnt lgkmcnt(8)
  v_mfma_f32_16x16x32_bf16 v[48:51], a[48:51], a[36:39], v[48:51]
  s_waitcnt lgkmcnt(7)
  v_mfma_f32_16x16x32_bf16 v[64:67], a[48:51], a[40:43], v[64:67]
  s_waitcnt lgkmcnt(6)
  v_mfma_f32_16x16x32_bf16 v[80:83], a[48:51], a[44:47], v[80:83]
  s_waitcnt lgkmcnt(0)
  s_barrier
  ds_read_b64_tr_b16 a[16:17], v10 offset:0
  v_mfma_f32_16x16x32_bf16 v[36:39], a[52:55], a[32:35], v[36:39]
  ds_read_b64_tr_b16 a[18:19], v10 offset:1024
  v_mfma_f32_16x16x32_bf16 v[52:55], a[52:55], a[36:39], v[52:55]
  ds_read_b128 a[0:3], v6 offset:0
  v_mfma_f32_16x16x32_bf16 v[68:71], a[52:55], a[40:43], v[68:71]
  ds_read_b128 a[4:7], v6 offset:256
  v_mfma_f32_16x16x32_bf16 v[84:87], a[52:55], a[44:47], v[84:87]
  ds_read_b128 a[8:11], v6 offset:512
  v_mfma_f32_16x16x32_bf16 v[40:43], a[56:59], a[32:35], v[40:43]
  ds_read_b128 a[12:15], v6 offset:768
  v_mfma_f32_16x16x32_bf16 v[56:59], a[56:59], a[36:39], v[56:59]
  ds_read_b64_tr_b16 a[20:21], v11 offset:0
  v_mfma_f32_16x16x32_bf16 v[72:75], a[56:59], a[40:43], v[72:75]
  ds_read_b64_tr_b16 a[22:23], v11 offset:1024
  v_mfma_f32_16x16x32_bf16 v[88:91], a[56:59], a[44:47], v[88:91]
  ds_read_b64_tr_b16 a[24:25], v12 offset:0
  v_mfma_f32_16x16x32_bf16 v[44:47], a[60:63], a[32:35], v[44:47]
  ds_read_b64_tr_b16 a[26:27], v12 offset:1024
  v_mfma_f32_16x16x32_bf16 v[60:63], a[60:63], a[36:39], v[60:63]
  ds_read_b64_tr_b16 a[28:29], v13 offset:0
  v_mfma_f32_16x16x32_bf16 v[76:79], a[60:63], a[40:43], v[76:79]
  ds_read_b64_tr_b16 a[30:31], v13 offset:1024
  v_mfma_f32_16x16x32_bf16 v[92:95], a[60:63], a[44:47], v[92:95]
  s_sub_u32 s32, s32, 1
  s_cmp_lg_u32 s32, 0
  s_cbranch_scc1 recurrent_scan__ssm_conv_h3__mixer_s_mlp__prompt_kernel_cm501
  s_waitcnt lgkmcnt(9)
  v_mfma_f32_16x16x32_bf16 v[32:35], a[16:19], a[0:3], v[32:35]
  ds_read_b64_tr_b16 a[48:49], v10 offset:8192
  s_waitcnt vmcnt(0)
  s_waitcnt lgkmcnt(9)
  v_mfma_f32_16x16x32_bf16 v[48:51], a[16:19], a[4:7], v[48:51]
  ds_read_b64_tr_b16 a[50:51], v10 offset:9216
  ds_read_b64 v[96:97], v18 offset:0
  s_waitcnt lgkmcnt(9)
  v_mfma_f32_16x16x32_bf16 v[64:67], a[16:19], a[8:11], v[64:67]
  ds_read_b128 a[32:35], v7 offset:0
  ds_read_b64 v[98:99], v30 offset:0
  s_waitcnt lgkmcnt(9)
  v_mfma_f32_16x16x32_bf16 v[80:83], a[16:19], a[12:15], v[80:83]
  ds_read_b128 a[36:39], v7 offset:256
  ds_read_b64 v[100:101], v31 offset:0
  s_waitcnt lgkmcnt(8)
  v_mfma_f32_16x16x32_bf16 v[36:39], a[20:23], a[0:3], v[36:39]
  ds_read_b128 a[40:43], v7 offset:512
  ds_read_b64 v[102:103], v5 offset:0
  v_mfma_f32_16x16x32_bf16 v[52:55], a[20:23], a[4:7], v[52:55]
  ds_read_b128 a[44:47], v7 offset:768
  ds_read_b64 v[104:105], v18 offset:4096
  v_mfma_f32_16x16x32_bf16 v[68:71], a[20:23], a[8:11], v[68:71]
  ds_read_b64_tr_b16 a[52:53], v11 offset:8192
  ds_read_b64 v[106:107], v30 offset:4096
  v_mfma_f32_16x16x32_bf16 v[84:87], a[20:23], a[12:15], v[84:87]
  ds_read_b64_tr_b16 a[54:55], v11 offset:9216
  ds_read_b64 v[108:109], v31 offset:4096
  s_waitcnt lgkmcnt(10)
  v_mfma_f32_16x16x32_bf16 v[40:43], a[24:27], a[0:3], v[40:43]
  ds_read_b64_tr_b16 a[56:57], v12 offset:8192
  ds_read_b64 v[110:111], v5 offset:4096
  v_mfma_f32_16x16x32_bf16 v[56:59], a[24:27], a[4:7], v[56:59]
  ds_read_b64_tr_b16 a[58:59], v12 offset:9216
  ds_read_b64 v[112:113], v18 offset:8192
  v_mfma_f32_16x16x32_bf16 v[72:75], a[24:27], a[8:11], v[72:75]
  ds_read_b64_tr_b16 a[60:61], v13 offset:8192
  ds_read_b64 v[114:115], v30 offset:8192
  v_mfma_f32_16x16x32_bf16 v[88:91], a[24:27], a[12:15], v[88:91]
  ds_read_b64_tr_b16 a[62:63], v13 offset:9216
  ds_read_b64 v[116:117], v31 offset:8192
  s_waitcnt lgkmcnt(12)
  v_mfma_f32_16x16x32_bf16 v[44:47], a[28:31], a[0:3], v[44:47]
  ds_read_b64 v[118:119], v5 offset:8192
  v_mfma_f32_16x16x32_bf16 v[60:63], a[28:31], a[4:7], v[60:63]
  ds_read_b64 v[120:121], v18 offset:12288
  v_mfma_f32_16x16x32_bf16 v[76:79], a[28:31], a[8:11], v[76:79]
  ds_read_b64 v[122:123], v30 offset:12288
  v_mfma_f32_16x16x32_bf16 v[92:95], a[28:31], a[12:15], v[92:95]
  ds_read_b64 v[124:125], v31 offset:12288
  s_waitcnt lgkmcnt(9)
  v_mfma_f32_16x16x32_bf16 v[32:35], a[48:51], a[32:35], v[32:35]
  ds_read_b64 v[126:127], v5 offset:12288
  s_waitcnt lgkmcnt(8)
  v_mfma_f32_16x16x32_bf16 v[48:51], a[48:51], a[36:39], v[48:51]
  s_nop 0
  s_waitcnt lgkmcnt(7)
  v_mfma_f32_16x16x32_bf16 v[64:67], a[48:51], a[40:43], v[64:67]
  s_nop 0
  s_waitcnt lgkmcnt(6)
  v_mfma_f32_16x16x32_bf16 v[80:83], a[48:51], a[44:47], v[80:83]
  s_waitcnt lgkmcnt(0)
  s_barrier
  ds_read_b64_tr_b16 a[16:17], v10 offset:32768
  s_nop 0
  v_mfma_f32_16x16x32_bf16 v[36:39], a[52:55], a[32:35], v[36:39]
  ds_read_b64_tr_b16 a[18:19], v10 offset:33792
  s_nop 0
  v_mfma_f32_16x16x32_bf16 v[52:55], a[52:55], a[36:39], v[52:55]
  ds_read_b128 a[0:3], v6 offset:32768
  s_waitcnt lgkmcnt(0)
  v_mfma_f32_16x16x32_bf16 v[68:71], a[52:55], a[40:43], v[68:71]
  ds_read_b128 a[4:7], v6 offset:33024
  v_lshlrev_b32 v136, 16, v100
  v_mfma_f32_16x16x32_bf16 v[84:87], a[52:55], a[44:47], v[84:87]
  ds_read_b128 a[8:11], v6 offset:33280
  v_and_b32 v137, 0xffff0000, v100
  v_mfma_f32_16x16x32_bf16 v[40:43], a[56:59], a[32:35], v[40:43]
  ds_read_b128 a[12:15], v6 offset:33536
  v_lshlrev_b32 v138, 16, v101
  v_mfma_f32_16x16x32_bf16 v[56:59], a[56:59], a[36:39], v[56:59]
  ds_read_b64_tr_b16 a[20:21], v11 offset:32768
  v_and_b32 v139, 0xffff0000, v101
  v_mfma_f32_16x16x32_bf16 v[72:75], a[56:59], a[40:43], v[72:75]
  ds_read_b64_tr_b16 a[22:23], v11 offset:33792
  v_lshlrev_b32 v140, 16, v102
  v_mfma_f32_16x16x32_bf16 v[88:91], a[56:59], a[44:47], v[88:91]
  ds_read_b64_tr_b16 a[24:25], v12 offset:32768
  v_and_b32 v141, 0xffff0000, v102
  v_mfma_f32_16x16x32_bf16 v[44:47], a[60:63], a[32:35], v[44:47]
  ds_read_b64_tr_b16 a[26:27], v12 offset:33792
  v_lshlrev_b32 v142, 16, v103
  v_mfma_f32_16x16x32_bf16 v[60:63], a[60:63], a[36:39], v[60:63]
  ds_read_b64_tr_b16 a[28:29], v13 offset:32768
  v_and_b32 v143, 0xffff0000, v103
  v_mfma_f32_16x16x32_bf16 v[76:79], a[60:63], a[40:43], v[76:79]
  ds_read_b64_tr_b16 a[30:31], v13 offset:33792
  v_fma_f32 v136, v136, v21, v20
  v_mfma_f32_16x16x32_bf16 v[92:95], a[60:63], a[44:47], v[92:95]
  v_fma_f32 v137, v137, v21, v20
  s_waitcnt lgkmcnt(9)
  v_mfma_f32_16x16x32_bf16 v[32:35], a[16:19], a[0:3], v[32:35]
  ds_read_b64_tr_b16 a[48:49], v10 offset:40960
  v_fma_f32 v138, v138, v21, v20
  s_waitcnt lgkmcnt(9)
  v_mfma_f32_16x16x32_bf16 v[48:51], a[16:19], a[4:7], v[48:51]
  ds_read_b64_tr_b16 a[50:51], v10 offset:41984
  v_fma_f32 v139, v139, v21, v20
  s_waitcnt lgkmcnt(9)
  v_mfma_f32_16x16x32_bf16 v[64:67], a[16:19], a[8:11], v[64:67]
  ds_read_b128 a[32:35], v7 offset:32768
  v_fma_f32 v140, v140, v21, v20
  s_waitcnt lgkmcnt(9)
  v_mfma_f32_16x16x32_bf16 v[80:83], a[16:19], a[12:15], v[80:83]
  ds_read_b128 a[36:39], v7 offset:33024
  v_fma_f32 v141, v141, v21, v20
  s_waitcnt lgkmcnt(8)
  v_mfma_f32_16x16x32_bf16 v[36:39], a[20:23], a[0:3], v[36:39]
  ds_read_b128 a[40:43], v7 offset:33280
  v_fma_f32 v142, v142, v21, v20
  v_mfma_f32_16x16x32_bf16 v[52:55], a[20:23], a[4:7], v[52:55]
  ds_read_b128 a[44:47], v7 offset:33536
  v_fma_f32 v143, v143, v21, v20
  v_mfma_f32_16x16x32_bf16 v[68:71], a[20:23], a[8:11], v[68:71]
  ds_read_b64_tr_b16 a[52:53], v11 offset:40960
  v_lshlrev_b32 v152, 16, v108
  v_mfma_f32_16x16x32_bf16 v[84:87], a[20:23], a[12:15], v[84:87]
  ds_read_b64_tr_b16 a[54:55], v11 offset:41984
  v_and_b32 v153, 0xffff0000, v108
  s_waitcnt lgkmcnt(10)
  v_mfma_f32_16x16x32_bf16 v[40:43], a[24:27], a[0:3], v[40:43]
  ds_read_b64_tr_b16 a[56:57], v12 offset:40960
  v_lshlrev_b32 v154, 16, v109
  v_mfma_f32_16x16x32_bf16 v[56:59], a[24:27], a[4:7], v[56:59]
  ds_read_b64_tr_b16 a[58:59], v12 offset:41984
  v_and_b32 v155, 0xffff0000, v109
  v_mfma_f32_16x16x32_bf16 v[72:75], a[24:27], a[8:11], v[72:75]
  ds_read_b64_tr_b16 a[60:61], v13 offset:40960
  v_lshlrev_b32 v156, 16, v110
  v_mfma_f32_16x16x32_bf16 v[88:91], a[24:27], a[12:15], v[88:91]
  ds_read_b64_tr_b16 a[62:63], v13 offset:41984
  v_and_b32 v157, 0xffff0000, v110
  s_waitcnt lgkmcnt(12)
  v_mfma_f32_16x16x32_bf16 v[44:47], a[28:31], a[0:3], v[44:47]
  v_lshlrev_b32_e64 v158, 16, v111
  v_mfma_f32_16x16x32_bf16 v[60:63], a[28:31], a[4:7], v[60:63]
  v_and_b32 v159, 0xffff0000, v111
  v_mfma_f32_16x16x32_bf16 v[76:79], a[28:31], a[8:11], v[76:79]
  v_fma_f32 v152, v152, v23, v22
  v_mfma_f32_16x16x32_bf16 v[92:95], a[28:31], a[12:15], v[92:95]
  v_fma_f32 v153, v153, v23, v22
  s_waitcnt lgkmcnt(9)
  v_mfma_f32_16x16x32_bf16 v[32:35], a[48:51], a[32:35], v[32:35]
  v_fma_f32 v154, v154, v23, v22
  s_waitcnt lgkmcnt(8)
  v_mfma_f32_16x16x32_bf16 v[48:51], a[48:51], a[36:39], v[48:51]
  v_fma_f32 v155, v155, v23, v22
  s_waitcnt lgkmcnt(7)
  v_mfma_f32_16x16x32_bf16 v[64:67], a[48:51], a[40:43], v[64:67]
  v_fma_f32 v156, v156, v23, v22
  s_waitcnt lgkmcnt(6)
  v_mfma_f32_16x16x32_bf16 v[80:83], a[48:51], a[44:47], v[80:83]
  s_waitcnt lgkmcnt(0)
  s_barrier
  ds_read_b64_tr_b16 a[16:17], v14 offset:0
  v_fma_f32 v157, v157, v23, v22
  v_mfma_f32_16x16x32_bf16 v[36:39], a[52:55], a[32:35], v[36:39]
  ds_read_b64_tr_b16 a[18:19], v14 offset:1024
  v_fma_f32 v158, v158, v23, v22
  v_mfma_f32_16x16x32_bf16 v[52:55], a[52:55], a[36:39], v[52:55]
  ds_read_b128 a[0:3], v8 offset:0
  v_fma_f32 v159, v159, v23, v22
  v_mfma_f32_16x16x32_bf16 v[68:71], a[52:55], a[40:43], v[68:71]
  ds_read_b128 a[4:7], v8 offset:256
  v_lshlrev_b32 v168, 16, v116
  v_mfma_f32_16x16x32_bf16 v[84:87], a[52:55], a[44:47], v[84:87]
  ds_read_b128 a[8:11], v8 offset:512
  v_and_b32 v169, 0xffff0000, v116
  v_mfma_f32_16x16x32_bf16 v[40:43], a[56:59], a[32:35], v[40:43]
  ds_read_b128 a[12:15], v8 offset:768
  v_lshlrev_b32 v170, 16, v117
  v_mfma_f32_16x16x32_bf16 v[56:59], a[56:59], a[36:39], v[56:59]
  ds_read_b64_tr_b16 a[20:21], v15 offset:0
  v_and_b32 v171, 0xffff0000, v117
  v_mfma_f32_16x16x32_bf16 v[72:75], a[56:59], a[40:43], v[72:75]
  ds_read_b64_tr_b16 a[22:23], v15 offset:1024
  v_lshlrev_b32 v172, 16, v118
  v_mfma_f32_16x16x32_bf16 v[88:91], a[56:59], a[44:47], v[88:91]
  ds_read_b64_tr_b16 a[24:25], v16 offset:0
  v_and_b32 v173, 0xffff0000, v118
  v_mfma_f32_16x16x32_bf16 v[44:47], a[60:63], a[32:35], v[44:47]
  ds_read_b64_tr_b16 a[26:27], v16 offset:1024
  v_lshlrev_b32 v174, 16, v119
  v_mfma_f32_16x16x32_bf16 v[60:63], a[60:63], a[36:39], v[60:63]
  ds_read_b64_tr_b16 a[28:29], v17 offset:0
  v_and_b32 v175, 0xffff0000, v119
  v_mfma_f32_16x16x32_bf16 v[76:79], a[60:63], a[40:43], v[76:79]
  ds_read_b64_tr_b16 a[30:31], v17 offset:1024
  v_fma_f32 v168, v168, v25, v24
  v_mfma_f32_16x16x32_bf16 v[92:95], a[60:63], a[44:47], v[92:95]
  v_fma_f32 v169, v169, v25, v24
  s_waitcnt lgkmcnt(9)
  v_mfma_f32_16x16x32_bf16 v[32:35], a[16:19], a[0:3], v[32:35]
  ds_read_b64_tr_b16 a[48:49], v14 offset:8192
  v_fma_f32 v170, v170, v25, v24
  s_waitcnt lgkmcnt(9)
  v_mfma_f32_16x16x32_bf16 v[48:51], a[16:19], a[4:7], v[48:51]
  ds_read_b64_tr_b16 a[50:51], v14 offset:9216
  v_fma_f32 v171, v171, v25, v24
  s_waitcnt lgkmcnt(9)
  v_mfma_f32_16x16x32_bf16 v[64:67], a[16:19], a[8:11], v[64:67]
  ds_read_b128 a[32:35], v9 offset:0
  v_fma_f32 v172, v172, v25, v24
  s_waitcnt lgkmcnt(9)
  v_mfma_f32_16x16x32_bf16 v[80:83], a[16:19], a[12:15], v[80:83]
  ds_read_b128 a[36:39], v9 offset:256
  v_fma_f32 v173, v173, v25, v24
  s_waitcnt lgkmcnt(8)
  v_mfma_f32_16x16x32_bf16 v[36:39], a[20:23], a[0:3], v[36:39]
  ds_read_b128 a[40:43], v9 offset:512
  v_fma_f32 v174, v174, v25, v24
  v_mfma_f32_16x16x32_bf16 v[52:55], a[20:23], a[4:7], v[52:55]
  ds_read_b128 a[44:47], v9 offset:768
  v_fma_f32 v175, v175, v25, v24
  v_mfma_f32_16x16x32_bf16 v[68:71], a[20:23], a[8:11], v[68:71]
  ds_read_b64_tr_b16 a[52:53], v15 offset:8192
  v_lshlrev_b32 v184, 16, v124
  v_mfma_f32_16x16x32_bf16 v[84:87], a[20:23], a[12:15], v[84:87]
  ds_read_b64_tr_b16 a[54:55], v15 offset:9216
  v_and_b32 v185, 0xffff0000, v124
  s_waitcnt lgkmcnt(10)
  v_mfma_f32_16x16x32_bf16 v[40:43], a[24:27], a[0:3], v[40:43]
  ds_read_b64_tr_b16 a[56:57], v16 offset:8192
  v_lshlrev_b32 v186, 16, v125
  v_mfma_f32_16x16x32_bf16 v[56:59], a[24:27], a[4:7], v[56:59]
  ds_read_b64_tr_b16 a[58:59], v16 offset:9216
  v_and_b32 v187, 0xffff0000, v125
  v_mfma_f32_16x16x32_bf16 v[72:75], a[24:27], a[8:11], v[72:75]
  ds_read_b64_tr_b16 a[60:61], v17 offset:8192
  v_lshlrev_b32 v188, 16, v126
  v_mfma_f32_16x16x32_bf16 v[88:91], a[24:27], a[12:15], v[88:91]
  ds_read_b64_tr_b16 a[62:63], v17 offset:9216
  v_and_b32 v189, 0xffff0000, v126
  s_waitcnt lgkmcnt(12)
  v_mfma_f32_16x16x32_bf16 v[44:47], a[28:31], a[0:3], v[44:47]
  v_lshlrev_b32_e64 v190, 16, v127
  v_mfma_f32_16x16x32_bf16 v[60:63], a[28:31], a[4:7], v[60:63]
  v_and_b32 v191, 0xffff0000, v127
  v_mfma_f32_16x16x32_bf16 v[76:79], a[28:31], a[8:11], v[76:79]
  v_fma_f32 v184, v184, v27, v26
  v_mfma_f32_16x16x32_bf16 v[92:95], a[28:31], a[12:15], v[92:95]
  v_fma_f32 v185, v185, v27, v26
  s_waitcnt lgkmcnt(9)
  v_mfma_f32_16x16x32_bf16 v[32:35], a[48:51], a[32:35], v[32:35]
  v_fma_f32 v186, v186, v27, v26
  s_waitcnt lgkmcnt(8)
  v_mfma_f32_16x16x32_bf16 v[48:51], a[48:51], a[36:39], v[48:51]
  v_fma_f32 v187, v187, v27, v26
  s_waitcnt lgkmcnt(7)
  v_mfma_f32_16x16x32_bf16 v[64:67], a[48:51], a[40:43], v[64:67]
  v_fma_f32 v188, v188, v27, v26
  s_waitcnt lgkmcnt(6)
  v_mfma_f32_16x16x32_bf16 v[80:83], a[48:51], a[44:47], v[80:83]
  s_waitcnt lgkmcnt(0)
  s_barrier
  ds_read_b64_tr_b16 a[16:17], v14 offset:32768
  v_fma_f32 v189, v189, v27, v26
  v_mfma_f32_16x16x32_bf16 v[36:39], a[52:55], a[32:35], v[36:39]
  ds_read_b64_tr_b16 a[18:19], v14 offset:33792
  v_fma_f32 v190, v190, v27, v26
  v_mfma_f32_16x16x32_bf16 v[52:55], a[52:55], a[36:39], v[52:55]
  ds_read_b128 a[0:3], v8 offset:32768
  v_fma_f32 v191, v191, v27, v26
  v_mfma_f32_16x16x32_bf16 v[68:71], a[52:55], a[40:43], v[68:71]
  ds_read_b128 a[4:7], v8 offset:33024
  v_lshlrev_b32 v128, 16, v96
  v_mfma_f32_16x16x32_bf16 v[84:87], a[52:55], a[44:47], v[84:87]
  ds_read_b128 a[8:11], v8 offset:33280
  v_and_b32 v129, 0xffff0000, v96
  v_mfma_f32_16x16x32_bf16 v[40:43], a[56:59], a[32:35], v[40:43]
  ds_read_b128 a[12:15], v8 offset:33536
  v_lshlrev_b32 v130, 16, v97
  v_mfma_f32_16x16x32_bf16 v[56:59], a[56:59], a[36:39], v[56:59]
  ds_read_b64_tr_b16 a[20:21], v15 offset:32768
  v_and_b32 v131, 0xffff0000, v97
  v_mfma_f32_16x16x32_bf16 v[72:75], a[56:59], a[40:43], v[72:75]
  ds_read_b64_tr_b16 a[22:23], v15 offset:33792
  v_lshlrev_b32 v132, 16, v98
  v_mfma_f32_16x16x32_bf16 v[88:91], a[56:59], a[44:47], v[88:91]
  ds_read_b64_tr_b16 a[24:25], v16 offset:32768
  v_and_b32 v133, 0xffff0000, v98
  v_mfma_f32_16x16x32_bf16 v[44:47], a[60:63], a[32:35], v[44:47]
  ds_read_b64_tr_b16 a[26:27], v16 offset:33792
  v_lshlrev_b32 v134, 16, v99
  v_mfma_f32_16x16x32_bf16 v[60:63], a[60:63], a[36:39], v[60:63]
  ds_read_b64_tr_b16 a[28:29], v17 offset:32768
  v_and_b32 v135, 0xffff0000, v99
  v_mfma_f32_16x16x32_bf16 v[76:79], a[60:63], a[40:43], v[76:79]
  ds_read_b64_tr_b16 a[30:31], v17 offset:33792
  v_fma_f32 v128, v128, v21, v20
  v_mfma_f32_16x16x32_bf16 v[92:95], a[60:63], a[44:47], v[92:95]
  v_fma_f32 v129, v129, v21, v20
  s_waitcnt lgkmcnt(9)
  v_mfma_f32_16x16x32_bf16 v[32:35], a[16:19], a[0:3], v[32:35]
  ds_read_b64_tr_b16 a[48:49], v14 offset:40960
  v_fma_f32 v130, v130, v21, v20
  s_waitcnt lgkmcnt(9)
  v_mfma_f32_16x16x32_bf16 v[48:51], a[16:19], a[4:7], v[48:51]
  ds_read_b64_tr_b16 a[50:51], v14 offset:41984
  v_fma_f32 v131, v131, v21, v20
  s_waitcnt lgkmcnt(9)
  v_mfma_f32_16x16x32_bf16 v[64:67], a[16:19], a[8:11], v[64:67]
  ds_read_b128 a[32:35], v9 offset:32768
  v_fma_f32 v132, v132, v21, v20
  s_waitcnt lgkmcnt(9)
  v_mfma_f32_16x16x32_bf16 v[80:83], a[16:19], a[12:15], v[80:83]
  ds_read_b128 a[36:39], v9 offset:33024
  v_fma_f32 v133, v133, v21, v20
  s_waitcnt lgkmcnt(8)
  v_mfma_f32_16x16x32_bf16 v[36:39], a[20:23], a[0:3], v[36:39]
  ds_read_b128 a[40:43], v9 offset:33280
  v_fma_f32 v134, v134, v21, v20
  v_mfma_f32_16x16x32_bf16 v[52:55], a[20:23], a[4:7], v[52:55]
  ds_read_b128 a[44:47], v9 offset:33536
  v_fma_f32 v135, v135, v21, v20
  v_mfma_f32_16x16x32_bf16 v[68:71], a[20:23], a[8:11], v[68:71]
  ds_read_b64_tr_b16 a[52:53], v15 offset:40960
  v_lshlrev_b32 v144, 16, v104
  v_mfma_f32_16x16x32_bf16 v[84:87], a[20:23], a[12:15], v[84:87]
  ds_read_b64_tr_b16 a[54:55], v15 offset:41984
  v_and_b32 v145, 0xffff0000, v104
  s_waitcnt lgkmcnt(10)
  v_mfma_f32_16x16x32_bf16 v[40:43], a[24:27], a[0:3], v[40:43]
  ds_read_b64_tr_b16 a[56:57], v16 offset:40960
  v_lshlrev_b32 v146, 16, v105
  v_mfma_f32_16x16x32_bf16 v[56:59], a[24:27], a[4:7], v[56:59]
  ds_read_b64_tr_b16 a[58:59], v16 offset:41984
  v_and_b32 v147, 0xffff0000, v105
  v_mfma_f32_16x16x32_bf16 v[72:75], a[24:27], a[8:11], v[72:75]
  ds_read_b64_tr_b16 a[60:61], v17 offset:40960
  v_lshlrev_b32 v148, 16, v106
  v_mfma_f32_16x16x32_bf16 v[88:91], a[24:27], a[12:15], v[88:91]
  ds_read_b64_tr_b16 a[62:63], v17 offset:41984
  v_and_b32 v149, 0xffff0000, v106
  s_waitcnt lgkmcnt(12)
  v_mfma_f32_16x16x32_bf16 v[44:47], a[28:31], a[0:3], v[44:47]
  v_lshlrev_b32_e64 v150, 16, v107
  v_mfma_f32_16x16x32_bf16 v[60:63], a[28:31], a[4:7], v[60:63]
  v_and_b32 v151, 0xffff0000, v107
  v_mfma_f32_16x16x32_bf16 v[76:79], a[28:31], a[8:11], v[76:79]
  v_fma_f32 v144, v144, v23, v22
  v_mfma_f32_16x16x32_bf16 v[92:95], a[28:31], a[12:15], v[92:95]
  v_fma_f32 v145, v145, v23, v22
  s_waitcnt lgkmcnt(9)
  v_mfma_f32_16x16x32_bf16 v[32:35], a[48:51], a[32:35], v[32:35]
  v_fma_f32 v146, v146, v23, v22
  s_waitcnt lgkmcnt(8)
  v_mfma_f32_16x16x32_bf16 v[48:51], a[48:51], a[36:39], v[48:51]
  v_fma_f32 v147, v147, v23, v22
  s_waitcnt lgkmcnt(7)
  v_mfma_f32_16x16x32_bf16 v[64:67], a[48:51], a[40:43], v[64:67]
  v_fma_f32 v148, v148, v23, v22
  s_waitcnt lgkmcnt(6)
  v_mfma_f32_16x16x32_bf16 v[80:83], a[48:51], a[44:47], v[80:83]
  s_waitcnt lgkmcnt(0)
  s_barrier
  ds_read_b64_tr_b16 a[16:17], v10 offset:0
  v_fma_f32 v149, v149, v23, v22
  v_mfma_f32_16x16x32_bf16 v[36:39], a[52:55], a[32:35], v[36:39]
  ds_read_b64_tr_b16 a[18:19], v10 offset:1024
  v_fma_f32 v150, v150, v23, v22
  v_mfma_f32_16x16x32_bf16 v[52:55], a[52:55], a[36:39], v[52:55]
  ds_read_b128 a[0:3], v6 offset:0
  v_fma_f32 v151, v151, v23, v22
  v_mfma_f32_16x16x32_bf16 v[68:71], a[52:55], a[40:43], v[68:71]
  ds_read_b128 a[4:7], v6 offset:256
  v_lshlrev_b32 v160, 16, v112
  v_mfma_f32_16x16x32_bf16 v[84:87], a[52:55], a[44:47], v[84:87]
  ds_read_b128 a[8:11], v6 offset:512
  v_and_b32 v161, 0xffff0000, v112
  v_mfma_f32_16x16x32_bf16 v[40:43], a[56:59], a[32:35], v[40:43]
  ds_read_b128 a[12:15], v6 offset:768
  v_lshlrev_b32 v162, 16, v113
  v_mfma_f32_16x16x32_bf16 v[56:59], a[56:59], a[36:39], v[56:59]
  ds_read_b64_tr_b16 a[20:21], v11 offset:0
  v_and_b32 v163, 0xffff0000, v113
  v_mfma_f32_16x16x32_bf16 v[72:75], a[56:59], a[40:43], v[72:75]
  ds_read_b64_tr_b16 a[22:23], v11 offset:1024
  v_lshlrev_b32 v164, 16, v114
  v_mfma_f32_16x16x32_bf16 v[88:91], a[56:59], a[44:47], v[88:91]
  ds_read_b64_tr_b16 a[24:25], v12 offset:0
  v_and_b32 v165, 0xffff0000, v114
  v_mfma_f32_16x16x32_bf16 v[44:47], a[60:63], a[32:35], v[44:47]
  ds_read_b64_tr_b16 a[26:27], v12 offset:1024
  v_lshlrev_b32 v166, 16, v115
  v_mfma_f32_16x16x32_bf16 v[60:63], a[60:63], a[36:39], v[60:63]
  ds_read_b64_tr_b16 a[28:29], v13 offset:0
  v_and_b32 v167, 0xffff0000, v115
  v_mfma_f32_16x16x32_bf16 v[76:79], a[60:63], a[40:43], v[76:79]
  ds_read_b64_tr_b16 a[30:31], v13 offset:1024
  v_fma_f32 v160, v160, v25, v24
  v_mfma_f32_16x16x32_bf16 v[92:95], a[60:63], a[44:47], v[92:95]
  v_fma_f32 v161, v161, v25, v24
  s_waitcnt lgkmcnt(2)
  s_nop 0
  v_mfma_f32_16x16x32_bf16 v[40:43], a[24:27], a[0:3], v[40:43]
  ds_read_b64_tr_b16 a[56:57], v12 offset:8192
  v_fma_f32 v162, v162, v25, v24
  v_mfma_f32_16x16x32_bf16 v[56:59], a[24:27], a[4:7], v[56:59]
  ds_read_b64_tr_b16 a[58:59], v12 offset:9216
  v_fma_f32 v163, v163, v25, v24
  v_mfma_f32_16x16x32_bf16 v[72:75], a[24:27], a[8:11], v[72:75]
  ds_read_b128 a[32:35], v7 offset:0
  v_fma_f32 v164, v164, v25, v24
  v_mfma_f32_16x16x32_bf16 v[88:91], a[24:27], a[12:15], v[88:91]
  ds_read_b128 a[36:39], v7 offset:256
  v_fma_f32 v165, v165, v25, v24
  s_waitcnt lgkmcnt(4)
  v_mfma_f32_16x16x32_bf16 v[44:47], a[28:31], a[0:3], v[44:47]
  ds_read_b128 a[40:43], v7 offset:512
  v_fma_f32 v166, v166, v25, v24
  v_mfma_f32_16x16x32_bf16 v[60:63], a[28:31], a[4:7], v[60:63]
  ds_read_b128 a[44:47], v7 offset:768
  v_fma_f32 v167, v167, v25, v24
  v_mfma_f32_16x16x32_bf16 v[76:79], a[28:31], a[8:11], v[76:79]
  ds_read_b64_tr_b16 a[60:61], v13 offset:8192
  v_lshlrev_b32 v176, 16, v120
  v_mfma_f32_16x16x32_bf16 v[92:95], a[28:31], a[12:15], v[92:95]
  ds_read_b64_tr_b16 a[62:63], v13 offset:9216
  v_and_b32 v177, 0xffff0000, v120
  s_waitcnt lgkmcnt(5)
  v_mfma_f32_16x16x32_bf16 v[40:43], a[56:59], a[32:35], v[40:43]
  s_waitcnt lgkmcnt(0)
  s_barrier
  ds_read_b64_tr_b16 a[24:25], v12 offset:32768
  v_lshlrev_b32 v178, 16, v121
  v_mfma_f32_16x16x32_bf16 v[56:59], a[56:59], a[36:39], v[56:59]
  ds_read_b64_tr_b16 a[26:27], v12 offset:33792
  v_and_b32 v179, 0xffff0000, v121
  v_mfma_f32_16x16x32_bf16 v[72:75], a[56:59], a[40:43], v[72:75]
  ds_read_b128 a[0:3], v6 offset:32768
  v_lshlrev_b32 v180, 16, v122
  v_mfma_f32_16x16x32_bf16 v[88:91], a[56:59], a[44:47], v[88:91]
  ds_read_b128 a[4:7], v6 offset:33024
  v_and_b32 v181, 0xffff0000, v122
  v_mfma_f32_16x16x32_bf16 v[44:47], a[60:63], a[32:35], v[44:47]
  ds_read_b128 a[8:11], v6 offset:33280
  v_lshlrev_b32 v182, 16, v123
  v_mfma_f32_16x16x32_bf16 v[60:63], a[60:63], a[36:39], v[60:63]
  ds_read_b128 a[12:15], v6 offset:33536
  v_and_b32 v183, 0xffff0000, v123
  v_mfma_f32_16x16x32_bf16 v[76:79], a[60:63], a[40:43], v[76:79]
  ds_read_b64_tr_b16 a[28:29], v13 offset:32768
  v_fma_f32 v176, v176, v27, v26
  v_mfma_f32_16x16x32_bf16 v[92:95], a[60:63], a[44:47], v[92:95]
  ds_read_b64_tr_b16 a[30:31], v13 offset:33792
  v_fma_f32 v177, v177, v27, v26
  s_waitcnt lgkmcnt(5)
  v_mfma_f32_16x16x32_bf16 v[40:43], a[24:27], a[0:3], v[40:43]
  ds_read_b64_tr_b16 a[56:57], v12 offset:40960
  v_fma_f32 v178, v178, v27, v26
  s_waitcnt lgkmcnt(5)
  v_mfma_f32_16x16x32_bf16 v[56:59], a[24:27], a[4:7], v[56:59]
  ds_read_b64_tr_b16 a[58:59], v12 offset:41984
  v_fma_f32 v179, v179, v27, v26
  s_waitcnt lgkmcnt(5)
  v_mfma_f32_16x16x32_bf16 v[72:75], a[24:27], a[8:11], v[72:75]
  ds_read_b128 a[32:35], v7 offset:32768
  v_fma_f32 v180, v180, v27, v26
  s_waitcnt lgkmcnt(5)
  v_mfma_f32_16x16x32_bf16 v[88:91], a[24:27], a[12:15], v[88:91]
  ds_read_b128 a[36:39], v7 offset:33024
  v_fma_f32 v181, v181, v27, v26
  s_waitcnt lgkmcnt(4)
  v_mfma_f32_16x16x32_bf16 v[44:47], a[28:31], a[0:3], v[44:47]
  ds_read_b128 a[40:43], v7 offset:33280
  v_fma_f32 v182, v182, v27, v26
  v_mfma_f32_16x16x32_bf16 v[60:63], a[28:31], a[4:7], v[60:63]
  ds_read_b128 a[44:47], v7 offset:33536
  v_fma_f32 v183, v183, v27, v26
  v_mfma_f32_16x16x32_bf16 v[76:79], a[28:31], a[8:11], v[76:79]
  ds_read_b64_tr_b16 a[60:61], v13 offset:40960
  v_mov_b32 v20, 0
  v_mfma_f32_16x16x32_bf16 v[92:95], a[28:31], a[12:15], v[92:95]
  ds_read_b64_tr_b16 a[62:63], v13 offset:41984
  v_mov_b32 v21, 0
  s_waitcnt lgkmcnt(5)
  v_mfma_f32_16x16x32_bf16 v[40:43], a[56:59], a[32:35], v[40:43]
  s_waitcnt lgkmcnt(0)
  s_barrier
  ds_read_b64_tr_b16 a[24:25], v16 offset:0
  v_mov_b32 v22, 0
  v_mfma_f32_16x16x32_bf16 v[56:59], a[56:59], a[36:39], v[56:59]
  ds_read_b64_tr_b16 a[26:27], v16 offset:1024
  v_mov_b32 v23, 0
  v_mfma_f32_16x16x32_bf16 v[72:75], a[56:59], a[40:43], v[72:75]
  ds_read_b128 a[0:3], v8 offset:0
  v_mov_b32 v24, 0
  v_mfma_f32_16x16x32_bf16 v[88:91], a[56:59], a[44:47], v[88:91]
  ds_read_b128 a[4:7], v8 offset:256
  v_mov_b32 v25, 0
  v_mfma_f32_16x16x32_bf16 v[44:47], a[60:63], a[32:35], v[44:47]
  ds_read_b128 a[8:11], v8 offset:512
  v_mov_b32 v26, 0
  v_mfma_f32_16x16x32_bf16 v[60:63], a[60:63], a[36:39], v[60:63]
  ds_read_b128 a[12:15], v8 offset:768
  v_mov_b32 v27, 0
  v_mfma_f32_16x16x32_bf16 v[76:79], a[60:63], a[40:43], v[76:79]
  ds_read_b64_tr_b16 a[28:29], v17 offset:0
  v_mfma_f32_16x16x32_bf16 v[92:95], a[60:63], a[44:47], v[92:95]
  ds_read_b64_tr_b16 a[30:31], v17 offset:1024
  s_waitcnt lgkmcnt(5)
  v_mfma_f32_16x16x32_bf16 v[40:43], a[24:27], a[0:3], v[40:43]
  ds_read_b64_tr_b16 a[56:57], v16 offset:8192
  s_waitcnt lgkmcnt(5)
  v_mfma_f32_16x16x32_bf16 v[56:59], a[24:27], a[4:7], v[56:59]
  ds_read_b64_tr_b16 a[58:59], v16 offset:9216
  s_waitcnt lgkmcnt(5)
  v_mfma_f32_16x16x32_bf16 v[72:75], a[24:27], a[8:11], v[72:75]
  ds_read_b128 a[32:35], v9 offset:0
  s_waitcnt lgkmcnt(5)
  v_mfma_f32_16x16x32_bf16 v[88:91], a[24:27], a[12:15], v[88:91]
  ds_read_b128 a[36:39], v9 offset:256
  s_waitcnt lgkmcnt(4)
  v_mfma_f32_16x16x32_bf16 v[44:47], a[28:31], a[0:3], v[44:47]
  ds_read_b128 a[40:43], v9 offset:512
  v_mfma_f32_16x16x32_bf16 v[60:63], a[28:31], a[4:7], v[60:63]
  ds_read_b128 a[44:47], v9 offset:768
  v_mfma_f32_16x16x32_bf16 v[76:79], a[28:31], a[8:11], v[76:79]
  ds_read_b64_tr_b16 a[60:61], v17 offset:8192
  v_mfma_f32_16x16x32_bf16 v[92:95], a[28:31], a[12:15], v[92:95]
  ds_read_b64_tr_b16 a[62:63], v17 offset:9216
  s_waitcnt lgkmcnt(5)
  v_mfma_f32_16x16x32_bf16 v[40:43], a[56:59], a[32:35], v[40:43]
  s_waitcnt lgkmcnt(0)
  s_barrier
  ds_read_b64_tr_b16 a[24:25], v16 offset:32768
  v_mfma_f32_16x16x32_bf16 v[56:59], a[56:59], a[36:39], v[56:59]
  ds_read_b64_tr_b16 a[26:27], v16 offset:33792
  v_mfma_f32_16x16x32_bf16 v[72:75], a[56:59], a[40:43], v[72:75]
  ds_read_b128 a[0:3], v8 offset:32768
  v_mfma_f32_16x16x32_bf16 v[88:91], a[56:59], a[44:47], v[88:91]
  ds_read_b128 a[4:7], v8 offset:33024
  v_mfma_f32_16x16x32_bf16 v[44:47], a[60:63], a[32:35], v[44:47]
  ds_read_b128 a[8:11], v8 offset:33280
  v_mfma_f32_16x16x32_bf16 v[60:63], a[60:63], a[36:39], v[60:63]
  ds_read_b128 a[12:15], v8 offset:33536
  v_mfma_f32_16x16x32_bf16 v[76:79], a[60:63], a[40:43], v[76:79]
  ds_read_b64_tr_b16 a[28:29], v17 offset:32768
  v_mfma_f32_16x16x32_bf16 v[92:95], a[60:63], a[44:47], v[92:95]
  ds_read_b64_tr_b16 a[30:31], v17 offset:33792
  s_waitcnt lgkmcnt(5)
  v_mfma_f32_16x16x32_bf16 v[40:43], a[24:27], a[0:3], v[40:43]
  ds_read_b64_tr_b16 a[56:57], v16 offset:40960
  s_waitcnt lgkmcnt(5)
  v_mfma_f32_16x16x32_bf16 v[56:59], a[24:27], a[4:7], v[56:59]
  ds_read_b64_tr_b16 a[58:59], v16 offset:41984
  s_waitcnt lgkmcnt(5)
  v_mfma_f32_16x16x32_bf16 v[72:75], a[24:27], a[8:11], v[72:75]
  ds_read_b128 a[32:35], v9 offset:32768
  s_waitcnt lgkmcnt(5)
  v_mfma_f32_16x16x32_bf16 v[88:91], a[24:27], a[12:15], v[88:91]
  ds_read_b128 a[36:39], v9 offset:33024
  s_waitcnt lgkmcnt(4)
  v_mfma_f32_16x16x32_bf16 v[44:47], a[28:31], a[0:3], v[44:47]
  ds_read_b128 a[40:43], v9 offset:33280
  v_mfma_f32_16x16x32_bf16 v[60:63], a[28:31], a[4:7], v[60:63]
  ds_read_b128 a[44:47], v9 offset:33536
  v_mfma_f32_16x16x32_bf16 v[76:79], a[28:31], a[8:11], v[76:79]
  ds_read_b64_tr_b16 a[60:61], v17 offset:40960
  v_mfma_f32_16x16x32_bf16 v[92:95], a[28:31], a[12:15], v[92:95]
  ds_read_b64_tr_b16 a[62:63], v17 offset:41984
  s_waitcnt lgkmcnt(5)
  v_mfma_f32_16x16x32_bf16 v[40:43], a[56:59], a[32:35], v[40:43]
  ds_read_b64_tr_b16 a[16:17], v10 offset:0
  s_waitcnt lgkmcnt(5)
  v_mfma_f32_16x16x32_bf16 v[56:59], a[56:59], a[36:39], v[56:59]
  ds_read_b64_tr_b16 a[18:19], v10 offset:1024
  s_waitcnt lgkmcnt(5)
  v_mfma_f32_16x16x32_bf16 v[72:75], a[56:59], a[40:43], v[72:75]
  ds_read_b128 a[0:3], v6 offset:0
  s_waitcnt lgkmcnt(5)
  v_mfma_f32_16x16x32_bf16 v[88:91], a[56:59], a[44:47], v[88:91]
  ds_read_b128 a[4:7], v6 offset:256
  s_waitcnt lgkmcnt(4)
  v_mfma_f32_16x16x32_bf16 v[44:47], a[60:63], a[32:35], v[44:47]
  ds_read_b128 a[8:11], v6 offset:512
  v_mfma_f32_16x16x32_bf16 v[60:63], a[60:63], a[36:39], v[60:63]
  ds_read_b128 a[12:15], v6 offset:768
  v_mfma_f32_16x16x32_bf16 v[76:79], a[60:63], a[40:43], v[76:79]
  ds_read_b64_tr_b16 a[20:21], v11 offset:0
  v_mfma_f32_16x16x32_bf16 v[92:95], a[60:63], a[44:47], v[92:95]
  ds_read_b64_tr_b16 a[22:23], v11 offset:1024
  s_waitcnt lgkmcnt(5)
  v_mfma_f32_16x16x32_bf16 v[32:35], a[16:19], a[0:3], v[32:35]
  ds_read_b64_tr_b16 a[48:49], v10 offset:8192
  v_add_f32 v40, v40, v136
  v_add_f32 v41, v41, v137
  s_waitcnt lgkmcnt(5)
  v_mfma_f32_16x16x32_bf16 v[48:51], a[16:19], a[4:7], v[48:51]
  ds_read_b64_tr_b16 a[50:51], v10 offset:9216
  v_add_f32 v42, v42, v138
  v_add_f32 v43, v43, v139
  s_waitcnt lgkmcnt(5)
  v_mfma_f32_16x16x32_bf16 v[64:67], a[16:19], a[8:11], v[64:67]
  ds_read_b128 a[32:35], v7 offset:0
  v_add_f32 v44, v44, v140
  v_add_f32 v45, v45, v141
  s_waitcnt lgkmcnt(5)
  v_mfma_f32_16x16x32_bf16 v[80:83], a[16:19], a[12:15], v[80:83]
  ds_read_b128 a[36:39], v7 offset:256
  v_add_f32 v46, v46, v142
  v_add_f32 v47, v47, v143
  s_waitcnt lgkmcnt(4)
  s_nop 0
  v_mfma_f32_16x16x32_bf16 v[36:39], a[20:23], a[0:3], v[36:39]
  ds_read_b128 a[40:43], v7 offset:512
  v_cvt_pk_bf16_f32 v100, v40, v41
  v_cvt_pk_bf16_f32 v101, v42, v43
  v_mfma_f32_16x16x32_bf16 v[52:55], a[20:23], a[4:7], v[52:55]
  ds_read_b128 a[44:47], v7 offset:768
  v_cvt_pk_bf16_f32 v102, v44, v45
  v_cvt_pk_bf16_f32 v103, v46, v47
  v_mfma_f32_16x16x32_bf16 v[68:71], a[20:23], a[8:11], v[68:71]
  ds_read_b64_tr_b16 a[52:53], v11 offset:8192
  v_permlane16_swap_b32 v100, v102
  v_permlane16_swap_b32 v101, v103
  v_mfma_f32_16x16x32_bf16 v[84:87], a[20:23], a[12:15], v[84:87]
  ds_read_b64_tr_b16 a[54:55], v11 offset:9216
  buffer_store_dwordx4 v[100:103], v29, s[4:7], s54 offen offset:0 sc1
  v_add_f32 v56, v56, v152
  s_waitcnt lgkmcnt(5)
  v_mfma_f32_16x16x32_bf16 v[32:35], a[48:51], a[32:35], v[32:35]
  ds_read_b64_tr_b16 a[16:17], v10 offset:32768
  v_add_f32 v57, v57, v153
  v_add_f32 v58, v58, v154
  s_waitcnt lgkmcnt(5)
  v_mfma_f32_16x16x32_bf16 v[48:51], a[48:51], a[36:39], v[48:51]
  ds_read_b64_tr_b16 a[18:19], v10 offset:33792
  v_add_f32 v59, v59, v155
  v_add_f32 v60, v60, v156
  s_waitcnt lgkmcnt(5)
  v_mfma_f32_16x16x32_bf16 v[64:67], a[48:51], a[40:43], v[64:67]
  ds_read_b128 a[0:3], v6 offset:32768
  v_add_f32 v61, v61, v157
  v_add_f32 v62, v62, v158
  s_waitcnt lgkmcnt(5)
  v_mfma_f32_16x16x32_bf16 v[80:83], a[48:51], a[44:47], v[80:83]
  ds_read_b128 a[4:7], v6 offset:33024
  v_add_f32 v63, v63, v159
  v_cvt_pk_bf16_f32 v108, v56, v57
  s_waitcnt lgkmcnt(4)
  s_nop 0
  v_mfma_f32_16x16x32_bf16 v[36:39], a[52:55], a[32:35], v[36:39]
  ds_read_b128 a[8:11], v6 offset:33280
  v_cvt_pk_bf16_f32 v109, v58, v59
  v_cvt_pk_bf16_f32 v110, v60, v61
  v_mfma_f32_16x16x32_bf16 v[52:55], a[52:55], a[36:39], v[52:55]
  ds_read_b128 a[12:15], v6 offset:33536
  v_cvt_pk_bf16_f32 v111, v62, v63
  v_permlane16_swap_b32 v108, v110
  v_mfma_f32_16x16x32_bf16 v[68:71], a[52:55], a[40:43], v[68:71]
  ds_read_b64_tr_b16 a[20:21], v11 offset:32768
  v_permlane16_swap_b32 v109, v111
  buffer_store_dwordx4 v[108:111], v29, s[4:7], s54 offen offset:256 sc1
  v_mfma_f32_16x16x32_bf16 v[84:87], a[52:55], a[44:47], v[84:87]
  ds_read_b64_tr_b16 a[22:23], v11 offset:33792
  v_add_f32 v72, v72, v168
  v_add_f32 v73, v73, v169
  s_waitcnt lgkmcnt(5)
  v_mfma_f32_16x16x32_bf16 v[32:35], a[16:19], a[0:3], v[32:35]
  ds_read_b64_tr_b16 a[48:49], v10 offset:40960
  v_add_f32 v74, v74, v170
  v_add_f32 v75, v75, v171
  s_waitcnt lgkmcnt(5)
  v_mfma_f32_16x16x32_bf16 v[48:51], a[16:19], a[4:7], v[48:51]
  ds_read_b64_tr_b16 a[50:51], v10 offset:41984
  v_add_f32 v76, v76, v172
  v_add_f32 v77, v77, v173
  s_waitcnt lgkmcnt(5)
  v_mfma_f32_16x16x32_bf16 v[64:67], a[16:19], a[8:11], v[64:67]
  ds_read_b128 a[32:35], v7 offset:32768
  v_add_f32 v78, v78, v174
  v_add_f32 v79, v79, v175
  s_waitcnt lgkmcnt(5)
  v_mfma_f32_16x16x32_bf16 v[80:83], a[16:19], a[12:15], v[80:83]
  ds_read_b128 a[36:39], v7 offset:33024
  v_cvt_pk_bf16_f32 v116, v72, v73
  v_cvt_pk_bf16_f32 v117, v74, v75
  s_waitcnt lgkmcnt(4)
  v_mfma_f32_16x16x32_bf16 v[36:39], a[20:23], a[0:3], v[36:39]
  ds_read_b128 a[40:43], v7 offset:33280
  v_cvt_pk_bf16_f32 v118, v76, v77
  v_cvt_pk_bf16_f32 v119, v78, v79
  v_mfma_f32_16x16x32_bf16 v[52:55], a[20:23], a[4:7], v[52:55]
  ds_read_b128 a[44:47], v7 offset:33536
  v_permlane16_swap_b32 v116, v118
  v_permlane16_swap_b32 v117, v119
  v_mfma_f32_16x16x32_bf16 v[68:71], a[20:23], a[8:11], v[68:71]
  ds_read_b64_tr_b16 a[52:53], v11 offset:40960
  buffer_store_dwordx4 v[116:119], v29, s[4:7], s54 offen offset:512 sc1
  v_add_f32 v88, v88, v184
  v_mfma_f32_16x16x32_bf16 v[84:87], a[20:23], a[12:15], v[84:87]
  ds_read_b64_tr_b16 a[54:55], v11 offset:41984
  v_add_f32 v89, v89, v185
  v_add_f32 v90, v90, v186
  s_waitcnt lgkmcnt(5)
  v_mfma_f32_16x16x32_bf16 v[32:35], a[48:51], a[32:35], v[32:35]
  ds_read_b64_tr_b16 a[16:17], v14 offset:0
  v_add_f32 v91, v91, v187
  v_add_f32 v92, v92, v188
  s_waitcnt lgkmcnt(5)
  v_mfma_f32_16x16x32_bf16 v[48:51], a[48:51], a[36:39], v[48:51]
  ds_read_b64_tr_b16 a[18:19], v14 offset:1024
  v_add_f32 v93, v93, v189
  v_add_f32 v94, v94, v190
  s_waitcnt lgkmcnt(5)
  v_mfma_f32_16x16x32_bf16 v[64:67], a[48:51], a[40:43], v[64:67]
  ds_read_b128 a[0:3], v8 offset:0
  v_add_f32 v95, v95, v191
  v_cvt_pk_bf16_f32 v124, v88, v89
  s_waitcnt lgkmcnt(5)
  v_mfma_f32_16x16x32_bf16 v[80:83], a[48:51], a[44:47], v[80:83]
  ds_read_b128 a[4:7], v8 offset:256
  v_cvt_pk_bf16_f32 v125, v90, v91
  v_cvt_pk_bf16_f32 v126, v92, v93
  s_waitcnt lgkmcnt(4)
  v_mfma_f32_16x16x32_bf16 v[36:39], a[52:55], a[32:35], v[36:39]
  ds_read_b128 a[8:11], v8 offset:512
  v_cvt_pk_bf16_f32 v127, v94, v95
  v_permlane16_swap_b32 v124, v126
  v_mfma_f32_16x16x32_bf16 v[52:55], a[52:55], a[36:39], v[52:55]
  ds_read_b128 a[12:15], v8 offset:768
  v_permlane16_swap_b32 v125, v127
  buffer_store_dwordx4 v[124:127], v29, s[4:7], s54 offen offset:768 sc1
  v_mfma_f32_16x16x32_bf16 v[68:71], a[52:55], a[40:43], v[68:71]
  ds_read_b64_tr_b16 a[20:21], v15 offset:0
  v_mfma_f32_16x16x32_bf16 v[84:87], a[52:55], a[44:47], v[84:87]
  ds_read_b64_tr_b16 a[22:23], v15 offset:1024
  s_waitcnt lgkmcnt(5)
  v_mfma_f32_16x16x32_bf16 v[32:35], a[16:19], a[0:3], v[32:35]
  ds_read_b64_tr_b16 a[48:49], v14 offset:8192
  s_waitcnt lgkmcnt(5)
  v_mfma_f32_16x16x32_bf16 v[48:51], a[16:19], a[4:7], v[48:51]
  ds_read_b64_tr_b16 a[50:51], v14 offset:9216
  s_waitcnt lgkmcnt(5)
  v_mfma_f32_16x16x32_bf16 v[64:67], a[16:19], a[8:11], v[64:67]
  ds_read_b128 a[32:35], v9 offset:0
  s_waitcnt lgkmcnt(5)
  v_mfma_f32_16x16x32_bf16 v[80:83], a[16:19], a[12:15], v[80:83]
  ds_read_b128 a[36:39], v9 offset:256
  s_waitcnt lgkmcnt(4)
  v_mfma_f32_16x16x32_bf16 v[36:39], a[20:23], a[0:3], v[36:39]
  ds_read_b128 a[40:43], v9 offset:512
  v_mfma_f32_16x16x32_bf16 v[52:55], a[20:23], a[4:7], v[52:55]
  ds_read_b128 a[44:47], v9 offset:768
  v_mfma_f32_16x16x32_bf16 v[68:71], a[20:23], a[8:11], v[68:71]
  ds_read_b64_tr_b16 a[52:53], v15 offset:8192
  v_mfma_f32_16x16x32_bf16 v[84:87], a[20:23], a[12:15], v[84:87]
  ds_read_b64_tr_b16 a[54:55], v15 offset:9216
  s_waitcnt lgkmcnt(5)
  v_mfma_f32_16x16x32_bf16 v[32:35], a[48:51], a[32:35], v[32:35]
  ds_read_b64_tr_b16 a[16:17], v14 offset:32768
  s_waitcnt lgkmcnt(5)
  v_mfma_f32_16x16x32_bf16 v[48:51], a[48:51], a[36:39], v[48:51]
  ds_read_b64_tr_b16 a[18:19], v14 offset:33792
  s_waitcnt lgkmcnt(5)
  v_mfma_f32_16x16x32_bf16 v[64:67], a[48:51], a[40:43], v[64:67]
  ds_read_b128 a[0:3], v8 offset:32768
  s_waitcnt lgkmcnt(5)
  v_mfma_f32_16x16x32_bf16 v[80:83], a[48:51], a[44:47], v[80:83]
  ds_read_b128 a[4:7], v8 offset:33024
  s_waitcnt lgkmcnt(4)
  v_mfma_f32_16x16x32_bf16 v[36:39], a[52:55], a[32:35], v[36:39]
  ds_read_b128 a[8:11], v8 offset:33280
  v_mfma_f32_16x16x32_bf16 v[52:55], a[52:55], a[36:39], v[52:55]
  ds_read_b128 a[12:15], v8 offset:33536
  v_mfma_f32_16x16x32_bf16 v[68:71], a[52:55], a[40:43], v[68:71]
  ds_read_b64_tr_b16 a[20:21], v15 offset:32768
  v_mfma_f32_16x16x32_bf16 v[84:87], a[52:55], a[44:47], v[84:87]
  ds_read_b64_tr_b16 a[22:23], v15 offset:33792
  s_waitcnt lgkmcnt(5)
  v_mfma_f32_16x16x32_bf16 v[32:35], a[16:19], a[0:3], v[32:35]
  ds_read_b64_tr_b16 a[48:49], v14 offset:40960
  s_waitcnt lgkmcnt(5)
  v_mfma_f32_16x16x32_bf16 v[48:51], a[16:19], a[4:7], v[48:51]
  ds_read_b64_tr_b16 a[50:51], v14 offset:41984
  s_waitcnt lgkmcnt(5)
  v_mfma_f32_16x16x32_bf16 v[64:67], a[16:19], a[8:11], v[64:67]
  ds_read_b128 a[32:35], v9 offset:32768
  s_waitcnt lgkmcnt(5)
  v_mfma_f32_16x16x32_bf16 v[80:83], a[16:19], a[12:15], v[80:83]
  ds_read_b128 a[36:39], v9 offset:33024
  s_waitcnt lgkmcnt(4)
  v_mfma_f32_16x16x32_bf16 v[36:39], a[20:23], a[0:3], v[36:39]
  ds_read_b128 a[40:43], v9 offset:33280
  v_mfma_f32_16x16x32_bf16 v[52:55], a[20:23], a[4:7], v[52:55]
  ds_read_b128 a[44:47], v9 offset:33536
  v_mfma_f32_16x16x32_bf16 v[68:71], a[20:23], a[8:11], v[68:71]
  ds_read_b64_tr_b16 a[52:53], v15 offset:40960
  v_mfma_f32_16x16x32_bf16 v[84:87], a[20:23], a[12:15], v[84:87]
  ds_read_b64_tr_b16 a[54:55], v15 offset:41984
  s_waitcnt lgkmcnt(5)
  v_mfma_f32_16x16x32_bf16 v[32:35], a[48:51], a[32:35], v[32:35]
  s_waitcnt lgkmcnt(0)
  s_barrier
  v_mfma_f32_16x16x32_bf16 v[48:51], a[48:51], a[36:39], v[48:51]
  v_mfma_f32_16x16x32_bf16 v[64:67], a[48:51], a[40:43], v[64:67]
  v_mfma_f32_16x16x32_bf16 v[80:83], a[48:51], a[44:47], v[80:83]
  v_mfma_f32_16x16x32_bf16 v[36:39], a[52:55], a[32:35], v[36:39]
  v_mfma_f32_16x16x32_bf16 v[52:55], a[52:55], a[36:39], v[52:55]
  v_mfma_f32_16x16x32_bf16 v[68:71], a[52:55], a[40:43], v[68:71]
  v_mfma_f32_16x16x32_bf16 v[84:87], a[52:55], a[44:47], v[84:87]
  v_pk_add_f32 v[32:33], v[32:33], v[128:129]
  v_pk_add_f32 v[34:35], v[34:35], v[130:131]
  s_nop 2
  s_nop 0
  v_pk_add_f32 v[36:37], v[36:37], v[132:133]
  v_pk_add_f32 v[38:39], v[38:39], v[134:135]
  v_cvt_pk_bf16_f32 v96, v32, v33
  v_cvt_pk_bf16_f32 v97, v34, v35
  v_cvt_pk_bf16_f32 v98, v36, v37
  v_cvt_pk_bf16_f32 v99, v38, v39
  s_nop 0
  v_permlane16_swap_b32 v96, v98
  v_permlane16_swap_b32_e64 v97, v99
  buffer_store_dwordx4 v[96:99], v28, s[4:7], s54 offen offset:0 sc1
  v_pk_add_f32 v[48:49], v[48:49], v[144:145]
  v_pk_add_f32 v[50:51], v[50:51], v[146:147]
  v_pk_add_f32 v[52:53], v[52:53], v[148:149]
  v_pk_add_f32 v[54:55], v[54:55], v[150:151]
  v_cvt_pk_bf16_f32 v104, v48, v49
  v_cvt_pk_bf16_f32 v105, v50, v51
  v_cvt_pk_bf16_f32 v106, v52, v53
  v_cvt_pk_bf16_f32 v107, v54, v55
  s_nop 0
  v_permlane16_swap_b32 v104, v106
  v_permlane16_swap_b32_e64 v105, v107
  buffer_store_dwordx4 v[104:107], v28, s[4:7], s54 offen offset:256 sc1
  v_pk_add_f32 v[64:65], v[64:65], v[160:161]
  v_pk_add_f32 v[66:67], v[66:67], v[162:163]
  v_pk_add_f32 v[68:69], v[68:69], v[164:165]
  v_pk_add_f32 v[70:71], v[70:71], v[166:167]
  v_cvt_pk_bf16_f32 v112, v64, v65
  v_cvt_pk_bf16_f32 v113, v66, v67
  v_cvt_pk_bf16_f32 v114, v68, v69
  v_cvt_pk_bf16_f32 v115, v70, v71
  s_nop 0
  v_permlane16_swap_b32 v112, v114
  v_permlane16_swap_b32_e64 v113, v115
  buffer_store_dwordx4 v[112:115], v28, s[4:7], s54 offen offset:512 sc1
  v_pk_add_f32 v[80:81], v[80:81], v[176:177]
  v_pk_add_f32 v[82:83], v[82:83], v[178:179]
  v_pk_add_f32 v[84:85], v[84:85], v[180:181]
  v_pk_add_f32 v[86:87], v[86:87], v[182:183]
  v_cvt_pk_bf16_f32 v120, v80, v81
  v_cvt_pk_bf16_f32 v121, v82, v83
  v_cvt_pk_bf16_f32 v122, v84, v85
  v_cvt_pk_bf16_f32 v123, v86, v87
  s_nop 0
  v_permlane16_swap_b32 v120, v122
  v_permlane16_swap_b32 v121, v123
  buffer_store_dwordx4 v[120:123], v28, s[4:7], s54 offen offset:768 sc1
  s_waitcnt vmcnt(4)
  s_barrier
  v_dot2c_f32_bf16 v20, s44, v96
  v_dot2c_f32_bf16 v21, v96, v96
  v_dot2c_f32_bf16 v20, s44, v97
  v_dot2c_f32_bf16 v21, v97, v97
  v_dot2c_f32_bf16 v20, s44, v98
  v_dot2c_f32_bf16 v21, v98, v98
  v_dot2c_f32_bf16 v20, s44, v99
  v_dot2c_f32_bf16 v21, v99, v99
  v_dot2c_f32_bf16 v20, s44, v100
  v_dot2c_f32_bf16 v21, v100, v100
  v_dot2c_f32_bf16 v20, s44, v101
  v_dot2c_f32_bf16 v21, v101, v101
  v_dot2c_f32_bf16 v20, s44, v102
  v_dot2c_f32_bf16 v21, v102, v102
  v_dot2c_f32_bf16 v20, s44, v103
  v_dot2c_f32_bf16 v21, v103, v103
  v_dot2c_f32_bf16 v22, s44, v104
  v_dot2c_f32_bf16 v23, v104, v104
  v_dot2c_f32_bf16 v22, s44, v105
  v_dot2c_f32_bf16 v23, v105, v105
  v_dot2c_f32_bf16 v22, s44, v106
  v_dot2c_f32_bf16 v23, v106, v106
  v_dot2c_f32_bf16 v22, s44, v107
  v_dot2c_f32_bf16 v23, v107, v107
  v_dot2c_f32_bf16 v22, s44, v108
  v_dot2c_f32_bf16 v23, v108, v108
  v_dot2c_f32_bf16 v22, s44, v109
  v_dot2c_f32_bf16 v23, v109, v109
  v_dot2c_f32_bf16 v22, s44, v110
  v_dot2c_f32_bf16 v23, v110, v110
  v_dot2c_f32_bf16 v22, s44, v111
  v_dot2c_f32_bf16 v23, v111, v111
  v_dot2c_f32_bf16 v24, s44, v112
  v_dot2c_f32_bf16 v25, v112, v112
  v_dot2c_f32_bf16 v24, s44, v113
  v_dot2c_f32_bf16 v25, v113, v113
  v_dot2c_f32_bf16 v24, s44, v114
  v_dot2c_f32_bf16 v25, v114, v114
  v_dot2c_f32_bf16 v24, s44, v115
  v_dot2c_f32_bf16 v25, v115, v115
  v_dot2c_f32_bf16 v24, s44, v116
  v_dot2c_f32_bf16 v25, v116, v116
  v_dot2c_f32_bf16 v24, s44, v117
  v_dot2c_f32_bf16 v25, v117, v117
  v_dot2c_f32_bf16 v24, s44, v118
  v_dot2c_f32_bf16 v25, v118, v118
  v_dot2c_f32_bf16 v24, s44, v119
  v_dot2c_f32_bf16 v25, v119, v119
  v_dot2c_f32_bf16 v26, s44, v120
  v_dot2c_f32_bf16 v27, v120, v120
  v_dot2c_f32_bf16 v26, s44, v121
  v_dot2c_f32_bf16 v27, v121, v121
  v_dot2c_f32_bf16 v26, s44, v122
  v_dot2c_f32_bf16 v27, v122, v122
  v_dot2c_f32_bf16 v26, s44, v123
  v_dot2c_f32_bf16 v27, v123, v123
  v_dot2c_f32_bf16 v26, s44, v124
  v_dot2c_f32_bf16 v27, v124, v124
  v_dot2c_f32_bf16 v26, s44, v125
  v_dot2c_f32_bf16 v27, v125, v125
  v_dot2c_f32_bf16 v26, s44, v126
  v_dot2c_f32_bf16 v27, v126, v126
  v_dot2c_f32_bf16 v26, s44, v127
  v_dot2c_f32_bf16 v27, v127, v127
  v_permlane32_swap_b32 v20, v24
  v_permlane32_swap_b32 v21, v25
  v_permlane32_swap_b32 v22, v26
  v_permlane32_swap_b32 v23, v27
  v_add_f32 v20, v20, v24
  v_add_f32 v21, v21, v25
  v_add_f32 v22, v22, v26
  v_add_f32 v23, v23, v27
  s_nop 0
  v_permlane16_swap_b32 v20, v22
  v_permlane16_swap_b32 v21, v23
  v_add_f32 v20, v20, v22
  v_add_f32 v21, v21, v23
  v_lshlrev_b32 v2, 3, v1
  buffer_store_dwordx2 v[20:21], v2, s[4:7], s53 offen sc1
k3_cbody:
  s_lshr_b32 s29, s2, 3
  s_lshl_b32 s27, s28, 3
  s_and_b32 s27, s27, 16
  s_xor_b32 s29, s29, s27
  s_xor_b32 s29, s29, 16
  s_load_dwordx2 s[20:21], s[0:1], 88
  s_mov_b32 s22, 4194304
  s_mov_b32 s23, 0x20000
  s_lshr_b32 s36, s28, 2
  s_mul_i32 s36, s36, 8
  s_lshr_b32 s37, s29, 2
  s_add_u32 s34, s36, s37
  s_and_b32 s36, s28, 3
  s_mul_i32 s36, s36, 4
  s_and_b32 s37, s29, 3
  s_add_u32 s35, s36, s37
  s_mul_i32 s30, s34, 262144
  s_add_u32 s30, s30, 16777216
  s_mul_i32 s31, s35, 448
  s_lshr_b32 s40, s33, 1
  s_and_b32 s41, s33, 1
  v_and_b32 v2, 15, v1
  v_lshrrev_b32 v3, 4, v1
  v_lshlrev_b32 v4, 11, v3
  v_lshl_add_u32 v4, v2, 4, v4
  s_lshl_b32 s36, s40, 10
  v_add_u32_e64 v6, s36, v4
  v_add_u32 v7, 8192, v6
  v_bfe_u32 v2, v1, 2, 2
  v_lshl_add_u32 v2, v3, 3, v2
  v_bfe_u32 v4, v2, 3, 1
  v_mul_u32_u24 v2, 448, v2
  v_and_b32 v3, 3, v1
  v_lshl_add_u32 v2, v3, 3, v2
  v_add_u32 v2, 16384, v2
  s_mul_i32 s36, s41, 7
  s_lshl_b32 s37, s41, 1
  s_add_u32 s37, s37, 0
  v_xor_b32 v3, s37, v4
  v_lshl_add_u32 v10, v3, 5, v2
  s_lshl_b32 s37, s41, 1
  s_add_u32 s37, s37, 1
  v_xor_b32 v3, s37, v4
  v_lshl_add_u32 v11, v3, 5, v2
  s_add_u32 s37, s41, 12
  v_xor_b32 v3, s37, v4
  v_lshl_add_u32 v12, v3, 5, v2
  v_add_u32 v8, 90112, v6
  v_add_u32 v9, 90112, v7
  v_add_u32 v13, 90112, v10
  v_add_u32 v14, 90112, v11
  v_add_u32 v15, 90112, v12
  v_and_b32 v2, 15, v1
  v_lshrrev_b32 v3, 4, v1
  v_and_b32 v4, 1, v3
  v_lshrrev_b32 v3, 1, v3
  v_lshl_or_b32 v3, v4, 1, v3
  v_lshlrev_b32 v3, 11, v3
  v_lshl_add_u32 v3, v2, 4, v3
  s_lshl_b32 s36, s41, 13
  s_lshl_b32 s37, s40, 10
  s_add_u32 s36, s36, s37
  v_add_u32 v18, s36, v3
  v_add_u32 v19, 65536, v18
  s_and_b32 s38, s35, 1
  s_lshl_b32 s36, s38, 13
  v_add_u32 v28, s36, v18
  v_add_u32 v29, 16384, v28
  v_add_u32 v30, 32768, v28
  v_lshrrev_b32 v3, 5, v1
  v_lshlrev_b32 v3, 11, v3
  v_and_b32 v4, 31, v1
  v_lshl_add_u32 v31, v4, 4, v3
  s_xor_b32 s38, s38, 1
  s_mul_i32 s38, s38, 49152
  s_add_u32 s38, s38, s37
  s_lshl_b32 s36, s41, 12
  s_add_u32 s38, s38, s36
  v_add_u32 v31, s38, v31
  s_mul_i32 s38, s35, 57344
  s_mul_i32 s36, s34, 917504
  s_add_u32 s38, s38, s36
  s_add_u32 s38, s38, 50331648
  s_lshl_b32 s50, s34, 4
  s_add_u32 s50, s50, s35
  s_lshl_b32 s50, s50, 5
  s_add_u32 s50, s50, s33
  s_lshl_b32 s50, s50, 2
  s_add_u32 s50, s50, 40009728
  s_waitcnt lgkmcnt(0)
  s_waitcnt vmcnt(0)
  s_barrier
  v_mov_b32 v32, 0
  v_mov_b32 v33, 0
  v_mov_b32 v34, 0
  v_mov_b32 v35, 0
  v_mov_b32 v36, 0
  v_mov_b32 v37, 0
  v_mov_b32 v38, 0
  v_mov_b32 v39, 0
  v_mov_b32 v40, 0
  v_mov_b32 v41, 0
  v_mov_b32 v42, 0
  v_mov_b32 v43, 0
  v_mov_b32 v44, 0
  v_mov_b32 v45, 0
  v_mov_b32 v46, 0
  v_mov_b32 v47, 0
  v_mov_b32 v48, 0
  v_mov_b32 v49, 0
  v_mov_b32 v50, 0
  v_mov_b32 v51, 0
  v_mov_b32 v52, 0
  v_mov_b32 v53, 0
  v_mov_b32 v54, 0
  v_mov_b32 v55, 0
  v_mov_b32 v56, 0
  v_mov_b32 v57, 0
  v_mov_b32 v58, 0
  v_mov_b32 v59, 0
  v_mov_b32 v60, 0
  v_mov_b32 v61, 0
  v_mov_b32 v62, 0
  v_mov_b32 v63, 0
  v_mov_b32 v64, 0
  v_mov_b32 v65, 0
  v_mov_b32 v66, 0
  v_mov_b32 v67, 0
  v_mov_b32 v68, 0
  v_mov_b32 v69, 0
  v_mov_b32 v70, 0
  v_mov_b32 v71, 0
  v_mov_b32 v72, 0
  v_mov_b32 v73, 0
  v_mov_b32 v74, 0
  v_mov_b32 v75, 0
  v_mov_b32 v76, 0
  v_mov_b32 v77, 0
  v_mov_b32 v78, 0
  v_mov_b32 v79, 0
  v_mov_b32 v80, 0
  v_mov_b32 v81, 0
  v_mov_b32 v82, 0
  v_mov_b32 v83, 0
  v_mov_b32 v84, 0
  v_mov_b32 v85, 0
  v_mov_b32 v86, 0
  v_mov_b32 v87, 0
  v_mov_b32 v88, 0
  v_mov_b32 v89, 0
  v_mov_b32 v90, 0
  v_mov_b32 v91, 0
  v_mov_b32 v92, 0
  v_mov_b32 v93, 0
  v_mov_b32 v94, 0
  v_mov_b32 v95, 0
  v_mov_b32 v96, 0
  v_mov_b32 v97, 0
  v_mov_b32 v98, 0
  v_mov_b32 v99, 0
  v_mov_b32 v100, 0
  v_mov_b32 v101, 0
  v_mov_b32 v102, 0
  v_mov_b32 v103, 0
  v_mov_b32 v104, 0
  v_mov_b32 v105, 0
  v_mov_b32 v106, 0
  v_mov_b32 v107, 0
  v_mov_b32 v108, 0
  v_mov_b32 v109, 0
  v_mov_b32 v110, 0
  v_mov_b32 v111, 0
  v_mov_b32 v112, 0
  v_mov_b32 v113, 0
  v_mov_b32 v114, 0
  v_mov_b32 v115, 0
  v_mov_b32 v116, 0
  v_mov_b32 v117, 0
  v_mov_b32 v118, 0
  v_mov_b32 v119, 0
  v_mov_b32 v120, 0
  v_mov_b32 v121, 0
  v_mov_b32 v122, 0
  v_mov_b32 v123, 0
  v_mov_b32 v124, 0
  v_mov_b32 v125, 0
  v_mov_b32 v126, 0
  v_mov_b32 v127, 0
  v_mov_b32 v128, 0
  v_mov_b32 v129, 0
  v_mov_b32 v130, 0
  v_mov_b32 v131, 0
  v_mov_b32 v132, 0
  v_mov_b32 v133, 0
  v_mov_b32 v134, 0
  v_mov_b32 v135, 0
  v_mov_b32 v136, 0
  v_mov_b32 v137, 0
  v_mov_b32 v138, 0
  v_mov_b32 v139, 0
  v_mov_b32 v140, 0
  v_mov_b32 v141, 0
  v_mov_b32 v142, 0
  v_mov_b32 v143, 0
  s_barrier
  s_barrier
  ds_read_b64_tr_b16 a[0:1], v10 offset:0
  ds_read_b64_tr_b16 a[2:3], v10 offset:1792
  ds_read_b128 v[160:163], v6 offset:0
  ds_read_b128 v[164:167], v6 offset:256
  ds_read_b128 v[168:171], v6 offset:512
  ds_read_b128 v[172:175], v6 offset:768
  ds_read_b64_tr_b16 a[4:5], v11 offset:0
  ds_read_b64_tr_b16 a[6:7], v11 offset:1792
  ds_read_b64_tr_b16 a[8:9], v10 offset:128
  ds_read_b64_tr_b16 a[10:11], v10 offset:1920
  ds_read_b64_tr_b16 a[12:13], v11 offset:128
  ds_read_b64_tr_b16 a[14:15], v11 offset:1920
  ds_read_b64_tr_b16 a[16:17], v10 offset:256
  ds_read_b64_tr_b16 a[18:19], v10 offset:2048
  ds_read_b64_tr_b16 a[20:21], v11 offset:256
  ds_read_b64_tr_b16 a[22:23], v11 offset:2048
  ds_read_b64_tr_b16 a[24:25], v12 offset:0
  ds_read_b64_tr_b16 a[26:27], v12 offset:1792
  s_mov_b32 s32, 5
  .p2align 3
recurrent_scan__ssm_conv_h3__mixer_s_mlp__prompt_kernel_cm1001:
  s_waitcnt lgkmcnt(15)
  v_mfma_f32_16x16x32_bf16 v[32:35], a[0:3], v[160:163], v[32:35]
  ds_read_b64_tr_b16 a[28:29], v10 offset:14336
  s_waitcnt lgkmcnt(15)
  v_mfma_f32_16x16x32_bf16 v[60:63], a[0:3], v[164:167], v[60:63]
  ds_read_b64_tr_b16 a[30:31], v10 offset:16128
  s_waitcnt lgkmcnt(15)
  v_mfma_f32_16x16x32_bf16 v[88:91], a[0:3], v[168:171], v[88:91]
  ds_read_b128 v[176:179], v7 offset:0
  s_waitcnt lgkmcnt(15)
  v_mfma_f32_16x16x32_bf16 v[116:119], a[0:3], v[172:175], v[116:119]
  ds_read_b128 v[180:183], v7 offset:256
  s_waitcnt lgkmcnt(14)
  v_mfma_f32_16x16x32_bf16 v[36:39], a[4:7], v[160:163], v[36:39]
  ds_read_b128 v[184:187], v7 offset:512
  v_mfma_f32_16x16x32_bf16 v[64:67], a[4:7], v[164:167], v[64:67]
  ds_read_b128 v[188:191], v7 offset:768
  v_mfma_f32_16x16x32_bf16 v[92:95], a[4:7], v[168:171], v[92:95]
  ds_read_b64_tr_b16 a[32:33], v11 offset:14336
  v_mfma_f32_16x16x32_bf16 v[120:123], a[4:7], v[172:175], v[120:123]
  ds_read_b64_tr_b16 a[34:35], v11 offset:16128
  s_waitcnt lgkmcnt(15)
  v_mfma_f32_16x16x32_bf16 v[40:43], a[8:11], v[160:163], v[40:43]
  ds_read_b64_tr_b16 a[36:37], v10 offset:14464
  v_mfma_f32_16x16x32_bf16 v[68:71], a[8:11], v[164:167], v[68:71]
  ds_read_b64_tr_b16 a[38:39], v10 offset:16256
  v_mfma_f32_16x16x32_bf16 v[96:99], a[8:11], v[168:171], v[96:99]
  ds_read_b64_tr_b16 a[40:41], v11 offset:14464
  v_mfma_f32_16x16x32_bf16 v[124:127], a[8:11], v[172:175], v[124:127]
  ds_read_b64_tr_b16 a[42:43], v11 offset:16256
  s_waitcnt lgkmcnt(15)
  v_mfma_f32_16x16x32_bf16 v[44:47], a[12:15], v[160:163], v[44:47]
  ds_read_b64_tr_b16 a[44:45], v10 offset:14592
  v_mfma_f32_16x16x32_bf16 v[72:75], a[12:15], v[164:167], v[72:75]
  ds_read_b64_tr_b16 a[46:47], v10 offset:16384
  v_mfma_f32_16x16x32_bf16 v[100:103], a[12:15], v[168:171], v[100:103]
  ds_read_b64_tr_b16 a[48:49], v11 offset:14592
  v_mfma_f32_16x16x32_bf16 v[128:131], a[12:15], v[172:175], v[128:131]
  ds_read_b64_tr_b16 a[50:51], v11 offset:16384
  v_mfma_f32_16x16x32_bf16 v[48:51], a[16:19], v[160:163], v[48:51]
  ds_read_b64_tr_b16 a[52:53], v12 offset:14336
  v_mfma_f32_16x16x32_bf16 v[76:79], a[16:19], v[164:167], v[76:79]
  ds_read_b64_tr_b16 a[54:55], v12 offset:16128
  v_mfma_f32_16x16x32_bf16 v[104:107], a[16:19], v[168:171], v[104:107]
  v_mfma_f32_16x16x32_bf16 v[132:135], a[16:19], v[172:175], v[132:135]
  s_waitcnt lgkmcnt(15)
  v_mfma_f32_16x16x32_bf16 v[52:55], a[20:23], v[160:163], v[52:55]
  v_mfma_f32_16x16x32_bf16 v[80:83], a[20:23], v[164:167], v[80:83]
  v_mfma_f32_16x16x32_bf16 v[108:111], a[20:23], v[168:171], v[108:111]
  v_mfma_f32_16x16x32_bf16 v[136:139], a[20:23], v[172:175], v[136:139]
  v_mfma_f32_16x16x32_bf16 v[56:59], a[24:27], v[160:163], v[56:59]
  v_mfma_f32_16x16x32_bf16 v[84:87], a[24:27], v[164:167], v[84:87]
  v_mfma_f32_16x16x32_bf16 v[112:115], a[24:27], v[168:171], v[112:115]
  v_mfma_f32_16x16x32_bf16 v[140:143], a[24:27], v[172:175], v[140:143]
  v_mfma_f32_16x16x32_bf16 v[32:35], a[28:31], v[176:179], v[32:35]
  s_waitcnt lgkmcnt(14)
  v_mfma_f32_16x16x32_bf16 v[60:63], a[28:31], v[180:183], v[60:63]
  s_waitcnt lgkmcnt(13)
  v_mfma_f32_16x16x32_bf16 v[88:91], a[28:31], v[184:187], v[88:91]
  s_waitcnt lgkmcnt(12)
  v_mfma_f32_16x16x32_bf16 v[116:119], a[28:31], v[188:191], v[116:119]
  s_waitcnt lgkmcnt(10)
  v_mfma_f32_16x16x32_bf16 v[36:39], a[32:35], v[176:179], v[36:39]
  s_waitcnt lgkmcnt(0)
  s_barrier
  ds_read_b64_tr_b16 a[0:1], v10 offset:45056
  v_mfma_f32_16x16x32_bf16 v[64:67], a[32:35], v[180:183], v[64:67]
  ds_read_b64_tr_b16 a[2:3], v10 offset:46848
  v_mfma_f32_16x16x32_bf16 v[92:95], a[32:35], v[184:187], v[92:95]
  ds_read_b128 v[160:163], v6 offset:45056
  v_mfma_f32_16x16x32_bf16 v[120:123], a[32:35], v[188:191], v[120:123]
  ds_read_b128 v[164:167], v6 offset:45312
  v_mfma_f32_16x16x32_bf16 v[40:43], a[36:39], v[176:179], v[40:43]
  ds_read_b128 v[168:171], v6 offset:45568
  v_mfma_f32_16x16x32_bf16 v[68:71], a[36:39], v[180:183], v[68:71]
  ds_read_b128 v[172:175], v6 offset:45824
  v_mfma_f32_16x16x32_bf16 v[96:99], a[36:39], v[184:187], v[96:99]
  ds_read_b64_tr_b16 a[4:5], v11 offset:45056
  v_mfma_f32_16x16x32_bf16 v[124:127], a[36:39], v[188:191], v[124:127]
  ds_read_b64_tr_b16 a[6:7], v11 offset:46848
  v_mfma_f32_16x16x32_bf16 v[44:47], a[40:43], v[176:179], v[44:47]
  ds_read_b64_tr_b16 a[8:9], v10 offset:45184
  v_mfma_f32_16x16x32_bf16 v[72:75], a[40:43], v[180:183], v[72:75]
  ds_read_b64_tr_b16 a[10:11], v10 offset:46976
  v_mfma_f32_16x16x32_bf16 v[100:103], a[40:43], v[184:187], v[100:103]
  ds_read_b64_tr_b16 a[12:13], v11 offset:45184
  v_mfma_f32_16x16x32_bf16 v[128:131], a[40:43], v[188:191], v[128:131]
  ds_read_b64_tr_b16 a[14:15], v11 offset:46976
  v_mfma_f32_16x16x32_bf16 v[48:51], a[44:47], v[176:179], v[48:51]
  ds_read_b64_tr_b16 a[16:17], v10 offset:45312
  v_mfma_f32_16x16x32_bf16 v[76:79], a[44:47], v[180:183], v[76:79]
  ds_read_b64_tr_b16 a[18:19], v10 offset:47104
  v_mfma_f32_16x16x32_bf16 v[104:107], a[44:47], v[184:187], v[104:107]
  ds_read_b64_tr_b16 a[20:21], v11 offset:45312
  v_mfma_f32_16x16x32_bf16 v[132:135], a[44:47], v[188:191], v[132:135]
  ds_read_b64_tr_b16 a[22:23], v11 offset:47104
  v_mfma_f32_16x16x32_bf16 v[52:55], a[48:51], v[176:179], v[52:55]
  ds_read_b64_tr_b16 a[24:25], v12 offset:45056
  v_mfma_f32_16x16x32_bf16 v[80:83], a[48:51], v[180:183], v[80:83]
  ds_read_b64_tr_b16 a[26:27], v12 offset:46848
  v_mfma_f32_16x16x32_bf16 v[108:111], a[48:51], v[184:187], v[108:111]
  v_mfma_f32_16x16x32_bf16 v[136:139], a[48:51], v[188:191], v[136:139]
  v_mfma_f32_16x16x32_bf16 v[56:59], a[52:55], v[176:179], v[56:59]
  v_mfma_f32_16x16x32_bf16 v[84:87], a[52:55], v[180:183], v[84:87]
  v_mfma_f32_16x16x32_bf16 v[112:115], a[52:55], v[184:187], v[112:115]
  v_mfma_f32_16x16x32_bf16 v[140:143], a[52:55], v[188:191], v[140:143]
  s_waitcnt lgkmcnt(15)
  v_mfma_f32_16x16x32_bf16 v[32:35], a[0:3], v[160:163], v[32:35]
  ds_read_b64_tr_b16 a[28:29], v10 offset:59392
  s_waitcnt lgkmcnt(15)
  v_mfma_f32_16x16x32_bf16 v[60:63], a[0:3], v[164:167], v[60:63]
  ds_read_b64_tr_b16 a[30:31], v10 offset:61184
  s_waitcnt lgkmcnt(15)
  v_mfma_f32_16x16x32_bf16 v[88:91], a[0:3], v[168:171], v[88:91]
  ds_read_b128 v[176:179], v7 offset:45056
  s_waitcnt lgkmcnt(15)
  v_mfma_f32_16x16x32_bf16 v[116:119], a[0:3], v[172:175], v[116:119]
  ds_read_b128 v[180:183], v7 offset:45312
  s_waitcnt lgkmcnt(14)
  v_mfma_f32_16x16x32_bf16 v[36:39], a[4:7], v[160:163], v[36:39]
  ds_read_b128 v[184:187], v7 offset:45568
  v_mfma_f32_16x16x32_bf16 v[64:67], a[4:7], v[164:167], v[64:67]
  ds_read_b128 v[188:191], v7 offset:45824
  v_mfma_f32_16x16x32_bf16 v[92:95], a[4:7], v[168:171], v[92:95]
  ds_read_b64_tr_b16 a[32:33], v11 offset:59392
  v_mfma_f32_16x16x32_bf16 v[120:123], a[4:7], v[172:175], v[120:123]
  ds_read_b64_tr_b16 a[34:35], v11 offset:61184
  s_waitcnt lgkmcnt(15)
  v_mfma_f32_16x16x32_bf16 v[40:43], a[8:11], v[160:163], v[40:43]
  ds_read_b64_tr_b16 a[36:37], v10 offset:59520
  v_mfma_f32_16x16x32_bf16 v[68:71], a[8:11], v[164:167], v[68:71]
  ds_read_b64_tr_b16 a[38:39], v10 offset:61312
  v_mfma_f32_16x16x32_bf16 v[96:99], a[8:11], v[168:171], v[96:99]
  ds_read_b64_tr_b16 a[40:41], v11 offset:59520
  v_mfma_f32_16x16x32_bf16 v[124:127], a[8:11], v[172:175], v[124:127]
  ds_read_b64_tr_b16 a[42:43], v11 offset:61312
  s_waitcnt lgkmcnt(15)
  v_mfma_f32_16x16x32_bf16 v[44:47], a[12:15], v[160:163], v[44:47]
  ds_read_b64_tr_b16 a[44:45], v10 offset:59648
  v_mfma_f32_16x16x32_bf16 v[72:75], a[12:15], v[164:167], v[72:75]
  ds_read_b64_tr_b16 a[46:47], v10 offset:61440
  v_mfma_f32_16x16x32_bf16 v[100:103], a[12:15], v[168:171], v[100:103]
  ds_read_b64_tr_b16 a[48:49], v11 offset:59648
  v_mfma_f32_16x16x32_bf16 v[128:131], a[12:15], v[172:175], v[128:131]
  ds_read_b64_tr_b16 a[50:51], v11 offset:61440
  v_mfma_f32_16x16x32_bf16 v[48:51], a[16:19], v[160:163], v[48:51]
  ds_read_b64_tr_b16 a[52:53], v12 offset:59392
  v_mfma_f32_16x16x32_bf16 v[76:79], a[16:19], v[164:167], v[76:79]
  ds_read_b64_tr_b16 a[54:55], v12 offset:61184
  v_mfma_f32_16x16x32_bf16 v[104:107], a[16:19], v[168:171], v[104:107]
  v_mfma_f32_16x16x32_bf16 v[132:135], a[16:19], v[172:175], v[132:135]
  s_waitcnt lgkmcnt(15)
  v_mfma_f32_16x16x32_bf16 v[52:55], a[20:23], v[160:163], v[52:55]
  v_mfma_f32_16x16x32_bf16 v[80:83], a[20:23], v[164:167], v[80:83]
  v_mfma_f32_16x16x32_bf16 v[108:111], a[20:23], v[168:171], v[108:111]
  v_mfma_f32_16x16x32_bf16 v[136:139], a[20:23], v[172:175], v[136:139]
  v_mfma_f32_16x16x32_bf16 v[56:59], a[24:27], v[160:163], v[56:59]
  v_mfma_f32_16x16x32_bf16 v[84:87], a[24:27], v[164:167], v[84:87]
  v_mfma_f32_16x16x32_bf16 v[112:115], a[24:27], v[168:171], v[112:115]
  v_mfma_f32_16x16x32_bf16 v[140:143], a[24:27], v[172:175], v[140:143]
  v_mfma_f32_16x16x32_bf16 v[32:35], a[28:31], v[176:179], v[32:35]
  s_waitcnt lgkmcnt(14)
  v_mfma_f32_16x16x32_bf16 v[60:63], a[28:31], v[180:183], v[60:63]
  s_waitcnt lgkmcnt(13)
  v_mfma_f32_16x16x32_bf16 v[88:91], a[28:31], v[184:187], v[88:91]
  s_waitcnt lgkmcnt(12)
  v_mfma_f32_16x16x32_bf16 v[116:119], a[28:31], v[188:191], v[116:119]
  s_waitcnt lgkmcnt(10)
  v_mfma_f32_16x16x32_bf16 v[36:39], a[32:35], v[176:179], v[36:39]
  s_waitcnt lgkmcnt(0)
  s_barrier
  ds_read_b64_tr_b16 a[0:1], v13 offset:0
  v_mfma_f32_16x16x32_bf16 v[64:67], a[32:35], v[180:183], v[64:67]
  ds_read_b64_tr_b16 a[2:3], v13 offset:1792
  v_mfma_f32_16x16x32_bf16 v[92:95], a[32:35], v[184:187], v[92:95]
  ds_read_b128 v[160:163], v8 offset:0
  v_mfma_f32_16x16x32_bf16 v[120:123], a[32:35], v[188:191], v[120:123]
  ds_read_b128 v[164:167], v8 offset:256
  v_mfma_f32_16x16x32_bf16 v[40:43], a[36:39], v[176:179], v[40:43]
  ds_read_b128 v[168:171], v8 offset:512
  v_mfma_f32_16x16x32_bf16 v[68:71], a[36:39], v[180:183], v[68:71]
  ds_read_b128 v[172:175], v8 offset:768
  v_mfma_f32_16x16x32_bf16 v[96:99], a[36:39], v[184:187], v[96:99]
  ds_read_b64_tr_b16 a[4:5], v14 offset:0
  v_mfma_f32_16x16x32_bf16 v[124:127], a[36:39], v[188:191], v[124:127]
  ds_read_b64_tr_b16 a[6:7], v14 offset:1792
  v_mfma_f32_16x16x32_bf16 v[44:47], a[40:43], v[176:179], v[44:47]
  ds_read_b64_tr_b16 a[8:9], v13 offset:128
  v_mfma_f32_16x16x32_bf16 v[72:75], a[40:43], v[180:183], v[72:75]
  ds_read_b64_tr_b16 a[10:11], v13 offset:1920
  v_mfma_f32_16x16x32_bf16 v[100:103], a[40:43], v[184:187], v[100:103]
  ds_read_b64_tr_b16 a[12:13], v14 offset:128
  v_mfma_f32_16x16x32_bf16 v[128:131], a[40:43], v[188:191], v[128:131]
  ds_read_b64_tr_b16 a[14:15], v14 offset:1920
  v_mfma_f32_16x16x32_bf16 v[48:51], a[44:47], v[176:179], v[48:51]
  ds_read_b64_tr_b16 a[16:17], v13 offset:256
  v_mfma_f32_16x16x32_bf16 v[76:79], a[44:47], v[180:183], v[76:79]
  ds_read_b64_tr_b16 a[18:19], v13 offset:2048
  v_mfma_f32_16x16x32_bf16 v[104:107], a[44:47], v[184:187], v[104:107]
  ds_read_b64_tr_b16 a[20:21], v14 offset:256
  v_mfma_f32_16x16x32_bf16 v[132:135], a[44:47], v[188:191], v[132:135]
  ds_read_b64_tr_b16 a[22:23], v14 offset:2048
  v_mfma_f32_16x16x32_bf16 v[52:55], a[48:51], v[176:179], v[52:55]
  ds_read_b64_tr_b16 a[24:25], v15 offset:0
  v_mfma_f32_16x16x32_bf16 v[80:83], a[48:51], v[180:183], v[80:83]
  ds_read_b64_tr_b16 a[26:27], v15 offset:1792
  v_mfma_f32_16x16x32_bf16 v[108:111], a[48:51], v[184:187], v[108:111]
  v_mfma_f32_16x16x32_bf16 v[136:139], a[48:51], v[188:191], v[136:139]
  v_mfma_f32_16x16x32_bf16 v[56:59], a[52:55], v[176:179], v[56:59]
  v_mfma_f32_16x16x32_bf16 v[84:87], a[52:55], v[180:183], v[84:87]
  v_mfma_f32_16x16x32_bf16 v[112:115], a[52:55], v[184:187], v[112:115]
  v_mfma_f32_16x16x32_bf16 v[140:143], a[52:55], v[188:191], v[140:143]
  s_waitcnt lgkmcnt(15)
  v_mfma_f32_16x16x32_bf16 v[32:35], a[0:3], v[160:163], v[32:35]
  ds_read_b64_tr_b16 a[28:29], v13 offset:14336
  s_waitcnt lgkmcnt(15)
  v_mfma_f32_16x16x32_bf16 v[60:63], a[0:3], v[164:167], v[60:63]
  ds_read_b64_tr_b16 a[30:31], v13 offset:16128
  s_waitcnt lgkmcnt(15)
  v_mfma_f32_16x16x32_bf16 v[88:91], a[0:3], v[168:171], v[88:91]
  ds_read_b128 v[176:179], v9 offset:0
  s_waitcnt lgkmcnt(15)
  v_mfma_f32_16x16x32_bf16 v[116:119], a[0:3], v[172:175], v[116:119]
  ds_read_b128 v[180:183], v9 offset:256
  s_waitcnt lgkmcnt(14)
  v_mfma_f32_16x16x32_bf16 v[36:39], a[4:7], v[160:163], v[36:39]
  ds_read_b128 v[184:187], v9 offset:512
  v_mfma_f32_16x16x32_bf16 v[64:67], a[4:7], v[164:167], v[64:67]
  ds_read_b128 v[188:191], v9 offset:768
  v_mfma_f32_16x16x32_bf16 v[92:95], a[4:7], v[168:171], v[92:95]
  ds_read_b64_tr_b16 a[32:33], v14 offset:14336
  v_mfma_f32_16x16x32_bf16 v[120:123], a[4:7], v[172:175], v[120:123]
  ds_read_b64_tr_b16 a[34:35], v14 offset:16128
  s_waitcnt lgkmcnt(15)
  v_mfma_f32_16x16x32_bf16 v[40:43], a[8:11], v[160:163], v[40:43]
  ds_read_b64_tr_b16 a[36:37], v13 offset:14464
  v_mfma_f32_16x16x32_bf16 v[68:71], a[8:11], v[164:167], v[68:71]
  ds_read_b64_tr_b16 a[38:39], v13 offset:16256
  v_mfma_f32_16x16x32_bf16 v[96:99], a[8:11], v[168:171], v[96:99]
  ds_read_b64_tr_b16 a[40:41], v14 offset:14464
  v_mfma_f32_16x16x32_bf16 v[124:127], a[8:11], v[172:175], v[124:127]
  ds_read_b64_tr_b16 a[42:43], v14 offset:16256
  s_waitcnt lgkmcnt(15)
  v_mfma_f32_16x16x32_bf16 v[44:47], a[12:15], v[160:163], v[44:47]
  ds_read_b64_tr_b16 a[44:45], v13 offset:14592
  v_mfma_f32_16x16x32_bf16 v[72:75], a[12:15], v[164:167], v[72:75]
  ds_read_b64_tr_b16 a[46:47], v13 offset:16384
  v_mfma_f32_16x16x32_bf16 v[100:103], a[12:15], v[168:171], v[100:103]
  ds_read_b64_tr_b16 a[48:49], v14 offset:14592
  v_mfma_f32_16x16x32_bf16 v[128:131], a[12:15], v[172:175], v[128:131]
  ds_read_b64_tr_b16 a[50:51], v14 offset:16384
  v_mfma_f32_16x16x32_bf16 v[48:51], a[16:19], v[160:163], v[48:51]
  ds_read_b64_tr_b16 a[52:53], v15 offset:14336
  v_mfma_f32_16x16x32_bf16 v[76:79], a[16:19], v[164:167], v[76:79]
  ds_read_b64_tr_b16 a[54:55], v15 offset:16128
  v_mfma_f32_16x16x32_bf16 v[104:107], a[16:19], v[168:171], v[104:107]
  v_mfma_f32_16x16x32_bf16 v[132:135], a[16:19], v[172:175], v[132:135]
  s_waitcnt lgkmcnt(15)
  v_mfma_f32_16x16x32_bf16 v[52:55], a[20:23], v[160:163], v[52:55]
  v_mfma_f32_16x16x32_bf16 v[80:83], a[20:23], v[164:167], v[80:83]
  v_mfma_f32_16x16x32_bf16 v[108:111], a[20:23], v[168:171], v[108:111]
  v_mfma_f32_16x16x32_bf16 v[136:139], a[20:23], v[172:175], v[136:139]
  v_mfma_f32_16x16x32_bf16 v[56:59], a[24:27], v[160:163], v[56:59]
  v_mfma_f32_16x16x32_bf16 v[84:87], a[24:27], v[164:167], v[84:87]
  v_mfma_f32_16x16x32_bf16 v[112:115], a[24:27], v[168:171], v[112:115]
  v_mfma_f32_16x16x32_bf16 v[140:143], a[24:27], v[172:175], v[140:143]
  v_mfma_f32_16x16x32_bf16 v[32:35], a[28:31], v[176:179], v[32:35]
  s_waitcnt lgkmcnt(14)
  v_mfma_f32_16x16x32_bf16 v[60:63], a[28:31], v[180:183], v[60:63]
  s_waitcnt lgkmcnt(13)
  v_mfma_f32_16x16x32_bf16 v[88:91], a[28:31], v[184:187], v[88:91]
  s_waitcnt lgkmcnt(12)
  v_mfma_f32_16x16x32_bf16 v[116:119], a[28:31], v[188:191], v[116:119]
  s_waitcnt lgkmcnt(10)
  v_mfma_f32_16x16x32_bf16 v[36:39], a[32:35], v[176:179], v[36:39]
  s_waitcnt lgkmcnt(0)
  s_barrier
  ds_read_b64_tr_b16 a[0:1], v10 offset:0
  v_mfma_f32_16x16x32_bf16 v[64:67], a[32:35], v[180:183], v[64:67]
  ds_read_b64_tr_b16 a[2:3], v10 offset:1792
  v_mfma_f32_16x16x32_bf16 v[92:95], a[32:35], v[184:187], v[92:95]
  ds_read_b128 v[160:163], v6 offset:0
  v_mfma_f32_16x16x32_bf16 v[120:123], a[32:35], v[188:191], v[120:123]
  ds_read_b128 v[164:167], v6 offset:256
  v_mfma_f32_16x16x32_bf16 v[40:43], a[36:39], v[176:179], v[40:43]
  ds_read_b128 v[168:171], v6 offset:512
  v_mfma_f32_16x16x32_bf16 v[68:71], a[36:39], v[180:183], v[68:71]
  ds_read_b128 v[172:175], v6 offset:768
  v_mfma_f32_16x16x32_bf16 v[96:99], a[36:39], v[184:187], v[96:99]
  ds_read_b64_tr_b16 a[4:5], v11 offset:0
  v_mfma_f32_16x16x32_bf16 v[124:127], a[36:39], v[188:191], v[124:127]
  ds_read_b64_tr_b16 a[6:7], v11 offset:1792
  v_mfma_f32_16x16x32_bf16 v[44:47], a[40:43], v[176:179], v[44:47]
  ds_read_b64_tr_b16 a[8:9], v10 offset:128
  v_mfma_f32_16x16x32_bf16 v[72:75], a[40:43], v[180:183], v[72:75]
  ds_read_b64_tr_b16 a[10:11], v10 offset:1920
  v_mfma_f32_16x16x32_bf16 v[100:103], a[40:43], v[184:187], v[100:103]
  ds_read_b64_tr_b16 a[12:13], v11 offset:128
  v_mfma_f32_16x16x32_bf16 v[128:131], a[40:43], v[188:191], v[128:131]
  ds_read_b64_tr_b16 a[14:15], v11 offset:1920
  v_mfma_f32_16x16x32_bf16 v[48:51], a[44:47], v[176:179], v[48:51]
  ds_read_b64_tr_b16 a[16:17], v10 offset:256
  v_mfma_f32_16x16x32_bf16 v[76:79], a[44:47], v[180:183], v[76:79]
  ds_read_b64_tr_b16 a[18:19], v10 offset:2048
  v_mfma_f32_16x16x32_bf16 v[104:107], a[44:47], v[184:187], v[104:107]
  ds_read_b64_tr_b16 a[20:21], v11 offset:256
  v_mfma_f32_16x16x32_bf16 v[132:135], a[44:47], v[188:191], v[132:135]
  ds_read_b64_tr_b16 a[22:23], v11 offset:2048
  v_mfma_f32_16x16x32_bf16 v[52:55], a[48:51], v[176:179], v[52:55]
  ds_read_b64_tr_b16 a[24:25], v12 offset:0
  v_mfma_f32_16x16x32_bf16 v[80:83], a[48:51], v[180:183], v[80:83]
  ds_read_b64_tr_b16 a[26:27], v12 offset:1792
  v_mfma_f32_16x16x32_bf16 v[108:111], a[48:51], v[184:187], v[108:111]
  v_mfma_f32_16x16x32_bf16 v[136:139], a[48:51], v[188:191], v[136:139]
  v_mfma_f32_16x16x32_bf16 v[56:59], a[52:55], v[176:179], v[56:59]
  v_mfma_f32_16x16x32_bf16 v[84:87], a[52:55], v[180:183], v[84:87]
  v_mfma_f32_16x16x32_bf16 v[112:115], a[52:55], v[184:187], v[112:115]
  v_mfma_f32_16x16x32_bf16 v[140:143], a[52:55], v[188:191], v[140:143]
  s_sub_u32 s32, s32, 1
  s_cmp_lg_u32 s32, 0
  s_cbranch_scc1 recurrent_scan__ssm_conv_h3__mixer_s_mlp__prompt_kernel_cm1001
  s_waitcnt lgkmcnt(15)
  v_mfma_f32_16x16x32_bf16 v[32:35], a[0:3], v[160:163], v[32:35]
  ds_read_b64_tr_b16 a[28:29], v10 offset:14336
  s_waitcnt lgkmcnt(15)
  v_mfma_f32_16x16x32_bf16 v[60:63], a[0:3], v[164:167], v[60:63]
  ds_read_b64_tr_b16 a[30:31], v10 offset:16128
  s_waitcnt lgkmcnt(15)
  v_mfma_f32_16x16x32_bf16 v[88:91], a[0:3], v[168:171], v[88:91]
  ds_read_b128 v[176:179], v7 offset:0
  s_waitcnt lgkmcnt(15)
  v_mfma_f32_16x16x32_bf16 v[116:119], a[0:3], v[172:175], v[116:119]
  ds_read_b128 v[180:183], v7 offset:256
  s_waitcnt lgkmcnt(14)
  v_mfma_f32_16x16x32_bf16 v[36:39], a[4:7], v[160:163], v[36:39]
  ds_read_b128 v[184:187], v7 offset:512
  v_mfma_f32_16x16x32_bf16 v[64:67], a[4:7], v[164:167], v[64:67]
  ds_read_b128 v[188:191], v7 offset:768
  v_mfma_f32_16x16x32_bf16 v[92:95], a[4:7], v[168:171], v[92:95]
  ds_read_b64_tr_b16 a[32:33], v11 offset:14336
  v_mfma_f32_16x16x32_bf16 v[120:123], a[4:7], v[172:175], v[120:123]
  ds_read_b64_tr_b16 a[34:35], v11 offset:16128
  s_waitcnt lgkmcnt(15)
  v_mfma_f32_16x16x32_bf16 v[40:43], a[8:11], v[160:163], v[40:43]
  ds_read_b64_tr_b16 a[36:37], v10 offset:14464
  v_mfma_f32_16x16x32_bf16 v[68:71], a[8:11], v[164:167], v[68:71]
  ds_read_b64_tr_b16 a[38:39], v10 offset:16256
  v_mfma_f32_16x16x32_bf16 v[96:99], a[8:11], v[168:171], v[96:99]
  ds_read_b64_tr_b16 a[40:41], v11 offset:14464
  v_mfma_f32_16x16x32_bf16 v[124:127], a[8:11], v[172:175], v[124:127]
  ds_read_b64_tr_b16 a[42:43], v11 offset:16256
  s_waitcnt lgkmcnt(15)
  v_mfma_f32_16x16x32_bf16 v[44:47], a[12:15], v[160:163], v[44:47]
  ds_read_b64_tr_b16 a[44:45], v10 offset:14592
  v_mfma_f32_16x16x32_bf16 v[72:75], a[12:15], v[164:167], v[72:75]
  ds_read_b64_tr_b16 a[46:47], v10 offset:16384
  v_mfma_f32_16x16x32_bf16 v[100:103], a[12:15], v[168:171], v[100:103]
  ds_read_b64_tr_b16 a[48:49], v11 offset:14592
  v_mfma_f32_16x16x32_bf16 v[128:131], a[12:15], v[172:175], v[128:131]
  ds_read_b64_tr_b16 a[50:51], v11 offset:16384
  v_mfma_f32_16x16x32_bf16 v[48:51], a[16:19], v[160:163], v[48:51]
  ds_read_b64_tr_b16 a[52:53], v12 offset:14336
  v_mfma_f32_16x16x32_bf16 v[76:79], a[16:19], v[164:167], v[76:79]
  ds_read_b64_tr_b16 a[54:55], v12 offset:16128
  v_mfma_f32_16x16x32_bf16 v[104:107], a[16:19], v[168:171], v[104:107]
  v_mfma_f32_16x16x32_bf16 v[132:135], a[16:19], v[172:175], v[132:135]
  s_waitcnt lgkmcnt(15)
  v_mfma_f32_16x16x32_bf16 v[52:55], a[20:23], v[160:163], v[52:55]
  v_mfma_f32_16x16x32_bf16 v[80:83], a[20:23], v[164:167], v[80:83]
  v_mfma_f32_16x16x32_bf16 v[108:111], a[20:23], v[168:171], v[108:111]
  v_mfma_f32_16x16x32_bf16 v[136:139], a[20:23], v[172:175], v[136:139]
  v_mfma_f32_16x16x32_bf16 v[56:59], a[24:27], v[160:163], v[56:59]
  v_mfma_f32_16x16x32_bf16 v[84:87], a[24:27], v[164:167], v[84:87]
  v_mfma_f32_16x16x32_bf16 v[112:115], a[24:27], v[168:171], v[112:115]
  v_mfma_f32_16x16x32_bf16 v[140:143], a[24:27], v[172:175], v[140:143]
  v_mfma_f32_16x16x32_bf16 v[32:35], a[28:31], v[176:179], v[32:35]
  s_waitcnt lgkmcnt(14)
  v_mfma_f32_16x16x32_bf16 v[60:63], a[28:31], v[180:183], v[60:63]
  s_waitcnt lgkmcnt(13)
  v_mfma_f32_16x16x32_bf16 v[88:91], a[28:31], v[184:187], v[88:91]
  s_waitcnt lgkmcnt(12)
  v_mfma_f32_16x16x32_bf16 v[116:119], a[28:31], v[188:191], v[116:119]
  s_waitcnt lgkmcnt(10)
  v_mfma_f32_16x16x32_bf16 v[36:39], a[32:35], v[176:179], v[36:39]
  s_waitcnt lgkmcnt(0)
  s_barrier
  v_mfma_f32_16x16x32_bf16 v[64:67], a[32:35], v[180:183], v[64:67]
  v_mfma_f32_16x16x32_bf16 v[92:95], a[32:35], v[184:187], v[92:95]
  v_mfma_f32_16x16x32_bf16 v[120:123], a[32:35], v[188:191], v[120:123]
  v_mfma_f32_16x16x32_bf16 v[40:43], a[36:39], v[176:179], v[40:43]
  v_mfma_f32_16x16x32_bf16 v[68:71], a[36:39], v[180:183], v[68:71]
  v_mfma_f32_16x16x32_bf16 v[96:99], a[36:39], v[184:187], v[96:99]
  v_mfma_f32_16x16x32_bf16 v[124:127], a[36:39], v[188:191], v[124:127]
  v_mfma_f32_16x16x32_bf16 v[44:47], a[40:43], v[176:179], v[44:47]
  v_mfma_f32_16x16x32_bf16 v[72:75], a[40:43], v[180:183], v[72:75]
  v_mfma_f32_16x16x32_bf16 v[100:103], a[40:43], v[184:187], v[100:103]
  v_mfma_f32_16x16x32_bf16 v[128:131], a[40:43], v[188:191], v[128:131]
  v_mfma_f32_16x16x32_bf16 v[48:51], a[44:47], v[176:179], v[48:51]
  v_mfma_f32_16x16x32_bf16 v[76:79], a[44:47], v[180:183], v[76:79]
  v_mfma_f32_16x16x32_bf16 v[104:107], a[44:47], v[184:187], v[104:107]
  v_mfma_f32_16x16x32_bf16 v[132:135], a[44:47], v[188:191], v[132:135]
  v_mfma_f32_16x16x32_bf16 v[52:55], a[48:51], v[176:179], v[52:55]
  v_mfma_f32_16x16x32_bf16 v[80:83], a[48:51], v[180:183], v[80:83]
  v_mfma_f32_16x16x32_bf16 v[108:111], a[48:51], v[184:187], v[108:111]
  v_mfma_f32_16x16x32_bf16 v[136:139], a[48:51], v[188:191], v[136:139]
  v_mfma_f32_16x16x32_bf16 v[56:59], a[52:55], v[176:179], v[56:59]
  v_mfma_f32_16x16x32_bf16 v[84:87], a[52:55], v[180:183], v[84:87]
  v_mfma_f32_16x16x32_bf16 v[112:115], a[52:55], v[184:187], v[112:115]
  v_mfma_f32_16x16x32_bf16 v[140:143], a[52:55], v[188:191], v[140:143]
  v_mov_b32 v168, 1
  v_mov_b32 v169, 0
  v_and_b32 v4, 15, v1
  s_lshl_b32 s36, s40, 9
  s_add_u32 s36, s36, 135168
  v_lshl_add_u32 v4, v4, 3, s36
  v_lshrrev_b32 v5, 4, v1
  s_lshl_b32 s36, s41, 7
  s_add_u32 s36, s36, 136192
  v_lshl_add_u32 v5, v5, 4, s36
  s_mov_b32 s44, 0xbdd2d3e8
  s_mov_b32 s45, 0xbdd2d3e8
  s_mov_b32 s48, 1.0
  s_mov_b32 s49, 1.0
  v_mov_b32 v2, 0xc0135761
  v_mov_b32 v3, 0xc0135761
  ds_read_b64 v[20:21], v4 offset:0
  ds_read_b64 v[22:23], v4 offset:128
  ds_read_b64 v[24:25], v4 offset:256
  ds_read_b64 v[26:27], v4 offset:384
  ds_read_b128 v[160:163], v5 offset:0
  ds_read_b128 v[164:167], v5 offset:64
  ds_read_b128 v[6:9], v5 offset:256
  ds_read_b128 v[10:13], v5 offset:320
  ds_read_b128 v[14:17], v5 offset:512
  s_waitcnt lgkmcnt(0)
  v_pk_mul_f32 v[144:145], v[160:161], v[20:21] op_sel:[0,1] op_sel_hi:[1,1]
  v_pk_mul_f32 v[146:147], v[162:163], v[20:21] op_sel:[0,1] op_sel_hi:[1,1]
  v_pk_fma_f32 v[32:33], v[32:33], v[20:21], v[144:145] op_sel:[0,0,0] op_sel_hi:[1,0,1]
  v_pk_fma_f32 v[34:35], v[34:35], v[20:21], v[146:147] op_sel:[0,0,0] op_sel_hi:[1,0,1]
  v_pk_mul_f32 v[144:145], v[164:165], v[20:21] op_sel:[0,1] op_sel_hi:[1,1]
  v_pk_mul_f32 v[146:147], v[166:167], v[20:21] op_sel:[0,1] op_sel_hi:[1,1]
  v_pk_fma_f32 v[36:37], v[36:37], v[20:21], v[144:145] op_sel:[0,0,0] op_sel_hi:[1,0,1]
  v_pk_fma_f32 v[38:39], v[38:39], v[20:21], v[146:147] op_sel:[0,0,0] op_sel_hi:[1,0,1]
  v_pk_mul_f32 v[144:145], v[32:33], v[32:33]
  v_pk_mul_f32 v[146:147], v[34:35], v[34:35]
  v_pk_mul_f32 v[148:149], v[36:37], v[36:37]
  v_pk_mul_f32 v[150:151], v[38:39], v[38:39]
  v_pk_fma_f32 v[144:145], v[144:145], s[44:45], v[2:3]
  v_pk_fma_f32 v[146:147], v[146:147], s[44:45], v[2:3]
  v_pk_fma_f32 v[148:149], v[148:149], s[44:45], v[2:3]
  v_pk_fma_f32 v[150:151], v[150:151], s[44:45], v[2:3]
  v_pk_mul_f32 v[144:145], v[144:145], v[32:33]
  v_pk_mul_f32 v[146:147], v[146:147], v[34:35]
  v_pk_mul_f32 v[148:149], v[148:149], v[36:37]
  v_pk_mul_f32 v[150:151], v[150:151], v[38:39]
  v_exp_f32 v144, v144
  v_exp_f32 v145, v145
  v_exp_f32 v146, v146
  v_exp_f32 v147, v147
  v_exp_f32 v148, v148
  v_exp_f32 v149, v149
  v_exp_f32 v150, v150
  v_exp_f32 v151, v151
  v_pk_add_f32 v[144:145], v[144:145], s[48:49]
  v_pk_add_f32 v[146:147], v[146:147], s[48:49]
  v_pk_add_f32 v[148:149], v[148:149], s[48:49]
  v_pk_add_f32 v[150:151], v[150:151], s[48:49]
  v_rcp_f32 v144, v144
  v_rcp_f32 v145, v145
  v_rcp_f32 v146, v146
  v_rcp_f32 v147, v147
  v_rcp_f32 v148, v148
  v_rcp_f32 v149, v149
  v_rcp_f32 v150, v150
  v_rcp_f32 v151, v151
  v_pk_mul_f32 v[32:33], v[32:33], v[144:145]
  v_pk_mul_f32 v[34:35], v[34:35], v[146:147]
  v_pk_mul_f32 v[36:37], v[36:37], v[148:149]
  v_pk_mul_f32 v[38:39], v[38:39], v[150:151]
  v_cvt_pk_bf16_f32 v152, v32, v33
  v_cvt_pk_bf16_f32 v153, v34, v35
  v_cvt_pk_bf16_f32 v154, v36, v37
  v_cvt_pk_bf16_f32 v155, v38, v39
  s_nop 0
  v_permlane16_swap_b32 v152, v154
  v_permlane16_swap_b32 v153, v155
  buffer_store_dwordx4 v[152:155], v28, s[4:7], s38 offen offset:0 sc1
  ds_write_b128 v18, v[152:155] offset:0
  ds_read_b128 v[32:35], v5 offset:576
  s_lshl_b32 s36, s41, 6
  v_subrev_u32 v5, s36, v5
  s_nop 0
  ds_read_b128 v[36:39], v5 offset:768
  v_pk_mul_f32 v[144:145], v[160:161], v[22:23] op_sel:[0,1] op_sel_hi:[1,1]
  v_pk_mul_f32 v[146:147], v[162:163], v[22:23] op_sel:[0,1] op_sel_hi:[1,1]
  v_pk_fma_f32 v[60:61], v[60:61], v[22:23], v[144:145] op_sel:[0,0,0] op_sel_hi:[1,0,1]
  v_pk_fma_f32 v[62:63], v[62:63], v[22:23], v[146:147] op_sel:[0,0,0] op_sel_hi:[1,0,1]
  v_pk_mul_f32 v[144:145], v[164:165], v[22:23] op_sel:[0,1] op_sel_hi:[1,1]
  v_pk_mul_f32 v[146:147], v[166:167], v[22:23] op_sel:[0,1] op_sel_hi:[1,1]
  v_pk_fma_f32 v[64:65], v[64:65], v[22:23], v[144:145] op_sel:[0,0,0] op_sel_hi:[1,0,1]
  v_pk_fma_f32 v[66:67], v[66:67], v[22:23], v[146:147] op_sel:[0,0,0] op_sel_hi:[1,0,1]
  v_pk_mul_f32 v[144:145], v[60:61], v[60:61]
  v_pk_mul_f32 v[146:147], v[62:63], v[62:63]
  v_pk_mul_f32 v[148:149], v[64:65], v[64:65]
  v_pk_mul_f32 v[150:151], v[66:67], v[66:67]
  v_pk_fma_f32 v[144:145], v[144:145], s[44:45], v[2:3]
  v_pk_fma_f32 v[146:147], v[146:147], s[44:45], v[2:3]
  v_pk_fma_f32 v[148:149], v[148:149], s[44:45], v[2:3]
  v_pk_fma_f32 v[150:151], v[150:151], s[44:45], v[2:3]
  v_pk_mul_f32 v[144:145], v[144:145], v[60:61]
  v_pk_mul_f32 v[146:147], v[146:147], v[62:63]
  v_pk_mul_f32 v[148:149], v[148:149], v[64:65]
  v_pk_mul_f32 v[150:151], v[150:151], v[66:67]
  v_exp_f32 v144, v144
  v_exp_f32 v145, v145
  v_exp_f32 v146, v146
  v_exp_f32 v147, v147
  v_exp_f32 v148, v148
  v_exp_f32 v149, v149
  v_exp_f32 v150, v150
  v_exp_f32 v151, v151
  v_pk_add_f32 v[144:145], v[144:145], s[48:49]
  v_pk_add_f32 v[146:147], v[146:147], s[48:49]
  v_pk_add_f32 v[148:149], v[148:149], s[48:49]
  v_pk_add_f32 v[150:151], v[150:151], s[48:49]
  v_rcp_f32 v144, v144
  v_rcp_f32 v145, v145
  v_rcp_f32 v146, v146
  v_rcp_f32 v147, v147
  v_rcp_f32 v148, v148
  v_rcp_f32 v149, v149
  v_rcp_f32 v150, v150
  v_rcp_f32 v151, v151
  v_pk_mul_f32 v[60:61], v[60:61], v[144:145]
  v_pk_mul_f32 v[62:63], v[62:63], v[146:147]
  v_pk_mul_f32 v[64:65], v[64:65], v[148:149]
  v_pk_mul_f32 v[66:67], v[66:67], v[150:151]
  v_cvt_pk_bf16_f32 v156, v60, v61
  v_cvt_pk_bf16_f32 v157, v62, v63
  v_cvt_pk_bf16_f32 v158, v64, v65
  v_cvt_pk_bf16_f32 v159, v66, v67
  s_nop 0
  v_permlane16_swap_b32 v156, v158
  v_permlane16_swap_b32_e64 v157, v159
  buffer_store_dwordx4 v[156:159], v28, s[4:7], s38 offen offset:256 sc1
  ds_write_b128 v18, v[156:159] offset:256
  v_pk_mul_f32 v[144:145], v[160:161], v[24:25] op_sel:[0,1] op_sel_hi:[1,1]
  v_pk_mul_f32 v[146:147], v[162:163], v[24:25] op_sel:[0,1] op_sel_hi:[1,1]
  v_pk_fma_f32 v[88:89], v[88:89], v[24:25], v[144:145] op_sel:[0,0,0] op_sel_hi:[1,0,1]
  v_pk_fma_f32 v[90:91], v[90:91], v[24:25], v[146:147] op_sel:[0,0,0] op_sel_hi:[1,0,1]
  v_pk_mul_f32 v[144:145], v[164:165], v[24:25] op_sel:[0,1] op_sel_hi:[1,1]
  v_pk_mul_f32 v[146:147], v[166:167], v[24:25] op_sel:[0,1] op_sel_hi:[1,1]
  v_pk_fma_f32 v[92:93], v[92:93], v[24:25], v[144:145] op_sel:[0,0,0] op_sel_hi:[1,0,1]
  v_pk_fma_f32 v[94:95], v[94:95], v[24:25], v[146:147] op_sel:[0,0,0] op_sel_hi:[1,0,1]
  v_pk_mul_f32 v[144:145], v[88:89], v[88:89]
  v_pk_mul_f32 v[146:147], v[90:91], v[90:91]
  v_pk_mul_f32 v[148:149], v[92:93], v[92:93]
  v_pk_mul_f32 v[150:151], v[94:95], v[94:95]
  v_pk_fma_f32 v[144:145], v[144:145], s[44:45], v[2:3]
  v_pk_fma_f32 v[146:147], v[146:147], s[44:45], v[2:3]
  v_pk_fma_f32 v[148:149], v[148:149], s[44:45], v[2:3]
  v_pk_fma_f32 v[150:151], v[150:151], s[44:45], v[2:3]
  v_pk_mul_f32 v[144:145], v[144:145], v[88:89]
  v_pk_mul_f32 v[146:147], v[146:147], v[90:91]
  v_pk_mul_f32 v[148:149], v[148:149], v[92:93]
  v_pk_mul_f32 v[150:151], v[150:151], v[94:95]
  v_exp_f32 v144, v144
  v_exp_f32 v145, v145
  v_exp_f32 v146, v146
  v_exp_f32 v147, v147
  v_exp_f32 v148, v148
  v_exp_f32 v149, v149
  v_exp_f32 v150, v150
  v_exp_f32 v151, v151
  v_pk_add_f32 v[144:145], v[144:145], s[48:49]
  v_pk_add_f32 v[146:147], v[146:147], s[48:49]
  v_pk_add_f32 v[148:149], v[148:149], s[48:49]
  v_pk_add_f32 v[150:151], v[150:151], s[48:49]
  v_rcp_f32 v144, v144
  v_rcp_f32 v145, v145
  v_rcp_f32 v146, v146
  v_rcp_f32 v147, v147
  v_rcp_f32 v148, v148
  v_rcp_f32 v149, v149
  v_rcp_f32 v150, v150
  v_rcp_f32 v151, v151
  v_pk_mul_f32 v[88:89], v[88:89], v[144:145]
  v_pk_mul_f32 v[90:91], v[90:91], v[146:147]
  v_pk_mul_f32 v[92:93], v[92:93], v[148:149]
  v_pk_mul_f32 v[94:95], v[94:95], v[150:151]
  v_cvt_pk_bf16_f32 v152, v88, v89
  v_cvt_pk_bf16_f32 v153, v90, v91
  v_cvt_pk_bf16_f32 v154, v92, v93
  v_cvt_pk_bf16_f32 v155, v94, v95
  s_nop 0
  v_permlane16_swap_b32 v152, v154
  v_permlane16_swap_b32 v153, v155
  buffer_store_dwordx4 v[152:155], v28, s[4:7], s38 offen offset:512 sc1
  ds_write_b128 v18, v[152:155] offset:512
  s_waitcnt lgkmcnt(0)
  v_pk_mul_f32 v[144:145], v[160:161], v[26:27] op_sel:[0,1] op_sel_hi:[1,1]
  v_pk_mul_f32 v[146:147], v[162:163], v[26:27] op_sel:[0,1] op_sel_hi:[1,1]
  v_pk_fma_f32 v[116:117], v[116:117], v[26:27], v[144:145] op_sel:[0,0,0] op_sel_hi:[1,0,1]
  v_pk_fma_f32 v[118:119], v[118:119], v[26:27], v[146:147] op_sel:[0,0,0] op_sel_hi:[1,0,1]
  v_pk_mul_f32 v[144:145], v[164:165], v[26:27] op_sel:[0,1] op_sel_hi:[1,1]
  v_pk_mul_f32 v[146:147], v[166:167], v[26:27] op_sel:[0,1] op_sel_hi:[1,1]
  v_pk_fma_f32 v[120:121], v[120:121], v[26:27], v[144:145] op_sel:[0,0,0] op_sel_hi:[1,0,1]
  v_pk_fma_f32 v[122:123], v[122:123], v[26:27], v[146:147] op_sel:[0,0,0] op_sel_hi:[1,0,1]
  v_pk_mul_f32 v[144:145], v[116:117], v[116:117]
  v_pk_mul_f32 v[146:147], v[118:119], v[118:119]
  v_pk_mul_f32 v[148:149], v[120:121], v[120:121]
  v_pk_mul_f32 v[150:151], v[122:123], v[122:123]
  v_pk_fma_f32 v[144:145], v[144:145], s[44:45], v[2:3]
  v_pk_fma_f32 v[146:147], v[146:147], s[44:45], v[2:3]
  v_pk_fma_f32 v[148:149], v[148:149], s[44:45], v[2:3]
  v_pk_fma_f32 v[150:151], v[150:151], s[44:45], v[2:3]
  v_pk_mul_f32 v[144:145], v[144:145], v[116:117]
  v_pk_mul_f32 v[146:147], v[146:147], v[118:119]
  v_pk_mul_f32 v[148:149], v[148:149], v[120:121]
  v_pk_mul_f32 v[150:151], v[150:151], v[122:123]
  v_exp_f32 v144, v144
  v_exp_f32 v145, v145
  v_exp_f32 v146, v146
  v_exp_f32 v147, v147
  v_exp_f32 v148, v148
  v_exp_f32 v149, v149
  v_exp_f32 v150, v150
  v_exp_f32 v151, v151
  v_pk_add_f32 v[144:145], v[144:145], s[48:49]
  v_pk_add_f32 v[146:147], v[146:147], s[48:49]
  v_pk_add_f32 v[148:149], v[148:149], s[48:49]
  v_pk_add_f32 v[150:151], v[150:151], s[48:49]
  v_rcp_f32 v144, v144
  v_rcp_f32 v145, v145
  v_rcp_f32 v146, v146
  v_rcp_f32 v147, v147
  v_rcp_f32 v148, v148
  v_rcp_f32 v149, v149
  v_rcp_f32 v150, v150
  v_rcp_f32 v151, v151
  v_pk_mul_f32 v[116:117], v[116:117], v[144:145]
  v_pk_mul_f32 v[118:119], v[118:119], v[146:147]
  v_pk_mul_f32 v[120:121], v[120:121], v[148:149]
  v_pk_mul_f32 v[122:123], v[122:123], v[150:151]
  v_cvt_pk_bf16_f32 v156, v116, v117
  v_cvt_pk_bf16_f32 v157, v118, v119
  v_cvt_pk_bf16_f32 v158, v120, v121
  v_cvt_pk_bf16_f32 v159, v122, v123
  s_nop 0
  v_permlane16_swap_b32 v156, v158
  v_permlane16_swap_b32_e64 v157, v159
  buffer_store_dwordx4 v[156:159], v28, s[4:7], s38 offen offset:768 sc1
  ds_write_b128 v18, v[156:159] offset:768
  v_pk_mul_f32 v[144:145], v[6:7], v[20:21] op_sel:[0,1] op_sel_hi:[1,1]
  v_pk_mul_f32 v[146:147], v[8:9], v[20:21] op_sel:[0,1] op_sel_hi:[1,1]
  v_pk_fma_f32 v[40:41], v[40:41], v[20:21], v[144:145] op_sel:[0,0,0] op_sel_hi:[1,0,1]
  v_pk_fma_f32 v[42:43], v[42:43], v[20:21], v[146:147] op_sel:[0,0,0] op_sel_hi:[1,0,1]
  v_pk_mul_f32 v[144:145], v[10:11], v[20:21] op_sel:[0,1] op_sel_hi:[1,1]
  v_pk_mul_f32 v[146:147], v[12:13], v[20:21] op_sel:[0,1] op_sel_hi:[1,1]
  v_pk_fma_f32 v[44:45], v[44:45], v[20:21], v[144:145] op_sel:[0,0,0] op_sel_hi:[1,0,1]
  v_pk_fma_f32 v[46:47], v[46:47], v[20:21], v[146:147] op_sel:[0,0,0] op_sel_hi:[1,0,1]
  v_pk_mul_f32 v[144:145], v[40:41], v[40:41]
  v_pk_mul_f32 v[146:147], v[42:43], v[42:43]
  v_pk_mul_f32 v[148:149], v[44:45], v[44:45]
  v_pk_mul_f32 v[150:151], v[46:47], v[46:47]
  v_pk_fma_f32 v[144:145], v[144:145], s[44:45], v[2:3]
  v_pk_fma_f32 v[146:147], v[146:147], s[44:45], v[2:3]
  v_pk_fma_f32 v[148:149], v[148:149], s[44:45], v[2:3]
  v_pk_fma_f32 v[150:151], v[150:151], s[44:45], v[2:3]
  v_pk_mul_f32 v[144:145], v[144:145], v[40:41]
  v_pk_mul_f32 v[146:147], v[146:147], v[42:43]
  v_pk_mul_f32 v[148:149], v[148:149], v[44:45]
  v_pk_mul_f32 v[150:151], v[150:151], v[46:47]
  v_exp_f32 v144, v144
  v_exp_f32 v145, v145
  v_exp_f32 v146, v146
  v_exp_f32 v147, v147
  v_exp_f32 v148, v148
  v_exp_f32 v149, v149
  v_exp_f32 v150, v150
  v_exp_f32 v151, v151
  v_pk_add_f32 v[144:145], v[144:145], s[48:49]
  v_pk_add_f32 v[146:147], v[146:147], s[48:49]
  v_pk_add_f32 v[148:149], v[148:149], s[48:49]
  v_pk_add_f32 v[150:151], v[150:151], s[48:49]
  v_rcp_f32 v144, v144
  v_rcp_f32 v145, v145
  v_rcp_f32 v146, v146
  v_rcp_f32 v147, v147
  v_rcp_f32 v148, v148
  v_rcp_f32 v149, v149
  v_rcp_f32 v150, v150
  v_rcp_f32 v151, v151
  v_pk_mul_f32 v[40:41], v[40:41], v[144:145]
  v_pk_mul_f32 v[42:43], v[42:43], v[146:147]
  v_pk_mul_f32 v[44:45], v[44:45], v[148:149]
  v_pk_mul_f32 v[46:47], v[46:47], v[150:151]
  v_cvt_pk_bf16_f32 v152, v40, v41
  v_cvt_pk_bf16_f32 v153, v42, v43
  v_cvt_pk_bf16_f32 v154, v44, v45
  v_cvt_pk_bf16_f32 v155, v46, v47
  s_nop 0
  v_permlane16_swap_b32 v152, v154
  v_permlane16_swap_b32_e64 v153, v155
  buffer_store_dwordx4 v[152:155], v29, s[4:7], s38 offen offset:0 sc1
  ds_write_b128 v18, v[152:155] offset:32768
  v_pk_mul_f32 v[144:145], v[6:7], v[22:23] op_sel:[0,1] op_sel_hi:[1,1]
  v_pk_mul_f32 v[146:147], v[8:9], v[22:23] op_sel:[0,1] op_sel_hi:[1,1]
  v_pk_fma_f32 v[68:69], v[68:69], v[22:23], v[144:145] op_sel:[0,0,0] op_sel_hi:[1,0,1]
  v_pk_fma_f32 v[70:71], v[70:71], v[22:23], v[146:147] op_sel:[0,0,0] op_sel_hi:[1,0,1]
  v_pk_mul_f32 v[144:145], v[10:11], v[22:23] op_sel:[0,1] op_sel_hi:[1,1]
  v_pk_mul_f32 v[146:147], v[12:13], v[22:23] op_sel:[0,1] op_sel_hi:[1,1]
  v_pk_fma_f32 v[72:73], v[72:73], v[22:23], v[144:145] op_sel:[0,0,0] op_sel_hi:[1,0,1]
  v_pk_fma_f32 v[74:75], v[74:75], v[22:23], v[146:147] op_sel:[0,0,0] op_sel_hi:[1,0,1]
  v_pk_mul_f32 v[144:145], v[68:69], v[68:69]
  v_pk_mul_f32 v[146:147], v[70:71], v[70:71]
  v_pk_mul_f32 v[148:149], v[72:73], v[72:73]
  v_pk_mul_f32 v[150:151], v[74:75], v[74:75]
  v_pk_fma_f32 v[144:145], v[144:145], s[44:45], v[2:3]
  v_pk_fma_f32 v[146:147], v[146:147], s[44:45], v[2:3]
  v_pk_fma_f32 v[148:149], v[148:149], s[44:45], v[2:3]
  v_pk_fma_f32 v[150:151], v[150:151], s[44:45], v[2:3]
  v_pk_mul_f32 v[144:145], v[144:145], v[68:69]
  v_pk_mul_f32 v[146:147], v[146:147], v[70:71]
  v_pk_mul_f32 v[148:149], v[148:149], v[72:73]
  v_pk_mul_f32 v[150:151], v[150:151], v[74:75]
  v_exp_f32 v144, v144
  v_exp_f32 v145, v145
  v_exp_f32 v146, v146
  v_exp_f32 v147, v147
  v_exp_f32 v148, v148
  v_exp_f32 v149, v149
  v_exp_f32 v150, v150
  v_exp_f32 v151, v151
  v_pk_add_f32 v[144:145], v[144:145], s[48:49]
  v_pk_add_f32 v[146:147], v[146:147], s[48:49]
  v_pk_add_f32 v[148:149], v[148:149], s[48:49]
  v_pk_add_f32 v[150:151], v[150:151], s[48:49]
  v_rcp_f32 v144, v144
  v_rcp_f32 v145, v145
  v_rcp_f32 v146, v146
  v_rcp_f32 v147, v147
  v_rcp_f32 v148, v148
  v_rcp_f32 v149, v149
  v_rcp_f32 v150, v150
  v_rcp_f32 v151, v151
  v_pk_mul_f32 v[68:69], v[68:69], v[144:145]
  v_pk_mul_f32 v[70:71], v[70:71], v[146:147]
  v_pk_mul_f32 v[72:73], v[72:73], v[148:149]
  v_pk_mul_f32 v[74:75], v[74:75], v[150:151]
  v_cvt_pk_bf16_f32 v156, v68, v69
  v_cvt_pk_bf16_f32 v157, v70, v71
  v_cvt_pk_bf16_f32 v158, v72, v73
  v_cvt_pk_bf16_f32 v159, v74, v75
  s_nop 0
  v_permlane16_swap_b32 v156, v158
  v_permlane16_swap_b32_e64 v157, v159
  buffer_store_dwordx4 v[156:159], v29, s[4:7], s38 offen offset:256 sc1
  ds_write_b128 v18, v[156:159] offset:33024
  v_pk_mul_f32 v[144:145], v[6:7], v[24:25] op_sel:[0,1] op_sel_hi:[1,1]
  v_pk_mul_f32 v[146:147], v[8:9], v[24:25] op_sel:[0,1] op_sel_hi:[1,1]
  v_pk_fma_f32 v[96:97], v[96:97], v[24:25], v[144:145] op_sel:[0,0,0] op_sel_hi:[1,0,1]
  v_pk_fma_f32 v[98:99], v[98:99], v[24:25], v[146:147] op_sel:[0,0,0] op_sel_hi:[1,0,1]
  v_pk_mul_f32 v[144:145], v[10:11], v[24:25] op_sel:[0,1] op_sel_hi:[1,1]
  v_pk_mul_f32 v[146:147], v[12:13], v[24:25] op_sel:[0,1] op_sel_hi:[1,1]
  v_pk_fma_f32 v[100:101], v[100:101], v[24:25], v[144:145] op_sel:[0,0,0] op_sel_hi:[1,0,1]
  v_pk_fma_f32 v[102:103], v[102:103], v[24:25], v[146:147] op_sel:[0,0,0] op_sel_hi:[1,0,1]
  v_pk_mul_f32 v[144:145], v[96:97], v[96:97]
  v_pk_mul_f32 v[146:147], v[98:99], v[98:99]
  v_pk_mul_f32 v[148:149], v[100:101], v[100:101]
  v_pk_mul_f32 v[150:151], v[102:103], v[102:103]
  v_pk_fma_f32 v[144:145], v[144:145], s[44:45], v[2:3]
  v_pk_fma_f32 v[146:147], v[146:147], s[44:45], v[2:3]
  v_pk_fma_f32 v[148:149], v[148:149], s[44:45], v[2:3]
  v_pk_fma_f32 v[150:151], v[150:151], s[44:45], v[2:3]
  v_pk_mul_f32 v[144:145], v[144:145], v[96:97]
  v_pk_mul_f32 v[146:147], v[146:147], v[98:99]
  v_pk_mul_f32 v[148:149], v[148:149], v[100:101]
  v_pk_mul_f32 v[150:151], v[150:151], v[102:103]
  v_exp_f32 v144, v144
  v_exp_f32 v145, v145
  v_exp_f32 v146, v146
  v_exp_f32 v147, v147
  v_exp_f32 v148, v148
  v_exp_f32 v149, v149
  v_exp_f32 v150, v150
  v_exp_f32 v151, v151
  v_pk_add_f32 v[144:145], v[144:145], s[48:49]
  v_pk_add_f32 v[146:147], v[146:147], s[48:49]
  v_pk_add_f32 v[148:149], v[148:149], s[48:49]
  v_pk_add_f32 v[150:151], v[150:151], s[48:49]
  v_rcp_f32 v144, v144
  v_rcp_f32 v145, v145
  v_rcp_f32 v146, v146
  v_rcp_f32 v147, v147
  v_rcp_f32 v148, v148
  v_rcp_f32 v149, v149
  v_rcp_f32 v150, v150
  v_rcp_f32 v151, v151
  v_pk_mul_f32 v[96:97], v[96:97], v[144:145]
  v_pk_mul_f32 v[98:99], v[98:99], v[146:147]
  v_pk_mul_f32 v[100:101], v[100:101], v[148:149]
  v_pk_mul_f32 v[102:103], v[102:103], v[150:151]
  v_cvt_pk_bf16_f32 v152, v96, v97
  v_cvt_pk_bf16_f32 v153, v98, v99
  v_cvt_pk_bf16_f32 v154, v100, v101
  v_cvt_pk_bf16_f32 v155, v102, v103
  s_nop 0
  v_permlane16_swap_b32 v152, v154
  v_permlane16_swap_b32_e64 v153, v155
  buffer_store_dwordx4 v[152:155], v29, s[4:7], s38 offen offset:512 sc1
  ds_write_b128 v18, v[152:155] offset:33280
  v_pk_mul_f32 v[144:145], v[6:7], v[26:27] op_sel:[0,1] op_sel_hi:[1,1]
  v_pk_mul_f32 v[146:147], v[8:9], v[26:27] op_sel:[0,1] op_sel_hi:[1,1]
  v_pk_fma_f32 v[124:125], v[124:125], v[26:27], v[144:145] op_sel:[0,0,0] op_sel_hi:[1,0,1]
  v_pk_fma_f32 v[126:127], v[126:127], v[26:27], v[146:147] op_sel:[0,0,0] op_sel_hi:[1,0,1]
  v_pk_mul_f32 v[144:145], v[10:11], v[26:27] op_sel:[0,1] op_sel_hi:[1,1]
  v_pk_mul_f32 v[146:147], v[12:13], v[26:27] op_sel:[0,1] op_sel_hi:[1,1]
  v_pk_fma_f32 v[128:129], v[128:129], v[26:27], v[144:145] op_sel:[0,0,0] op_sel_hi:[1,0,1]
  v_pk_fma_f32 v[130:131], v[130:131], v[26:27], v[146:147] op_sel:[0,0,0] op_sel_hi:[1,0,1]
  v_pk_mul_f32 v[144:145], v[124:125], v[124:125]
  v_pk_mul_f32 v[146:147], v[126:127], v[126:127]
  v_pk_mul_f32 v[148:149], v[128:129], v[128:129]
  v_pk_mul_f32 v[150:151], v[130:131], v[130:131]
  v_pk_fma_f32 v[144:145], v[144:145], s[44:45], v[2:3]
  v_pk_fma_f32 v[146:147], v[146:147], s[44:45], v[2:3]
  v_pk_fma_f32 v[148:149], v[148:149], s[44:45], v[2:3]
  v_pk_fma_f32 v[150:151], v[150:151], s[44:45], v[2:3]
  v_pk_mul_f32 v[144:145], v[144:145], v[124:125]
  v_pk_mul_f32 v[146:147], v[146:147], v[126:127]
  v_pk_mul_f32 v[148:149], v[148:149], v[128:129]
  v_pk_mul_f32 v[150:151], v[150:151], v[130:131]
  v_exp_f32 v144, v144
  v_exp_f32 v145, v145
  v_exp_f32 v146, v146
  v_exp_f32 v147, v147
  v_exp_f32 v148, v148
  v_exp_f32 v149, v149
  v_exp_f32 v150, v150
  v_exp_f32 v151, v151
  v_pk_add_f32 v[144:145], v[144:145], s[48:49]
  v_pk_add_f32 v[146:147], v[146:147], s[48:49]
  v_pk_add_f32 v[148:149], v[148:149], s[48:49]
  v_pk_add_f32 v[150:151], v[150:151], s[48:49]
  v_rcp_f32 v144, v144
  v_rcp_f32 v145, v145
  v_rcp_f32 v146, v146
  v_rcp_f32 v147, v147
  v_rcp_f32 v148, v148
  v_rcp_f32 v149, v149
  v_rcp_f32 v150, v150
  v_rcp_f32 v151, v151
  v_pk_mul_f32 v[124:125], v[124:125], v[144:145]
  v_pk_mul_f32 v[126:127], v[126:127], v[146:147]
  v_pk_mul_f32 v[128:129], v[128:129], v[148:149]
  v_pk_mul_f32 v[130:131], v[130:131], v[150:151]
  v_cvt_pk_bf16_f32 v156, v124, v125
  v_cvt_pk_bf16_f32 v157, v126, v127
  v_cvt_pk_bf16_f32 v158, v128, v129
  v_cvt_pk_bf16_f32 v159, v130, v131
  s_nop 0
  v_permlane16_swap_b32 v156, v158
  v_permlane16_swap_b32_e64 v157, v159
  buffer_store_dwordx4 v[156:159], v29, s[4:7], s38 offen offset:768 sc1
  ds_write_b128 v18, v[156:159] offset:33536
  v_pk_mul_f32 v[144:145], v[14:15], v[20:21] op_sel:[0,1] op_sel_hi:[1,1]
  v_pk_mul_f32 v[146:147], v[16:17], v[20:21] op_sel:[0,1] op_sel_hi:[1,1]
  v_pk_fma_f32 v[48:49], v[48:49], v[20:21], v[144:145] op_sel:[0,0,0] op_sel_hi:[1,0,1]
  v_pk_fma_f32 v[50:51], v[50:51], v[20:21], v[146:147] op_sel:[0,0,0] op_sel_hi:[1,0,1]
  v_pk_mul_f32 v[144:145], v[32:33], v[20:21] op_sel:[0,1] op_sel_hi:[1,1]
  v_pk_mul_f32 v[146:147], v[34:35], v[20:21] op_sel:[0,1] op_sel_hi:[1,1]
  v_pk_fma_f32 v[52:53], v[52:53], v[20:21], v[144:145] op_sel:[0,0,0] op_sel_hi:[1,0,1]
  v_pk_fma_f32 v[54:55], v[54:55], v[20:21], v[146:147] op_sel:[0,0,0] op_sel_hi:[1,0,1]
  v_pk_mul_f32 v[144:145], v[48:49], v[48:49]
  v_pk_mul_f32 v[146:147], v[50:51], v[50:51]
  v_pk_mul_f32 v[148:149], v[52:53], v[52:53]
  v_pk_mul_f32 v[150:151], v[54:55], v[54:55]
  v_pk_fma_f32 v[144:145], v[144:145], s[44:45], v[2:3]
  v_pk_fma_f32 v[146:147], v[146:147], s[44:45], v[2:3]
  v_pk_fma_f32 v[148:149], v[148:149], s[44:45], v[2:3]
  v_pk_fma_f32 v[150:151], v[150:151], s[44:45], v[2:3]
  v_pk_mul_f32 v[144:145], v[144:145], v[48:49]
  v_pk_mul_f32 v[146:147], v[146:147], v[50:51]
  v_pk_mul_f32 v[148:149], v[148:149], v[52:53]
  v_pk_mul_f32 v[150:151], v[150:151], v[54:55]
  v_exp_f32 v144, v144
  v_exp_f32 v145, v145
  v_exp_f32 v146, v146
  v_exp_f32 v147, v147
  v_exp_f32 v148, v148
  v_exp_f32 v149, v149
  v_exp_f32 v150, v150
  v_exp_f32 v151, v151
  v_pk_add_f32 v[144:145], v[144:145], s[48:49]
  v_pk_add_f32 v[146:147], v[146:147], s[48:49]
  v_pk_add_f32 v[148:149], v[148:149], s[48:49]
  v_pk_add_f32 v[150:151], v[150:151], s[48:49]
  v_rcp_f32 v144, v144
  v_rcp_f32 v145, v145
  v_rcp_f32 v146, v146
  v_rcp_f32 v147, v147
  v_rcp_f32 v148, v148
  v_rcp_f32 v149, v149
  v_rcp_f32 v150, v150
  v_rcp_f32 v151, v151
  v_pk_mul_f32 v[48:49], v[48:49], v[144:145]
  v_pk_mul_f32 v[50:51], v[50:51], v[146:147]
  v_pk_mul_f32 v[52:53], v[52:53], v[148:149]
  v_pk_mul_f32 v[54:55], v[54:55], v[150:151]
  v_cvt_pk_bf16_f32 v152, v48, v49
  v_cvt_pk_bf16_f32 v153, v50, v51
  v_cvt_pk_bf16_f32 v154, v52, v53
  v_cvt_pk_bf16_f32 v155, v54, v55
  s_nop 0
  v_permlane16_swap_b32 v152, v154
  v_permlane16_swap_b32_e64 v153, v155
  buffer_store_dwordx4 v[152:155], v30, s[4:7], s38 offen offset:0 sc1
  ds_write_b128 v19, v[152:155] offset:0
  v_pk_mul_f32 v[144:145], v[14:15], v[22:23] op_sel:[0,1] op_sel_hi:[1,1]
  v_pk_mul_f32 v[146:147], v[16:17], v[22:23] op_sel:[0,1] op_sel_hi:[1,1]
  v_pk_fma_f32 v[76:77], v[76:77], v[22:23], v[144:145] op_sel:[0,0,0] op_sel_hi:[1,0,1]
  v_pk_fma_f32 v[78:79], v[78:79], v[22:23], v[146:147] op_sel:[0,0,0] op_sel_hi:[1,0,1]
  v_pk_mul_f32 v[144:145], v[32:33], v[22:23] op_sel:[0,1] op_sel_hi:[1,1]
  v_pk_mul_f32 v[146:147], v[34:35], v[22:23] op_sel:[0,1] op_sel_hi:[1,1]
  v_pk_fma_f32 v[80:81], v[80:81], v[22:23], v[144:145] op_sel:[0,0,0] op_sel_hi:[1,0,1]
  v_pk_fma_f32 v[82:83], v[82:83], v[22:23], v[146:147] op_sel:[0,0,0] op_sel_hi:[1,0,1]
  v_pk_mul_f32 v[144:145], v[76:77], v[76:77]
  v_pk_mul_f32 v[146:147], v[78:79], v[78:79]
  v_pk_mul_f32 v[148:149], v[80:81], v[80:81]
  v_pk_mul_f32 v[150:151], v[82:83], v[82:83]
  v_pk_fma_f32 v[144:145], v[144:145], s[44:45], v[2:3]
  v_pk_fma_f32 v[146:147], v[146:147], s[44:45], v[2:3]
  v_pk_fma_f32 v[148:149], v[148:149], s[44:45], v[2:3]
  v_pk_fma_f32 v[150:151], v[150:151], s[44:45], v[2:3]
  v_pk_mul_f32 v[144:145], v[144:145], v[76:77]
  v_pk_mul_f32 v[146:147], v[146:147], v[78:79]
  v_pk_mul_f32 v[148:149], v[148:149], v[80:81]
  v_pk_mul_f32 v[150:151], v[150:151], v[82:83]
  v_exp_f32 v144, v144
  v_exp_f32 v145, v145
  v_exp_f32 v146, v146
  v_exp_f32 v147, v147
  v_exp_f32 v148, v148
  v_exp_f32 v149, v149
  v_exp_f32 v150, v150
  v_exp_f32 v151, v151
  v_pk_add_f32 v[144:145], v[144:145], s[48:49]
  v_pk_add_f32 v[146:147], v[146:147], s[48:49]
  v_pk_add_f32 v[148:149], v[148:149], s[48:49]
  v_pk_add_f32 v[150:151], v[150:151], s[48:49]
  v_rcp_f32 v144, v144
  v_rcp_f32 v145, v145
  v_rcp_f32 v146, v146
  v_rcp_f32 v147, v147
  v_rcp_f32 v148, v148
  v_rcp_f32 v149, v149
  v_rcp_f32 v150, v150
  v_rcp_f32 v151, v151
  v_pk_mul_f32 v[76:77], v[76:77], v[144:145]
  v_pk_mul_f32 v[78:79], v[78:79], v[146:147]
  v_pk_mul_f32 v[80:81], v[80:81], v[148:149]
  v_pk_mul_f32 v[82:83], v[82:83], v[150:151]
  v_cvt_pk_bf16_f32 v156, v76, v77
  v_cvt_pk_bf16_f32 v157, v78, v79
  v_cvt_pk_bf16_f32 v158, v80, v81
  v_cvt_pk_bf16_f32 v159, v82, v83
  s_nop 0
  v_permlane16_swap_b32 v156, v158
  v_permlane16_swap_b32 v157, v159
  buffer_store_dwordx4 v[156:159], v30, s[4:7], s38 offen offset:256 sc1
  ds_write_b128 v19, v[156:159] offset:256
  s_waitcnt vmcnt(2)
  s_barrier
  s_nop 0
  v_pk_mul_f32 v[144:145], v[14:15], v[24:25] op_sel:[0,1] op_sel_hi:[1,1]
  v_pk_mul_f32 v[146:147], v[16:17], v[24:25] op_sel:[0,1] op_sel_hi:[1,1]
  v_pk_fma_f32 v[104:105], v[104:105], v[24:25], v[144:145] op_sel:[0,0,0] op_sel_hi:[1,0,1]
  v_pk_fma_f32 v[106:107], v[106:107], v[24:25], v[146:147] op_sel:[0,0,0] op_sel_hi:[1,0,1]
  v_pk_mul_f32 v[144:145], v[32:33], v[24:25] op_sel:[0,1] op_sel_hi:[1,1]
  v_pk_mul_f32 v[146:147], v[34:35], v[24:25] op_sel:[0,1] op_sel_hi:[1,1]
  v_pk_fma_f32 v[108:109], v[108:109], v[24:25], v[144:145] op_sel:[0,0,0] op_sel_hi:[1,0,1]
  v_pk_fma_f32 v[110:111], v[110:111], v[24:25], v[146:147] op_sel:[0,0,0] op_sel_hi:[1,0,1]
  v_pk_mul_f32 v[144:145], v[104:105], v[104:105]
  v_pk_mul_f32 v[146:147], v[106:107], v[106:107]
  v_pk_mul_f32 v[148:149], v[108:109], v[108:109]
  v_pk_mul_f32 v[150:151], v[110:111], v[110:111]
  v_pk_fma_f32 v[144:145], v[144:145], s[44:45], v[2:3]
  v_pk_fma_f32 v[146:147], v[146:147], s[44:45], v[2:3]
  v_pk_fma_f32 v[148:149], v[148:149], s[44:45], v[2:3]
  v_pk_fma_f32 v[150:151], v[150:151], s[44:45], v[2:3]
  v_pk_mul_f32 v[144:145], v[144:145], v[104:105]
  v_pk_mul_f32 v[146:147], v[146:147], v[106:107]
  v_pk_mul_f32 v[148:149], v[148:149], v[108:109]
  v_pk_mul_f32 v[150:151], v[150:151], v[110:111]
  v_exp_f32 v144, v144
  v_exp_f32 v145, v145
  v_exp_f32 v146, v146
  v_exp_f32 v147, v147
  v_exp_f32 v148, v148
  v_exp_f32 v149, v149
  v_exp_f32 v150, v150
  v_exp_f32 v151, v151
  v_pk_add_f32 v[144:145], v[144:145], s[48:49]
  v_pk_add_f32 v[146:147], v[146:147], s[48:49]
  v_pk_add_f32 v[148:149], v[148:149], s[48:49]
  v_pk_add_f32 v[150:151], v[150:151], s[48:49]
  v_rcp_f32 v144, v144
  v_rcp_f32 v145, v145
  v_rcp_f32 v146, v146
  v_rcp_f32 v147, v147
  v_rcp_f32 v148, v148
  v_rcp_f32 v149, v149
  v_rcp_f32 v150, v150
  v_rcp_f32 v151, v151
  v_pk_mul_f32 v[104:105], v[104:105], v[144:145]
  v_pk_mul_f32 v[106:107], v[106:107], v[146:147]
  v_pk_mul_f32 v[108:109], v[108:109], v[148:149]
  v_pk_mul_f32 v[110:111], v[110:111], v[150:151]
  v_cvt_pk_bf16_f32 v152, v104, v105
  v_cvt_pk_bf16_f32 v153, v106, v107
  v_cvt_pk_bf16_f32 v154, v108, v109
  v_cvt_pk_bf16_f32 v155, v110, v111
  s_nop 0
  v_permlane16_swap_b32 v152, v154
  v_permlane16_swap_b32_e64 v153, v155
  buffer_store_dwordx4 v[152:155], v30, s[4:7], s38 offen offset:512 sc1
  ds_write_b128 v19, v[152:155] offset:512
  v_pk_mul_f32 v[144:145], v[14:15], v[26:27] op_sel:[0,1] op_sel_hi:[1,1]
  v_pk_mul_f32 v[146:147], v[16:17], v[26:27] op_sel:[0,1] op_sel_hi:[1,1]
  v_pk_fma_f32 v[132:133], v[132:133], v[26:27], v[144:145] op_sel:[0,0,0] op_sel_hi:[1,0,1]
  v_pk_fma_f32 v[134:135], v[134:135], v[26:27], v[146:147] op_sel:[0,0,0] op_sel_hi:[1,0,1]
  v_pk_mul_f32 v[144:145], v[32:33], v[26:27] op_sel:[0,1] op_sel_hi:[1,1]
  v_pk_mul_f32 v[146:147], v[34:35], v[26:27] op_sel:[0,1] op_sel_hi:[1,1]
  v_pk_fma_f32 v[136:137], v[136:137], v[26:27], v[144:145] op_sel:[0,0,0] op_sel_hi:[1,0,1]
  v_pk_fma_f32 v[138:139], v[138:139], v[26:27], v[146:147] op_sel:[0,0,0] op_sel_hi:[1,0,1]
  v_pk_mul_f32 v[144:145], v[132:133], v[132:133]
  v_pk_mul_f32 v[146:147], v[134:135], v[134:135]
  v_pk_mul_f32 v[148:149], v[136:137], v[136:137]
  v_pk_mul_f32 v[150:151], v[138:139], v[138:139]
  v_pk_fma_f32 v[144:145], v[144:145], s[44:45], v[2:3]
  v_pk_fma_f32 v[146:147], v[146:147], s[44:45], v[2:3]
  v_pk_fma_f32 v[148:149], v[148:149], s[44:45], v[2:3]
  v_pk_fma_f32 v[150:151], v[150:151], s[44:45], v[2:3]
  v_pk_mul_f32 v[144:145], v[144:145], v[132:133]
  v_pk_mul_f32 v[146:147], v[146:147], v[134:135]
  v_pk_mul_f32 v[148:149], v[148:149], v[136:137]
  v_pk_mul_f32 v[150:151], v[150:151], v[138:139]
  v_exp_f32 v144, v144
  v_exp_f32 v145, v145
  v_exp_f32 v146, v146
  v_exp_f32 v147, v147
  v_exp_f32 v148, v148
  v_exp_f32 v149, v149
  v_exp_f32 v150, v150
  v_exp_f32 v151, v151
  v_pk_add_f32 v[144:145], v[144:145], s[48:49]
  v_pk_add_f32 v[146:147], v[146:147], s[48:49]
  v_pk_add_f32 v[148:149], v[148:149], s[48:49]
  v_pk_add_f32 v[150:151], v[150:151], s[48:49]
  v_rcp_f32 v144, v144
  v_rcp_f32 v145, v145
  v_rcp_f32 v146, v146
  v_rcp_f32 v147, v147
  v_rcp_f32 v148, v148
  v_rcp_f32 v149, v149
  v_rcp_f32 v150, v150
  v_rcp_f32 v151, v151
  v_pk_mul_f32 v[132:133], v[132:133], v[144:145]
  v_pk_mul_f32 v[134:135], v[134:135], v[146:147]
  v_pk_mul_f32 v[136:137], v[136:137], v[148:149]
  v_pk_mul_f32 v[138:139], v[138:139], v[150:151]
  v_cvt_pk_bf16_f32 v156, v132, v133
  v_cvt_pk_bf16_f32 v157, v134, v135
  v_cvt_pk_bf16_f32 v158, v136, v137
  v_cvt_pk_bf16_f32 v159, v138, v139
  s_nop 0
  v_permlane16_swap_b32 v156, v158
  v_permlane16_swap_b32 v157, v159
  buffer_store_dwordx4 v[156:159], v30, s[4:7], s38 offen offset:768 sc1
  ds_write_b128 v19, v[156:159] offset:768
  s_barrier
  v_pk_mul_f32 v[144:145], v[36:37], v[20:21] op_sel:[0,1] op_sel_hi:[1,1]
  v_pk_mul_f32 v[146:147], v[38:39], v[20:21] op_sel:[0,1] op_sel_hi:[1,1]
  v_pk_fma_f32 v[56:57], v[56:57], v[20:21], v[144:145] op_sel:[0,0,0] op_sel_hi:[1,0,1]
  v_pk_fma_f32 v[58:59], v[58:59], v[20:21], v[146:147] op_sel:[0,0,0] op_sel_hi:[1,0,1]
  v_pk_mul_f32 v[144:145], v[36:37], v[22:23] op_sel:[0,1] op_sel_hi:[1,1]
  v_pk_mul_f32 v[146:147], v[38:39], v[22:23] op_sel:[0,1] op_sel_hi:[1,1]
  v_pk_fma_f32 v[84:85], v[84:85], v[22:23], v[144:145] op_sel:[0,0,0] op_sel_hi:[1,0,1]
  v_pk_fma_f32 v[86:87], v[86:87], v[22:23], v[146:147] op_sel:[0,0,0] op_sel_hi:[1,0,1]
  v_pk_mul_f32 v[144:145], v[56:57], v[56:57]
  v_pk_mul_f32 v[146:147], v[58:59], v[58:59]
  v_pk_mul_f32 v[148:149], v[84:85], v[84:85]
  v_pk_mul_f32 v[150:151], v[86:87], v[86:87]
  v_pk_fma_f32 v[144:145], v[144:145], s[44:45], v[2:3]
  v_pk_fma_f32 v[146:147], v[146:147], s[44:45], v[2:3]
  v_pk_fma_f32 v[148:149], v[148:149], s[44:45], v[2:3]
  v_pk_fma_f32 v[150:151], v[150:151], s[44:45], v[2:3]
  v_pk_mul_f32 v[144:145], v[144:145], v[56:57]
  v_pk_mul_f32 v[146:147], v[146:147], v[58:59]
  v_pk_mul_f32 v[148:149], v[148:149], v[84:85]
  v_pk_mul_f32 v[150:151], v[150:151], v[86:87]
  v_exp_f32 v144, v144
  v_exp_f32 v145, v145
  v_exp_f32 v146, v146
  v_exp_f32 v147, v147
  v_exp_f32 v148, v148
  v_exp_f32 v149, v149
  v_exp_f32 v150, v150
  v_exp_f32 v151, v151
  v_pk_add_f32 v[144:145], v[144:145], s[48:49]
  v_pk_add_f32 v[146:147], v[146:147], s[48:49]
  v_pk_add_f32 v[148:149], v[148:149], s[48:49]
  v_pk_add_f32 v[150:151], v[150:151], s[48:49]
  v_rcp_f32 v144, v144
  v_rcp_f32 v145, v145
  v_rcp_f32 v146, v146
  v_rcp_f32 v147, v147
  v_rcp_f32 v148, v148
  v_rcp_f32 v149, v149
  v_rcp_f32 v150, v150
  v_rcp_f32 v151, v151
  v_pk_mul_f32 v[56:57], v[56:57], v[144:145]
  v_pk_mul_f32 v[58:59], v[58:59], v[146:147]
  v_pk_mul_f32 v[84:85], v[84:85], v[148:149]
  v_pk_mul_f32 v[86:87], v[86:87], v[150:151]
  v_cvt_pk_bf16_f32 v152, v56, v57
  v_cvt_pk_bf16_f32 v153, v58, v59
  v_cvt_pk_bf16_f32 v154, v84, v85
  v_cvt_pk_bf16_f32 v155, v86, v87
  s_nop 0
  v_permlane16_swap_b32 v152, v154
  v_permlane16_swap_b32_e64 v153, v155
  buffer_store_dwordx4 v[152:155], v31, s[4:7], s38 offen offset:0 sc1
  v_pk_mul_f32 v[144:145], v[36:37], v[24:25] op_sel:[0,1] op_sel_hi:[1,1]
  v_pk_mul_f32 v[146:147], v[38:39], v[24:25] op_sel:[0,1] op_sel_hi:[1,1]
  v_pk_fma_f32 v[112:113], v[112:113], v[24:25], v[144:145] op_sel:[0,0,0] op_sel_hi:[1,0,1]
  v_pk_fma_f32 v[114:115], v[114:115], v[24:25], v[146:147] op_sel:[0,0,0] op_sel_hi:[1,0,1]
  v_pk_mul_f32 v[144:145], v[36:37], v[26:27] op_sel:[0,1] op_sel_hi:[1,1]
  v_pk_mul_f32 v[146:147], v[38:39], v[26:27] op_sel:[0,1] op_sel_hi:[1,1]
  v_pk_fma_f32 v[140:141], v[140:141], v[26:27], v[144:145] op_sel:[0,0,0] op_sel_hi:[1,0,1]
  v_pk_fma_f32 v[142:143], v[142:143], v[26:27], v[146:147] op_sel:[0,0,0] op_sel_hi:[1,0,1]
  v_pk_mul_f32 v[144:145], v[112:113], v[112:113]
  v_pk_mul_f32 v[146:147], v[114:115], v[114:115]
  v_pk_mul_f32 v[148:149], v[140:141], v[140:141]
  v_pk_mul_f32 v[150:151], v[142:143], v[142:143]
  v_pk_fma_f32 v[144:145], v[144:145], s[44:45], v[2:3]
  v_pk_fma_f32 v[146:147], v[146:147], s[44:45], v[2:3]
  v_pk_fma_f32 v[148:149], v[148:149], s[44:45], v[2:3]
  v_pk_fma_f32 v[150:151], v[150:151], s[44:45], v[2:3]
  v_pk_mul_f32 v[144:145], v[144:145], v[112:113]
  v_pk_mul_f32 v[146:147], v[146:147], v[114:115]
  v_pk_mul_f32 v[148:149], v[148:149], v[140:141]
  v_pk_mul_f32 v[150:151], v[150:151], v[142:143]
  v_exp_f32 v144, v144
  v_exp_f32 v145, v145
  v_exp_f32 v146, v146
  v_exp_f32 v147, v147
  v_exp_f32 v148, v148
  v_exp_f32 v149, v149
  v_exp_f32 v150, v150
  v_exp_f32 v151, v151
  v_pk_add_f32 v[144:145], v[144:145], s[48:49]
  v_pk_add_f32 v[146:147], v[146:147], s[48:49]
  v_pk_add_f32 v[148:149], v[148:149], s[48:49]
  v_pk_add_f32 v[150:151], v[150:151], s[48:49]
  v_rcp_f32 v144, v144
  v_rcp_f32 v145, v145
  v_rcp_f32 v146, v146
  v_rcp_f32 v147, v147
  v_rcp_f32 v148, v148
  v_rcp_f32 v149, v149
  v_rcp_f32 v150, v150
  v_rcp_f32 v151, v151
  v_pk_mul_f32 v[112:113], v[112:113], v[144:145]
  v_pk_mul_f32 v[114:115], v[114:115], v[146:147]
  v_pk_mul_f32 v[140:141], v[140:141], v[148:149]
  v_pk_mul_f32 v[142:143], v[142:143], v[150:151]
  v_cvt_pk_bf16_f32 v156, v112, v113
  v_cvt_pk_bf16_f32 v157, v114, v115
  v_cvt_pk_bf16_f32 v158, v140, v141
  v_cvt_pk_bf16_f32 v159, v142, v143
  s_nop 0
  v_permlane16_swap_b32 v156, v158
  v_permlane16_swap_b32 v157, v159
  buffer_store_dwordx4 v[156:159], v31, s[4:7], s38 offen offset:512 sc1
  s_lshr_b32 s26, s35, 3
  s_and_b32 s35, s35, 7
  s_lshl_b32 s27, s35, 1
  s_add_u32 s27, s27, s26
  s_mul_i32 s30, s34, 917504
  s_mul_i32 s36, s26, 458752
  s_add_u32 s30, s30, s36
  s_add_u32 s30, s30, 50331648
  s_lshl_b32 s31, s35, 8
  s_mul_i32 s36, s26, 3670016
  s_add_u32 s31, s31, s36
  s_lshr_b32 s40, s33, 1
  s_and_b32 s41, s33, 1
  v_and_b32 v2, 15, v1
  v_lshrrev_b32 v3, 4, v1
  v_lshlrev_b32 v4, 11, v3
  v_lshl_add_u32 v4, v2, 4, v4
  s_lshl_b32 s36, s40, 10
  v_add_u32_e64 v6, s36, v4
  v_add_u32 v7, 8192, v6
  v_bfe_u32 v2, v1, 2, 2
  v_lshl_add_u32 v2, v3, 3, v2
  v_and_b32_e64 v4, 3, v2
  v_bfe_u32 v5, v2, 3, 1
  v_lshl_or_b32 v4, v5, 2, v4
  v_mul_u32_u24 v2, 256, v2
  v_and_b32 v3, 3, v1
  v_lshl_add_u32 v2, v3, 3, v2
  v_add_u32 v2, 16384, v2
  s_mul_i32 s36, s41, 4
  s_xor_b32 s37, s26, 0
  s_lshl_b32 s37, s37, 1
  s_add_u32 s37, s37, s41
  s_lshl_b32 s37, s37, 1
  v_xor_b32 v3, s37, v4
  v_lshl_add_u32 v10, v3, 5, v2
  s_xor_b32 s37, s26, 0
  s_lshl_b32 s37, s37, 1
  s_add_u32 s37, s37, s41
  s_lshl_b32 s37, s37, 1
  s_add_u32 s37, s37, 1
  v_xor_b32 v3, s37, v4
  v_lshl_add_u32 v11, v3, 5, v2
  s_xor_b32 s37, s26, 1
  s_lshl_b32 s37, s37, 1
  s_add_u32 s37, s37, s41
  s_lshl_b32 s37, s37, 1
  v_xor_b32 v3, s37, v4
  v_lshl_add_u32 v12, v3, 5, v2
  s_xor_b32 s37, s26, 1
  s_lshl_b32 s37, s37, 1
  s_add_u32 s37, s37, s41
  s_lshl_b32 s37, s37, 1
  s_add_u32 s37, s37, 1
  v_xor_b32 v3, s37, v4
  v_lshl_add_u32 v13, v3, 5, v2
  v_add_u32 v8, 65536, v6
  v_add_u32 v9, 65536, v7
  v_add_u32 v14, 65536, v10
  v_add_u32 v15, 65536, v11
  v_add_u32 v16, 65536, v12
  v_add_u32 v17, 65536, v13
  s_waitcnt lgkmcnt(0)
  s_barrier
  ds_read_b64_tr_b16 a[16:17], v10 offset:0
  ds_read_b64_tr_b16 a[18:19], v10 offset:1024
  ds_read_b128 a[0:3], v6 offset:0
  ds_read_b128 a[4:7], v6 offset:256
  ds_read_b128 a[8:11], v6 offset:512
  ds_read_b128 a[12:15], v6 offset:768
  ds_read_b64_tr_b16 a[20:21], v11 offset:0
  ds_read_b64_tr_b16 a[22:23], v11 offset:1024
  ds_read_b64_tr_b16 a[24:25], v12 offset:0
  ds_read_b64_tr_b16 a[26:27], v12 offset:1024
  ds_read_b64_tr_b16 a[28:29], v13 offset:0
  ds_read_b64_tr_b16 a[30:31], v13 offset:1024
  s_waitcnt lgkmcnt(9)
  v_mfma_f32_16x16x32_bf16 v[32:35], a[16:19], a[0:3], 0
  ds_read_b64_tr_b16 a[48:49], v10 offset:8192
  v_and_b32 v2, 15, v1
  s_waitcnt lgkmcnt(9)
  v_mfma_f32_16x16x32_bf16 v[48:51], a[16:19], a[4:7], 0
  ds_read_b64_tr_b16 a[50:51], v10 offset:9216
  v_lshrrev_b32 v3, 4, v1
  s_waitcnt lgkmcnt(9)
  v_mfma_f32_16x16x32_bf16 v[64:67], a[16:19], a[8:11], 0
  ds_read_b128 a[32:35], v7 offset:0
  v_and_b32 v4, 1, v3
  s_waitcnt lgkmcnt(9)
  v_mfma_f32_16x16x32_bf16 v[80:83], a[16:19], a[12:15], 0
  ds_read_b128 a[36:39], v7 offset:256
  v_lshrrev_b32 v3, 1, v3
  s_waitcnt lgkmcnt(8)
  v_mfma_f32_16x16x32_bf16 v[36:39], a[20:23], a[0:3], 0
  ds_read_b128 a[40:43], v7 offset:512
  v_lshl_or_b32 v3, v4, 1, v3
  v_mfma_f32_16x16x32_bf16 v[52:55], a[20:23], a[4:7], 0
  ds_read_b128 a[44:47], v7 offset:768
  s_lshl_b32 s51, s33, 12
  v_mfma_f32_16x16x32_bf16 v[68:71], a[20:23], a[8:11], 0
  ds_read_b64_tr_b16 a[52:53], v11 offset:8192
  v_lshlrev_b32 v4, 6, v2
  v_mfma_f32_16x16x32_bf16 v[84:87], a[20:23], a[12:15], 0
  ds_read_b64_tr_b16 a[54:55], v11 offset:9216
  v_lshl_add_u32 v4, v3, 4, v4
  s_waitcnt lgkmcnt(10)
  v_mfma_f32_16x16x32_bf16 v[40:43], a[24:27], a[0:3], 0
  ds_read_b64_tr_b16 a[56:57], v12 offset:8192
  v_add_u32 v190, s51, v4
  v_mfma_f32_16x16x32_bf16 v[56:59], a[24:27], a[4:7], 0
  ds_read_b64_tr_b16 a[58:59], v12 offset:9216
  v_lshl_add_u32 v191, v1, 4, s51
  v_mfma_f32_16x16x32_bf16 v[72:75], a[24:27], a[8:11], 0
  ds_read_b64_tr_b16 a[60:61], v13 offset:8192
  v_lshrrev_b32 v4, 2, v1
  v_mfma_f32_16x16x32_bf16 v[88:91], a[24:27], a[12:15], 0
  ds_read_b64_tr_b16 a[62:63], v13 offset:9216
  v_lshlrev_b32 v4, 11, v4
  s_waitcnt lgkmcnt(12)
  v_mfma_f32_16x16x32_bf16 v[44:47], a[28:31], a[0:3], 0
  v_and_b32 v3, 3, v1
  v_mfma_f32_16x16x32_bf16 v[60:63], a[28:31], a[4:7], 0
  v_lshl_add_u32 v18, v3, 4, v4
  v_mfma_f32_16x16x32_bf16 v[76:79], a[28:31], a[8:11], 0
  v_lshlrev_b32 v19, 3, v2
  v_mfma_f32_16x16x32_bf16 v[92:95], a[28:31], a[12:15], 0
  s_lshl_b32 s36, s34, 1
  s_waitcnt lgkmcnt(9)
  v_mfma_f32_16x16x32_bf16 v[32:35], a[48:51], a[32:35], v[32:35]
  s_add_u32 s36, s36, s40
  s_waitcnt lgkmcnt(8)
  v_mfma_f32_16x16x32_bf16 v[48:51], a[48:51], a[36:39], v[48:51]
  s_lshl_b32 s50, s36, 17
  s_waitcnt lgkmcnt(7)
  v_mfma_f32_16x16x32_bf16 v[64:67], a[48:51], a[40:43], v[64:67]
  s_lshl_b32 s51, s27, 7
  s_waitcnt lgkmcnt(6)
  v_mfma_f32_16x16x32_bf16 v[80:83], a[48:51], a[44:47], v[80:83]
  s_waitcnt lgkmcnt(0)
  s_barrier
  ds_read_b64_tr_b16 a[16:17], v10 offset:32768
  s_add_u32 s50, s50, s51
  v_mfma_f32_16x16x32_bf16 v[36:39], a[52:55], a[32:35], v[36:39]
  ds_read_b64_tr_b16 a[18:19], v10 offset:33792
  s_lshl_b32 s51, s41, 6
  v_mfma_f32_16x16x32_bf16 v[52:55], a[52:55], a[36:39], v[52:55]
  ds_read_b128 a[0:3], v6 offset:32768
  s_add_u32 s50, s50, s51
  v_mfma_f32_16x16x32_bf16 v[68:71], a[52:55], a[40:43], v[68:71]
  ds_read_b128 a[4:7], v6 offset:33024
  s_lshl_b32 s51, s36, 9
  v_mfma_f32_16x16x32_bf16 v[84:87], a[52:55], a[44:47], v[84:87]
  ds_read_b128 a[8:11], v6 offset:33280
  s_add_u32 s52, s51, 36700160
  v_mfma_f32_16x16x32_bf16 v[40:43], a[56:59], a[32:35], v[40:43]
  ds_read_b128 a[12:15], v6 offset:33536
  v_lshrrev_b32 v3, 5, v1
  v_mfma_f32_16x16x32_bf16 v[56:59], a[56:59], a[36:39], v[56:59]
  ds_read_b64_tr_b16 a[20:21], v11 offset:32768
  s_lshl_b32 s51, s41, 2
  v_mfma_f32_16x16x32_bf16 v[72:75], a[56:59], a[40:43], v[72:75]
  ds_read_b64_tr_b16 a[22:23], v11 offset:33792
  v_add_u32 v3, s51, v3
  v_mfma_f32_16x16x32_bf16 v[88:91], a[56:59], a[44:47], v[88:91]
  ds_read_b64_tr_b16 a[24:25], v12 offset:32768
  v_lshrrev_b32 v4, 1, v2
  v_mfma_f32_16x16x32_bf16 v[44:47], a[60:63], a[32:35], v[44:47]
  ds_read_b64_tr_b16 a[26:27], v12 offset:33792
  v_xor_b32 v3, v3, v4
  v_mfma_f32_16x16x32_bf16 v[60:63], a[60:63], a[36:39], v[60:63]
  ds_read_b64_tr_b16 a[28:29], v13 offset:32768
  v_bfe_u32 v4, v1, 4, 1
  v_mfma_f32_16x16x32_bf16 v[76:79], a[60:63], a[40:43], v[76:79]
  ds_read_b64_tr_b16 a[30:31], v13 offset:33792
  v_lshlrev_b32 v4, 3, v4
  v_mfma_f32_16x16x32_bf16 v[92:95], a[60:63], a[44:47], v[92:95]
  v_lshl_add_u32 v4, v2, 7, v4
  s_waitcnt lgkmcnt(9)
  v_mfma_f32_16x16x32_bf16 v[32:35], a[16:19], a[0:3], v[32:35]
  ds_read_b64_tr_b16 a[48:49], v10 offset:40960
  s_lshl_b32 s51, s40, 13
  s_waitcnt lgkmcnt(9)
  v_mfma_f32_16x16x32_bf16 v[48:51], a[16:19], a[4:7], v[48:51]
  ds_read_b64_tr_b16 a[50:51], v10 offset:41984
  s_add_u32 s51, s51, 131072
  s_waitcnt lgkmcnt(9)
  v_mfma_f32_16x16x32_bf16 v[64:67], a[16:19], a[8:11], v[64:67]
  ds_read_b128 a[32:35], v7 offset:32768
  v_add_u32 v4, s51, v4
  s_waitcnt lgkmcnt(9)
  v_mfma_f32_16x16x32_bf16 v[80:83], a[16:19], a[12:15], v[80:83]
  ds_read_b128 a[36:39], v7 offset:33024
  v_lshl_add_u32 v28, v3, 4, v4
  s_waitcnt lgkmcnt(8)
  v_mfma_f32_16x16x32_bf16 v[36:39], a[20:23], a[0:3], v[36:39]
  ds_read_b128 a[40:43], v7 offset:33280
  v_xor_b32 v29, 32, v28
  v_mfma_f32_16x16x32_bf16 v[52:55], a[20:23], a[4:7], v[52:55]
  ds_read_b128 a[44:47], v7 offset:33536
  v_lshrrev_b32 v3, 2, v1
  v_mfma_f32_16x16x32_bf16 v[68:71], a[20:23], a[8:11], v[68:71]
  ds_read_b64_tr_b16 a[52:53], v11 offset:40960
  v_and_b32 v4, 3, v1
  v_mfma_f32_16x16x32_bf16 v[84:87], a[20:23], a[12:15], v[84:87]
  ds_read_b64_tr_b16 a[54:55], v11 offset:41984
  v_lshlrev_b32 v4, 3, v4
  s_waitcnt lgkmcnt(10)
  v_mfma_f32_16x16x32_bf16 v[40:43], a[24:27], a[0:3], v[40:43]
  ds_read_b64_tr_b16 a[56:57], v12 offset:40960
  v_lshl_add_u32 v3, v3, 8, v4
  v_mfma_f32_16x16x32_bf16 v[56:59], a[24:27], a[4:7], v[56:59]
  ds_read_b64_tr_b16 a[58:59], v12 offset:41984
  s_lshl_b32 s51, s41, 13
  v_mfma_f32_16x16x32_bf16 v[72:75], a[24:27], a[8:11], v[72:75]
  ds_read_b64_tr_b16 a[60:61], v13 offset:40960
  s_lshl_b32 s53, s40, 7
  v_mfma_f32_16x16x32_bf16 v[88:91], a[24:27], a[12:15], v[88:91]
  ds_read_b64_tr_b16 a[62:63], v13 offset:41984
  s_add_u32 s51, s51, s53
  s_waitcnt lgkmcnt(12)
  v_mfma_f32_16x16x32_bf16 v[44:47], a[28:31], a[0:3], v[44:47]
  s_add_u32 s51, s51, 147456
  v_mfma_f32_16x16x32_bf16 v[60:63], a[28:31], a[4:7], v[60:63]
  v_add_u32 v30, s51, v3
  v_mfma_f32_16x16x32_bf16 v[76:79], a[28:31], a[8:11], v[76:79]
  v_lshrrev_b32 v3, 5, v1
  v_mfma_f32_16x16x32_bf16 v[92:95], a[28:31], a[12:15], v[92:95]
  v_lshlrev_b32 v3, 11, v3
  s_waitcnt lgkmcnt(9)
  v_mfma_f32_16x16x32_bf16 v[32:35], a[48:51], a[32:35], v[32:35]
  v_lshl_add_u32 v3, v2, 4, v3
  s_waitcnt lgkmcnt(8)
  v_mfma_f32_16x16x32_bf16 v[48:51], a[48:51], a[36:39], v[48:51]
  v_bfe_u32 v4, v1, 4, 1
  s_waitcnt lgkmcnt(7)
  v_mfma_f32_16x16x32_bf16 v[64:67], a[48:51], a[40:43], v[64:67]
  v_lshl_add_u32 v3, v4, 3, v3
  s_waitcnt lgkmcnt(6)
  v_mfma_f32_16x16x32_bf16 v[80:83], a[48:51], a[44:47], v[80:83]
  s_waitcnt lgkmcnt(0)
  s_waitcnt vmcnt(0)
  s_barrier
  ds_read_b64_tr_b16 a[16:17], v14 offset:0
  s_lshl_b32 s51, s41, 13
  v_mfma_f32_16x16x32_bf16 v[36:39], a[52:55], a[32:35], v[36:39]
  ds_read_b64_tr_b16 a[18:19], v14 offset:1024
  s_lshl_b32 s53, s40, 10
  v_mfma_f32_16x16x32_bf16 v[52:55], a[52:55], a[36:39], v[52:55]
  ds_read_b128 a[0:3], v8 offset:0
  s_add_u32 s51, s51, s53
  v_mfma_f32_16x16x32_bf16 v[68:71], a[52:55], a[40:43], v[68:71]
  ds_read_b128 a[4:7], v8 offset:256
  v_add_u32 v31, s51, v3
  v_mfma_f32_16x16x32_bf16 v[84:87], a[52:55], a[44:47], v[84:87]
  ds_read_b128 a[8:11], v8 offset:512
  s_mul_i32 s57, s34, 262144
  v_mfma_f32_16x16x32_bf16 v[40:43], a[56:59], a[32:35], v[40:43]
  ds_read_b128 a[12:15], v8 offset:768
  s_lshl_b32 s51, s27, 14
  v_mfma_f32_16x16x32_bf16 v[56:59], a[56:59], a[36:39], v[56:59]
  ds_read_b64_tr_b16 a[20:21], v15 offset:0
  s_add_u32 s57, s57, s51
  v_mfma_f32_16x16x32_bf16 v[72:75], a[56:59], a[40:43], v[72:75]
  ds_read_b64_tr_b16 a[22:23], v15 offset:1024
  s_add_u32 s57, s57, 16777216
  v_mfma_f32_16x16x32_bf16 v[88:91], a[56:59], a[44:47], v[88:91]
  ds_read_b64_tr_b16 a[24:25], v16 offset:0
  s_add_u32 s43, s57, 4096
  v_mfma_f32_16x16x32_bf16 v[44:47], a[60:63], a[32:35], v[44:47]
  ds_read_b64_tr_b16 a[26:27], v16 offset:1024
  s_lshl_b32 s53, s34, 4
  v_mfma_f32_16x16x32_bf16 v[60:63], a[60:63], a[36:39], v[60:63]
  ds_read_b64_tr_b16 a[28:29], v17 offset:0
  s_add_u32 s53, s53, s27
  v_mfma_f32_16x16x32_bf16 v[76:79], a[60:63], a[40:43], v[76:79]
  ds_read_b64_tr_b16 a[30:31], v17 offset:1024
  s_lshl_b32 s53, s53, 2
  v_mfma_f32_16x16x32_bf16 v[92:95], a[60:63], a[44:47], v[92:95]
  s_add_u32 s53, s53, s33
  s_waitcnt lgkmcnt(9)
  v_mfma_f32_16x16x32_bf16 v[32:35], a[16:19], a[0:3], v[32:35]
  ds_read_b64_tr_b16 a[48:49], v14 offset:8192
  s_xor_b32 s54, s53, 4
  s_waitcnt lgkmcnt(9)
  v_mfma_f32_16x16x32_bf16 v[48:51], a[16:19], a[4:7], v[48:51]
  ds_read_b64_tr_b16 a[50:51], v14 offset:9216
  s_lshl_b32 s55, s53, 12
  s_waitcnt lgkmcnt(9)
  v_mfma_f32_16x16x32_bf16 v[64:67], a[16:19], a[8:11], v[64:67]
  ds_read_b128 a[32:35], v9 offset:0
  s_add_u32 s55, s55, 0
  s_waitcnt lgkmcnt(9)
  v_mfma_f32_16x16x32_bf16 v[80:83], a[16:19], a[12:15], v[80:83]
  ds_read_b128 a[36:39], v9 offset:256
  s_lshl_b32 s56, s54, 12
  s_waitcnt lgkmcnt(8)
  v_mfma_f32_16x16x32_bf16 v[36:39], a[20:23], a[0:3], v[36:39]
  ds_read_b128 a[40:43], v9 offset:512
  s_add_u32 s56, s56, 0
  v_mfma_f32_16x16x32_bf16 v[52:55], a[20:23], a[4:7], v[52:55]
  ds_read_b128 a[44:47], v9 offset:768
  s_lshl_b32 s53, s53, 5
  v_mfma_f32_16x16x32_bf16 v[68:71], a[20:23], a[8:11], v[68:71]
  ds_read_b64_tr_b16 a[52:53], v15 offset:8192
  s_add_u32 s53, s53, 39845888
  v_mfma_f32_16x16x32_bf16 v[84:87], a[20:23], a[12:15], v[84:87]
  ds_read_b64_tr_b16 a[54:55], v15 offset:9216
  s_lshl_b32 s54, s54, 5
  s_waitcnt lgkmcnt(10)
  v_mfma_f32_16x16x32_bf16 v[40:43], a[24:27], a[0:3], v[40:43]
  ds_read_b64_tr_b16 a[56:57], v16 offset:8192
  s_add_u32 s54, s54, 39845888
  v_mfma_f32_16x16x32_bf16 v[56:59], a[24:27], a[4:7], v[56:59]
  ds_read_b64_tr_b16 a[58:59], v16 offset:9216
  v_lshlrev_b32 v5, 4, v1
  v_mfma_f32_16x16x32_bf16 v[72:75], a[24:27], a[8:11], v[72:75]
  ds_read_b64_tr_b16 a[60:61], v17 offset:8192
  s_mov_b32 s44, 0xbfb8aa3b
  v_mfma_f32_16x16x32_bf16 v[88:91], a[24:27], a[12:15], v[88:91]
  ds_read_b64_tr_b16 a[62:63], v17 offset:9216
  s_mov_b32 s45, 0xbfb8aa3b
  s_waitcnt lgkmcnt(12)
  v_mfma_f32_16x16x32_bf16 v[44:47], a[28:31], a[0:3], v[44:47]
  s_mov_b32 s48, 1.0
  v_mfma_f32_16x16x32_bf16 v[60:63], a[28:31], a[4:7], v[60:63]
  s_mov_b32 s49, 1.0
  v_mfma_f32_16x16x32_bf16 v[76:79], a[28:31], a[8:11], v[76:79]
  s_add_u32 s58, s55, 4096
  v_mfma_f32_16x16x32_bf16 v[92:95], a[28:31], a[12:15], v[92:95]
  s_add_u32 s59, s56, 4096
  s_waitcnt lgkmcnt(9)
  v_mfma_f32_16x16x32_bf16 v[32:35], a[48:51], a[32:35], v[32:35]
  buffer_load_dwordx2 v[20:21], v19, s[4:7], s52 offen offset:0 sc1
  s_waitcnt lgkmcnt(8)
  v_mfma_f32_16x16x32_bf16 v[48:51], a[48:51], a[36:39], v[48:51]
  buffer_load_dwordx2 v[22:23], v19, s[4:7], s52 offen offset:128 sc1
  s_waitcnt lgkmcnt(7)
  v_mfma_f32_16x16x32_bf16 v[64:67], a[48:51], a[40:43], v[64:67]
  buffer_load_dwordx2 v[24:25], v19, s[4:7], s52 offen offset:256 sc1
  s_waitcnt lgkmcnt(6)
  v_mfma_f32_16x16x32_bf16 v[80:83], a[48:51], a[44:47], v[80:83]
  s_waitcnt lgkmcnt(0)
  s_barrier
  ds_read_b64_tr_b16 a[16:17], v14 offset:32768
  buffer_load_dwordx2 v[26:27], v19, s[4:7], s52 offen offset:384 sc1
  v_mfma_f32_16x16x32_bf16 v[36:39], a[52:55], a[32:35], v[36:39]
  ds_read_b64_tr_b16 a[18:19], v14 offset:33792
  v_mfma_f32_16x16x32_bf16 v[52:55], a[52:55], a[36:39], v[52:55]
  ds_read_b128 a[0:3], v8 offset:32768
  v_mfma_f32_16x16x32_bf16 v[68:71], a[52:55], a[40:43], v[68:71]
  ds_read_b128 a[4:7], v8 offset:33024
  v_mfma_f32_16x16x32_bf16 v[84:87], a[52:55], a[44:47], v[84:87]
  ds_read_b128 a[8:11], v8 offset:33280
  v_mfma_f32_16x16x32_bf16 v[40:43], a[56:59], a[32:35], v[40:43]
  ds_read_b128 a[12:15], v8 offset:33536
  v_mfma_f32_16x16x32_bf16 v[56:59], a[56:59], a[36:39], v[56:59]
  ds_read_b64_tr_b16 a[20:21], v15 offset:32768
  v_mfma_f32_16x16x32_bf16 v[72:75], a[56:59], a[40:43], v[72:75]
  ds_read_b64_tr_b16 a[22:23], v15 offset:33792
  v_mfma_f32_16x16x32_bf16 v[88:91], a[56:59], a[44:47], v[88:91]
  ds_read_b64_tr_b16 a[24:25], v16 offset:32768
  v_mfma_f32_16x16x32_bf16 v[44:47], a[60:63], a[32:35], v[44:47]
  ds_read_b64_tr_b16 a[26:27], v16 offset:33792
  v_mfma_f32_16x16x32_bf16 v[60:63], a[60:63], a[36:39], v[60:63]
  ds_read_b64_tr_b16 a[28:29], v17 offset:32768
  v_mfma_f32_16x16x32_bf16 v[76:79], a[60:63], a[40:43], v[76:79]
  ds_read_b64_tr_b16 a[30:31], v17 offset:33792
  v_mfma_f32_16x16x32_bf16 v[92:95], a[60:63], a[44:47], v[92:95]
  s_waitcnt lgkmcnt(9)
  v_mfma_f32_16x16x32_bf16 v[32:35], a[16:19], a[0:3], v[32:35]
  ds_read_b64_tr_b16 a[48:49], v14 offset:40960
  s_waitcnt lgkmcnt(9)
  v_mfma_f32_16x16x32_bf16 v[48:51], a[16:19], a[4:7], v[48:51]
  ds_read_b64_tr_b16 a[50:51], v14 offset:41984
  s_waitcnt lgkmcnt(9)
  v_mfma_f32_16x16x32_bf16 v[64:67], a[16:19], a[8:11], v[64:67]
  ds_read_b128 a[32:35], v9 offset:32768
  s_waitcnt lgkmcnt(9)
  v_mfma_f32_16x16x32_bf16 v[80:83], a[16:19], a[12:15], v[80:83]
  ds_read_b128 a[36:39], v9 offset:33024
  s_waitcnt lgkmcnt(8)
  v_mfma_f32_16x16x32_bf16 v[36:39], a[20:23], a[0:3], v[36:39]
  ds_read_b128 a[40:43], v9 offset:33280
  v_mfma_f32_16x16x32_bf16 v[52:55], a[20:23], a[4:7], v[52:55]
  ds_read_b128 a[44:47], v9 offset:33536
  v_mfma_f32_16x16x32_bf16 v[68:71], a[20:23], a[8:11], v[68:71]
  ds_read_b64_tr_b16 a[52:53], v15 offset:40960
  v_mfma_f32_16x16x32_bf16 v[84:87], a[20:23], a[12:15], v[84:87]
  ds_read_b64_tr_b16 a[54:55], v15 offset:41984
  s_waitcnt lgkmcnt(10)
  v_mfma_f32_16x16x32_bf16 v[40:43], a[24:27], a[0:3], v[40:43]
  ds_read_b64_tr_b16 a[56:57], v16 offset:40960
  v_mfma_f32_16x16x32_bf16 v[56:59], a[24:27], a[4:7], v[56:59]
  ds_read_b64_tr_b16 a[58:59], v16 offset:41984
  v_mfma_f32_16x16x32_bf16 v[72:75], a[24:27], a[8:11], v[72:75]
  ds_read_b64_tr_b16 a[60:61], v17 offset:40960
  v_mfma_f32_16x16x32_bf16 v[88:91], a[24:27], a[12:15], v[88:91]
  ds_read_b64_tr_b16 a[62:63], v17 offset:41984
  s_waitcnt lgkmcnt(12)
  v_mfma_f32_16x16x32_bf16 v[44:47], a[28:31], a[0:3], v[44:47]
  v_mfma_f32_16x16x32_bf16 v[60:63], a[28:31], a[4:7], v[60:63]
  v_mfma_f32_16x16x32_bf16 v[76:79], a[28:31], a[8:11], v[76:79]
  v_mfma_f32_16x16x32_bf16 v[92:95], a[28:31], a[12:15], v[92:95]
  s_waitcnt lgkmcnt(9)
  v_mfma_f32_16x16x32_bf16 v[32:35], a[48:51], a[32:35], v[32:35]
  s_waitcnt lgkmcnt(8)
  v_mfma_f32_16x16x32_bf16 v[48:51], a[48:51], a[36:39], v[48:51]
  s_waitcnt lgkmcnt(7)
  v_mfma_f32_16x16x32_bf16 v[64:67], a[48:51], a[40:43], v[64:67]
  s_waitcnt lgkmcnt(6)
  v_mfma_f32_16x16x32_bf16 v[80:83], a[48:51], a[44:47], v[80:83]
  s_waitcnt lgkmcnt(0)
  s_barrier
  ds_read_b64_tr_b16 a[16:17], v10 offset:0
  v_mfma_f32_16x16x32_bf16 v[36:39], a[52:55], a[32:35], v[36:39]
  ds_read_b64_tr_b16 a[18:19], v10 offset:1024
  v_mfma_f32_16x16x32_bf16 v[52:55], a[52:55], a[36:39], v[52:55]
  ds_read_b128 a[0:3], v6 offset:0
  v_mfma_f32_16x16x32_bf16 v[68:71], a[52:55], a[40:43], v[68:71]
  ds_read_b128 a[4:7], v6 offset:256
  v_mfma_f32_16x16x32_bf16 v[84:87], a[52:55], a[44:47], v[84:87]
  ds_read_b128 a[8:11], v6 offset:512
  v_mfma_f32_16x16x32_bf16 v[40:43], a[56:59], a[32:35], v[40:43]
  ds_read_b128 a[12:15], v6 offset:768
  v_mfma_f32_16x16x32_bf16 v[56:59], a[56:59], a[36:39], v[56:59]
  ds_read_b64_tr_b16 a[20:21], v11 offset:0
  v_mfma_f32_16x16x32_bf16 v[72:75], a[56:59], a[40:43], v[72:75]
  ds_read_b64_tr_b16 a[22:23], v11 offset:1024
  v_mfma_f32_16x16x32_bf16 v[88:91], a[56:59], a[44:47], v[88:91]
  ds_read_b64_tr_b16 a[24:25], v12 offset:0
  v_mfma_f32_16x16x32_bf16 v[44:47], a[60:63], a[32:35], v[44:47]
  ds_read_b64_tr_b16 a[26:27], v12 offset:1024
  v_mfma_f32_16x16x32_bf16 v[60:63], a[60:63], a[36:39], v[60:63]
  ds_read_b64_tr_b16 a[28:29], v13 offset:0
  v_mfma_f32_16x16x32_bf16 v[76:79], a[60:63], a[40:43], v[76:79]
  ds_read_b64_tr_b16 a[30:31], v13 offset:1024
  v_mfma_f32_16x16x32_bf16 v[92:95], a[60:63], a[44:47], v[92:95]
  s_mov_b32 s32, 5
  .p2align 3
recurrent_scan__ssm_conv_h3__mixer_s_mlp__prompt_kernel_cm1002:
  s_waitcnt lgkmcnt(9)
  v_mfma_f32_16x16x32_bf16 v[32:35], a[16:19], a[0:3], v[32:35]
  ds_read_b64_tr_b16 a[48:49], v10 offset:8192
  s_waitcnt lgkmcnt(9)
  v_mfma_f32_16x16x32_bf16 v[48:51], a[16:19], a[4:7], v[48:51]
  ds_read_b64_tr_b16 a[50:51], v10 offset:9216
  s_waitcnt lgkmcnt(9)
  v_mfma_f32_16x16x32_bf16 v[64:67], a[16:19], a[8:11], v[64:67]
  ds_read_b128 a[32:35], v7 offset:0
  s_waitcnt lgkmcnt(9)
  v_mfma_f32_16x16x32_bf16 v[80:83], a[16:19], a[12:15], v[80:83]
  ds_read_b128 a[36:39], v7 offset:256
  s_waitcnt lgkmcnt(8)
  v_mfma_f32_16x16x32_bf16 v[36:39], a[20:23], a[0:3], v[36:39]
  ds_read_b128 a[40:43], v7 offset:512
  v_mfma_f32_16x16x32_bf16 v[52:55], a[20:23], a[4:7], v[52:55]
  ds_read_b128 a[44:47], v7 offset:768
  v_mfma_f32_16x16x32_bf16 v[68:71], a[20:23], a[8:11], v[68:71]
  ds_read_b64_tr_b16 a[52:53], v11 offset:8192
  v_mfma_f32_16x16x32_bf16 v[84:87], a[20:23], a[12:15], v[84:87]
  ds_read_b64_tr_b16 a[54:55], v11 offset:9216
  s_waitcnt lgkmcnt(10)
  v_mfma_f32_16x16x32_bf16 v[40:43], a[24:27], a[0:3], v[40:43]
  ds_read_b64_tr_b16 a[56:57], v12 offset:8192
  v_mfma_f32_16x16x32_bf16 v[56:59], a[24:27], a[4:7], v[56:59]
  ds_read_b64_tr_b16 a[58:59], v12 offset:9216
  v_mfma_f32_16x16x32_bf16 v[72:75], a[24:27], a[8:11], v[72:75]
  ds_read_b64_tr_b16 a[60:61], v13 offset:8192
  v_mfma_f32_16x16x32_bf16 v[88:91], a[24:27], a[12:15], v[88:91]
  ds_read_b64_tr_b16 a[62:63], v13 offset:9216
  s_waitcnt lgkmcnt(12)
  v_mfma_f32_16x16x32_bf16 v[44:47], a[28:31], a[0:3], v[44:47]
  v_mfma_f32_16x16x32_bf16 v[60:63], a[28:31], a[4:7], v[60:63]
  v_mfma_f32_16x16x32_bf16 v[76:79], a[28:31], a[8:11], v[76:79]
  v_mfma_f32_16x16x32_bf16 v[92:95], a[28:31], a[12:15], v[92:95]
  s_waitcnt lgkmcnt(9)
  v_mfma_f32_16x16x32_bf16 v[32:35], a[48:51], a[32:35], v[32:35]
  s_waitcnt lgkmcnt(8)
  v_mfma_f32_16x16x32_bf16 v[48:51], a[48:51], a[36:39], v[48:51]
  s_waitcnt lgkmcnt(7)
  v_mfma_f32_16x16x32_bf16 v[64:67], a[48:51], a[40:43], v[64:67]
  s_waitcnt lgkmcnt(6)
  v_mfma_f32_16x16x32_bf16 v[80:83], a[48:51], a[44:47], v[80:83]
  s_waitcnt lgkmcnt(0)
  s_barrier
  ds_read_b64_tr_b16 a[16:17], v10 offset:32768
  v_mfma_f32_16x16x32_bf16 v[36:39], a[52:55], a[32:35], v[36:39]
  ds_read_b64_tr_b16 a[18:19], v10 offset:33792
  v_mfma_f32_16x16x32_bf16 v[52:55], a[52:55], a[36:39], v[52:55]
  ds_read_b128 a[0:3], v6 offset:32768
  v_mfma_f32_16x16x32_bf16 v[68:71], a[52:55], a[40:43], v[68:71]
  ds_read_b128 a[4:7], v6 offset:33024
  v_mfma_f32_16x16x32_bf16 v[84:87], a[52:55], a[44:47], v[84:87]
  ds_read_b128 a[8:11], v6 offset:33280
  v_mfma_f32_16x16x32_bf16 v[40:43], a[56:59], a[32:35], v[40:43]
  ds_read_b128 a[12:15], v6 offset:33536
  v_mfma_f32_16x16x32_bf16 v[56:59], a[56:59], a[36:39], v[56:59]
  ds_read_b64_tr_b16 a[20:21], v11 offset:32768
  v_mfma_f32_16x16x32_bf16 v[72:75], a[56:59], a[40:43], v[72:75]
  ds_read_b64_tr_b16 a[22:23], v11 offset:33792
  v_mfma_f32_16x16x32_bf16 v[88:91], a[56:59], a[44:47], v[88:91]
  ds_read_b64_tr_b16 a[24:25], v12 offset:32768
  v_mfma_f32_16x16x32_bf16 v[44:47], a[60:63], a[32:35], v[44:47]
  ds_read_b64_tr_b16 a[26:27], v12 offset:33792
  v_mfma_f32_16x16x32_bf16 v[60:63], a[60:63], a[36:39], v[60:63]
  ds_read_b64_tr_b16 a[28:29], v13 offset:32768
  v_mfma_f32_16x16x32_bf16 v[76:79], a[60:63], a[40:43], v[76:79]
  ds_read_b64_tr_b16 a[30:31], v13 offset:33792
  v_mfma_f32_16x16x32_bf16 v[92:95], a[60:63], a[44:47], v[92:95]
  s_waitcnt lgkmcnt(9)
  v_mfma_f32_16x16x32_bf16 v[32:35], a[16:19], a[0:3], v[32:35]
  ds_read_b64_tr_b16 a[48:49], v10 offset:40960
  s_waitcnt lgkmcnt(9)
  v_mfma_f32_16x16x32_bf16 v[48:51], a[16:19], a[4:7], v[48:51]
  ds_read_b64_tr_b16 a[50:51], v10 offset:41984
  s_waitcnt lgkmcnt(9)
  v_mfma_f32_16x16x32_bf16 v[64:67], a[16:19], a[8:11], v[64:67]
  ds_read_b128 a[32:35], v7 offset:32768
  s_waitcnt lgkmcnt(9)
  v_mfma_f32_16x16x32_bf16 v[80:83], a[16:19], a[12:15], v[80:83]
  ds_read_b128 a[36:39], v7 offset:33024
  s_waitcnt lgkmcnt(8)
  v_mfma_f32_16x16x32_bf16 v[36:39], a[20:23], a[0:3], v[36:39]
  ds_read_b128 a[40:43], v7 offset:33280
  v_mfma_f32_16x16x32_bf16 v[52:55], a[20:23], a[4:7], v[52:55]
  ds_read_b128 a[44:47], v7 offset:33536
  v_mfma_f32_16x16x32_bf16 v[68:71], a[20:23], a[8:11], v[68:71]
  ds_read_b64_tr_b16 a[52:53], v11 offset:40960
  v_mfma_f32_16x16x32_bf16 v[84:87], a[20:23], a[12:15], v[84:87]
  ds_read_b64_tr_b16 a[54:55], v11 offset:41984
  s_waitcnt lgkmcnt(10)
  v_mfma_f32_16x16x32_bf16 v[40:43], a[24:27], a[0:3], v[40:43]
  ds_read_b64_tr_b16 a[56:57], v12 offset:40960
  v_mfma_f32_16x16x32_bf16 v[56:59], a[24:27], a[4:7], v[56:59]
  ds_read_b64_tr_b16 a[58:59], v12 offset:41984
  v_mfma_f32_16x16x32_bf16 v[72:75], a[24:27], a[8:11], v[72:75]
  ds_read_b64_tr_b16 a[60:61], v13 offset:40960
  v_mfma_f32_16x16x32_bf16 v[88:91], a[24:27], a[12:15], v[88:91]
  ds_read_b64_tr_b16 a[62:63], v13 offset:41984
  s_waitcnt lgkmcnt(12)
  v_mfma_f32_16x16x32_bf16 v[44:47], a[28:31], a[0:3], v[44:47]
  v_mfma_f32_16x16x32_bf16 v[60:63], a[28:31], a[4:7], v[60:63]
  v_mfma_f32_16x16x32_bf16 v[76:79], a[28:31], a[8:11], v[76:79]
  v_mfma_f32_16x16x32_bf16 v[92:95], a[28:31], a[12:15], v[92:95]
  s_waitcnt lgkmcnt(9)
  v_mfma_f32_16x16x32_bf16 v[32:35], a[48:51], a[32:35], v[32:35]
  s_waitcnt lgkmcnt(8)
  v_mfma_f32_16x16x32_bf16 v[48:51], a[48:51], a[36:39], v[48:51]
  s_waitcnt lgkmcnt(7)
  v_mfma_f32_16x16x32_bf16 v[64:67], a[48:51], a[40:43], v[64:67]
  s_waitcnt lgkmcnt(6)
  v_mfma_f32_16x16x32_bf16 v[80:83], a[48:51], a[44:47], v[80:83]
  s_waitcnt lgkmcnt(0)
  s_barrier
  ds_read_b64_tr_b16 a[16:17], v14 offset:0
  v_mfma_f32_16x16x32_bf16 v[36:39], a[52:55], a[32:35], v[36:39]
  ds_read_b64_tr_b16 a[18:19], v14 offset:1024
  v_mfma_f32_16x16x32_bf16 v[52:55], a[52:55], a[36:39], v[52:55]
  ds_read_b128 a[0:3], v8 offset:0
  v_mfma_f32_16x16x32_bf16 v[68:71], a[52:55], a[40:43], v[68:71]
  ds_read_b128 a[4:7], v8 offset:256
  v_mfma_f32_16x16x32_bf16 v[84:87], a[52:55], a[44:47], v[84:87]
  ds_read_b128 a[8:11], v8 offset:512
  v_mfma_f32_16x16x32_bf16 v[40:43], a[56:59], a[32:35], v[40:43]
  ds_read_b128 a[12:15], v8 offset:768
  v_mfma_f32_16x16x32_bf16 v[56:59], a[56:59], a[36:39], v[56:59]
  ds_read_b64_tr_b16 a[20:21], v15 offset:0
  v_mfma_f32_16x16x32_bf16 v[72:75], a[56:59], a[40:43], v[72:75]
  ds_read_b64_tr_b16 a[22:23], v15 offset:1024
  v_mfma_f32_16x16x32_bf16 v[88:91], a[56:59], a[44:47], v[88:91]
  ds_read_b64_tr_b16 a[24:25], v16 offset:0
  v_mfma_f32_16x16x32_bf16 v[44:47], a[60:63], a[32:35], v[44:47]
  ds_read_b64_tr_b16 a[26:27], v16 offset:1024
  v_mfma_f32_16x16x32_bf16 v[60:63], a[60:63], a[36:39], v[60:63]
  ds_read_b64_tr_b16 a[28:29], v17 offset:0
  v_mfma_f32_16x16x32_bf16 v[76:79], a[60:63], a[40:43], v[76:79]
  ds_read_b64_tr_b16 a[30:31], v17 offset:1024
  v_mfma_f32_16x16x32_bf16 v[92:95], a[60:63], a[44:47], v[92:95]
  s_waitcnt lgkmcnt(9)
  v_mfma_f32_16x16x32_bf16 v[32:35], a[16:19], a[0:3], v[32:35]
  ds_read_b64_tr_b16 a[48:49], v14 offset:8192
  s_waitcnt lgkmcnt(9)
  v_mfma_f32_16x16x32_bf16 v[48:51], a[16:19], a[4:7], v[48:51]
  ds_read_b64_tr_b16 a[50:51], v14 offset:9216
  s_waitcnt lgkmcnt(9)
  v_mfma_f32_16x16x32_bf16 v[64:67], a[16:19], a[8:11], v[64:67]
  ds_read_b128 a[32:35], v9 offset:0
  s_waitcnt lgkmcnt(9)
  v_mfma_f32_16x16x32_bf16 v[80:83], a[16:19], a[12:15], v[80:83]
  ds_read_b128 a[36:39], v9 offset:256
  s_waitcnt lgkmcnt(8)
  v_mfma_f32_16x16x32_bf16 v[36:39], a[20:23], a[0:3], v[36:39]
  ds_read_b128 a[40:43], v9 offset:512
  v_mfma_f32_16x16x32_bf16 v[52:55], a[20:23], a[4:7], v[52:55]
  ds_read_b128 a[44:47], v9 offset:768
  v_mfma_f32_16x16x32_bf16 v[68:71], a[20:23], a[8:11], v[68:71]
  ds_read_b64_tr_b16 a[52:53], v15 offset:8192
  v_mfma_f32_16x16x32_bf16 v[84:87], a[20:23], a[12:15], v[84:87]
  ds_read_b64_tr_b16 a[54:55], v15 offset:9216
  s_waitcnt lgkmcnt(10)
  v_mfma_f32_16x16x32_bf16 v[40:43], a[24:27], a[0:3], v[40:43]
  ds_read_b64_tr_b16 a[56:57], v16 offset:8192
  v_mfma_f32_16x16x32_bf16 v[56:59], a[24:27], a[4:7], v[56:59]
  ds_read_b64_tr_b16 a[58:59], v16 offset:9216
  v_mfma_f32_16x16x32_bf16 v[72:75], a[24:27], a[8:11], v[72:75]
  ds_read_b64_tr_b16 a[60:61], v17 offset:8192
  v_mfma_f32_16x16x32_bf16 v[88:91], a[24:27], a[12:15], v[88:91]
  ds_read_b64_tr_b16 a[62:63], v17 offset:9216
  s_waitcnt lgkmcnt(12)
  v_mfma_f32_16x16x32_bf16 v[44:47], a[28:31], a[0:3], v[44:47]
  v_mfma_f32_16x16x32_bf16 v[60:63], a[28:31], a[4:7], v[60:63]
  v_mfma_f32_16x16x32_bf16 v[76:79], a[28:31], a[8:11], v[76:79]
  v_mfma_f32_16x16x32_bf16 v[92:95], a[28:31], a[12:15], v[92:95]
  s_waitcnt lgkmcnt(9)
  v_mfma_f32_16x16x32_bf16 v[32:35], a[48:51], a[32:35], v[32:35]
  s_waitcnt lgkmcnt(8)
  v_mfma_f32_16x16x32_bf16 v[48:51], a[48:51], a[36:39], v[48:51]
  s_waitcnt lgkmcnt(7)
  v_mfma_f32_16x16x32_bf16 v[64:67], a[48:51], a[40:43], v[64:67]
  s_waitcnt lgkmcnt(6)
  v_mfma_f32_16x16x32_bf16 v[80:83], a[48:51], a[44:47], v[80:83]
  s_waitcnt lgkmcnt(0)
  s_barrier
  ds_read_b64_tr_b16 a[16:17], v14 offset:32768
  v_mfma_f32_16x16x32_bf16 v[36:39], a[52:55], a[32:35], v[36:39]
  ds_read_b64_tr_b16 a[18:19], v14 offset:33792
  v_mfma_f32_16x16x32_bf16 v[52:55], a[52:55], a[36:39], v[52:55]
  ds_read_b128 a[0:3], v8 offset:32768
  v_mfma_f32_16x16x32_bf16 v[68:71], a[52:55], a[40:43], v[68:71]
  ds_read_b128 a[4:7], v8 offset:33024
  v_mfma_f32_16x16x32_bf16 v[84:87], a[52:55], a[44:47], v[84:87]
  ds_read_b128 a[8:11], v8 offset:33280
  v_mfma_f32_16x16x32_bf16 v[40:43], a[56:59], a[32:35], v[40:43]
  ds_read_b128 a[12:15], v8 offset:33536
  v_mfma_f32_16x16x32_bf16 v[56:59], a[56:59], a[36:39], v[56:59]
  ds_read_b64_tr_b16 a[20:21], v15 offset:32768
  v_mfma_f32_16x16x32_bf16 v[72:75], a[56:59], a[40:43], v[72:75]
  ds_read_b64_tr_b16 a[22:23], v15 offset:33792
  v_mfma_f32_16x16x32_bf16 v[88:91], a[56:59], a[44:47], v[88:91]
  ds_read_b64_tr_b16 a[24:25], v16 offset:32768
  v_mfma_f32_16x16x32_bf16 v[44:47], a[60:63], a[32:35], v[44:47]
  ds_read_b64_tr_b16 a[26:27], v16 offset:33792
  v_mfma_f32_16x16x32_bf16 v[60:63], a[60:63], a[36:39], v[60:63]
  ds_read_b64_tr_b16 a[28:29], v17 offset:32768
  v_mfma_f32_16x16x32_bf16 v[76:79], a[60:63], a[40:43], v[76:79]
  ds_read_b64_tr_b16 a[30:31], v17 offset:33792
  v_mfma_f32_16x16x32_bf16 v[92:95], a[60:63], a[44:47], v[92:95]
  s_waitcnt lgkmcnt(9)
  v_mfma_f32_16x16x32_bf16 v[32:35], a[16:19], a[0:3], v[32:35]
  ds_read_b64_tr_b16 a[48:49], v14 offset:40960
  s_waitcnt lgkmcnt(9)
  v_mfma_f32_16x16x32_bf16 v[48:51], a[16:19], a[4:7], v[48:51]
  ds_read_b64_tr_b16 a[50:51], v14 offset:41984
  s_waitcnt lgkmcnt(9)
  v_mfma_f32_16x16x32_bf16 v[64:67], a[16:19], a[8:11], v[64:67]
  ds_read_b128 a[32:35], v9 offset:32768
  s_waitcnt lgkmcnt(9)
  v_mfma_f32_16x16x32_bf16 v[80:83], a[16:19], a[12:15], v[80:83]
  ds_read_b128 a[36:39], v9 offset:33024
  s_waitcnt lgkmcnt(8)
  v_mfma_f32_16x16x32_bf16 v[36:39], a[20:23], a[0:3], v[36:39]
  ds_read_b128 a[40:43], v9 offset:33280
  v_mfma_f32_16x16x32_bf16 v[52:55], a[20:23], a[4:7], v[52:55]
  ds_read_b128 a[44:47], v9 offset:33536
  v_mfma_f32_16x16x32_bf16 v[68:71], a[20:23], a[8:11], v[68:71]
  ds_read_b64_tr_b16 a[52:53], v15 offset:40960
  v_mfma_f32_16x16x32_bf16 v[84:87], a[20:23], a[12:15], v[84:87]
  ds_read_b64_tr_b16 a[54:55], v15 offset:41984
  s_waitcnt lgkmcnt(10)
  v_mfma_f32_16x16x32_bf16 v[40:43], a[24:27], a[0:3], v[40:43]
  ds_read_b64_tr_b16 a[56:57], v16 offset:40960
  v_mfma_f32_16x16x32_bf16 v[56:59], a[24:27], a[4:7], v[56:59]
  ds_read_b64_tr_b16 a[58:59], v16 offset:41984
  v_mfma_f32_16x16x32_bf16 v[72:75], a[24:27], a[8:11], v[72:75]
  ds_read_b64_tr_b16 a[60:61], v17 offset:40960
  v_mfma_f32_16x16x32_bf16 v[88:91], a[24:27], a[12:15], v[88:91]
  ds_read_b64_tr_b16 a[62:63], v17 offset:41984
  s_waitcnt lgkmcnt(12)
  v_mfma_f32_16x16x32_bf16 v[44:47], a[28:31], a[0:3], v[44:47]
  v_mfma_f32_16x16x32_bf16 v[60:63], a[28:31], a[4:7], v[60:63]
  v_mfma_f32_16x16x32_bf16 v[76:79], a[28:31], a[8:11], v[76:79]
  v_mfma_f32_16x16x32_bf16 v[92:95], a[28:31], a[12:15], v[92:95]
  s_waitcnt lgkmcnt(9)
  v_mfma_f32_16x16x32_bf16 v[32:35], a[48:51], a[32:35], v[32:35]
  s_waitcnt lgkmcnt(8)
  v_mfma_f32_16x16x32_bf16 v[48:51], a[48:51], a[36:39], v[48:51]
  s_waitcnt lgkmcnt(7)
  v_mfma_f32_16x16x32_bf16 v[64:67], a[48:51], a[40:43], v[64:67]
  s_waitcnt lgkmcnt(6)
  v_mfma_f32_16x16x32_bf16 v[80:83], a[48:51], a[44:47], v[80:83]
  s_waitcnt lgkmcnt(0)
  s_barrier
  ds_read_b64_tr_b16 a[16:17], v10 offset:0
  v_mfma_f32_16x16x32_bf16 v[36:39], a[52:55], a[32:35], v[36:39]
  ds_read_b64_tr_b16 a[18:19], v10 offset:1024
  v_mfma_f32_16x16x32_bf16 v[52:55], a[52:55], a[36:39], v[52:55]
  ds_read_b128 a[0:3], v6 offset:0
  v_mfma_f32_16x16x32_bf16 v[68:71], a[52:55], a[40:43], v[68:71]
  ds_read_b128 a[4:7], v6 offset:256
  v_mfma_f32_16x16x32_bf16 v[84:87], a[52:55], a[44:47], v[84:87]
  ds_read_b128 a[8:11], v6 offset:512
  v_mfma_f32_16x16x32_bf16 v[40:43], a[56:59], a[32:35], v[40:43]
  ds_read_b128 a[12:15], v6 offset:768
  v_mfma_f32_16x16x32_bf16 v[56:59], a[56:59], a[36:39], v[56:59]
  ds_read_b64_tr_b16 a[20:21], v11 offset:0
  v_mfma_f32_16x16x32_bf16 v[72:75], a[56:59], a[40:43], v[72:75]
  ds_read_b64_tr_b16 a[22:23], v11 offset:1024
  v_mfma_f32_16x16x32_bf16 v[88:91], a[56:59], a[44:47], v[88:91]
  ds_read_b64_tr_b16 a[24:25], v12 offset:0
  v_mfma_f32_16x16x32_bf16 v[44:47], a[60:63], a[32:35], v[44:47]
  ds_read_b64_tr_b16 a[26:27], v12 offset:1024
  v_mfma_f32_16x16x32_bf16 v[60:63], a[60:63], a[36:39], v[60:63]
  ds_read_b64_tr_b16 a[28:29], v13 offset:0
  v_mfma_f32_16x16x32_bf16 v[76:79], a[60:63], a[40:43], v[76:79]
  ds_read_b64_tr_b16 a[30:31], v13 offset:1024
  v_mfma_f32_16x16x32_bf16 v[92:95], a[60:63], a[44:47], v[92:95]
  s_sub_u32 s32, s32, 1
  s_cmp_lg_u32 s32, 0
  s_cbranch_scc1 recurrent_scan__ssm_conv_h3__mixer_s_mlp__prompt_kernel_cm1002
  s_waitcnt lgkmcnt(9)
  v_mfma_f32_16x16x32_bf16 v[32:35], a[16:19], a[0:3], v[32:35]
  ds_read_b64_tr_b16 a[48:49], v10 offset:8192
  buffer_load_dwordx2 v[112:113], v31, s[4:7], s57 offen offset:0 sc1
  s_waitcnt lgkmcnt(9)
  v_mfma_f32_16x16x32_bf16 v[48:51], a[16:19], a[4:7], v[48:51]
  ds_read_b64_tr_b16 a[50:51], v10 offset:9216
  s_waitcnt lgkmcnt(9)
  v_mfma_f32_16x16x32_bf16 v[64:67], a[16:19], a[8:11], v[64:67]
  ds_read_b128 a[32:35], v7 offset:0
  s_waitcnt lgkmcnt(9)
  v_mfma_f32_16x16x32_bf16 v[80:83], a[16:19], a[12:15], v[80:83]
  ds_read_b128 a[36:39], v7 offset:256
  s_waitcnt lgkmcnt(8)
  v_mfma_f32_16x16x32_bf16 v[36:39], a[20:23], a[0:3], v[36:39]
  ds_read_b128 a[40:43], v7 offset:512
  buffer_load_dwordx2 v[114:115], v31, s[4:7], s43 offen offset:0 sc1
  v_mfma_f32_16x16x32_bf16 v[52:55], a[20:23], a[4:7], v[52:55]
  ds_read_b128 a[44:47], v7 offset:768
  v_mfma_f32_16x16x32_bf16 v[68:71], a[20:23], a[8:11], v[68:71]
  ds_read_b64_tr_b16 a[52:53], v11 offset:8192
  v_mfma_f32_16x16x32_bf16 v[84:87], a[20:23], a[12:15], v[84:87]
  ds_read_b64_tr_b16 a[54:55], v11 offset:9216
  s_waitcnt lgkmcnt(10)
  v_mfma_f32_16x16x32_bf16 v[40:43], a[24:27], a[0:3], v[40:43]
  ds_read_b64_tr_b16 a[56:57], v12 offset:8192
  buffer_load_dwordx2 v[116:117], v31, s[4:7], s57 offen offset:256 sc1
  v_mfma_f32_16x16x32_bf16 v[56:59], a[24:27], a[4:7], v[56:59]
  ds_read_b64_tr_b16 a[58:59], v12 offset:9216
  v_mfma_f32_16x16x32_bf16 v[72:75], a[24:27], a[8:11], v[72:75]
  ds_read_b64_tr_b16 a[60:61], v13 offset:8192
  v_mfma_f32_16x16x32_bf16 v[88:91], a[24:27], a[12:15], v[88:91]
  ds_read_b64_tr_b16 a[62:63], v13 offset:9216
  s_waitcnt lgkmcnt(12)
  v_mfma_f32_16x16x32_bf16 v[44:47], a[28:31], a[0:3], v[44:47]
  buffer_load_dwordx2 v[118:119], v31, s[4:7], s43 offen offset:256 sc1
  v_mfma_f32_16x16x32_bf16 v[60:63], a[28:31], a[4:7], v[60:63]
  v_mfma_f32_16x16x32_bf16 v[76:79], a[28:31], a[8:11], v[76:79]
  v_mfma_f32_16x16x32_bf16 v[92:95], a[28:31], a[12:15], v[92:95]
  s_waitcnt lgkmcnt(9)
  v_mfma_f32_16x16x32_bf16 v[32:35], a[48:51], a[32:35], v[32:35]
  buffer_load_dwordx2 v[120:121], v31, s[4:7], s57 offen offset:512 sc1
  s_waitcnt lgkmcnt(8)
  v_mfma_f32_16x16x32_bf16 v[48:51], a[48:51], a[36:39], v[48:51]
  s_waitcnt lgkmcnt(7)
  v_mfma_f32_16x16x32_bf16 v[64:67], a[48:51], a[40:43], v[64:67]
  s_waitcnt lgkmcnt(6)
  v_mfma_f32_16x16x32_bf16 v[80:83], a[48:51], a[44:47], v[80:83]
  s_waitcnt lgkmcnt(0)
  s_barrier
  ds_read_b64_tr_b16 a[16:17], v10 offset:32768
  v_mfma_f32_16x16x32_bf16 v[36:39], a[52:55], a[32:35], v[36:39]
  ds_read_b64_tr_b16 a[18:19], v10 offset:33792
  buffer_load_dwordx2 v[122:123], v31, s[4:7], s43 offen offset:512 sc1
  v_mfma_f32_16x16x32_bf16 v[52:55], a[52:55], a[36:39], v[52:55]
  ds_read_b128 a[0:3], v6 offset:32768
  v_mfma_f32_16x16x32_bf16 v[68:71], a[52:55], a[40:43], v[68:71]
  ds_read_b128 a[4:7], v6 offset:33024
  v_mfma_f32_16x16x32_bf16 v[84:87], a[52:55], a[44:47], v[84:87]
  ds_read_b128 a[8:11], v6 offset:33280
  v_mfma_f32_16x16x32_bf16 v[40:43], a[56:59], a[32:35], v[40:43]
  ds_read_b128 a[12:15], v6 offset:33536
  buffer_load_dwordx2 v[124:125], v31, s[4:7], s57 offen offset:768 sc1
  v_mfma_f32_16x16x32_bf16 v[56:59], a[56:59], a[36:39], v[56:59]
  ds_read_b64_tr_b16 a[20:21], v11 offset:32768
  v_mfma_f32_16x16x32_bf16 v[72:75], a[56:59], a[40:43], v[72:75]
  ds_read_b64_tr_b16 a[22:23], v11 offset:33792
  v_mfma_f32_16x16x32_bf16 v[88:91], a[56:59], a[44:47], v[88:91]
  ds_read_b64_tr_b16 a[24:25], v12 offset:32768
  v_mfma_f32_16x16x32_bf16 v[44:47], a[60:63], a[32:35], v[44:47]
  ds_read_b64_tr_b16 a[26:27], v12 offset:33792
  buffer_load_dwordx2 v[126:127], v31, s[4:7], s43 offen offset:768 sc1
  v_mfma_f32_16x16x32_bf16 v[60:63], a[60:63], a[36:39], v[60:63]
  ds_read_b64_tr_b16 a[28:29], v13 offset:32768
  v_mfma_f32_16x16x32_bf16 v[76:79], a[60:63], a[40:43], v[76:79]
  ds_read_b64_tr_b16 a[30:31], v13 offset:33792
  v_mfma_f32_16x16x32_bf16 v[92:95], a[60:63], a[44:47], v[92:95]
  s_waitcnt lgkmcnt(9)
  v_mfma_f32_16x16x32_bf16 v[32:35], a[16:19], a[0:3], v[32:35]
  ds_read_b64_tr_b16 a[48:49], v10 offset:40960
  s_waitcnt lgkmcnt(9)
  v_mfma_f32_16x16x32_bf16 v[48:51], a[16:19], a[4:7], v[48:51]
  ds_read_b64_tr_b16 a[50:51], v10 offset:41984
  s_waitcnt lgkmcnt(9)
  v_mfma_f32_16x16x32_bf16 v[64:67], a[16:19], a[8:11], v[64:67]
  ds_read_b128 a[32:35], v7 offset:32768
  s_waitcnt lgkmcnt(9)
  v_mfma_f32_16x16x32_bf16 v[80:83], a[16:19], a[12:15], v[80:83]
  ds_read_b128 a[36:39], v7 offset:33024
  s_waitcnt lgkmcnt(8)
  v_mfma_f32_16x16x32_bf16 v[36:39], a[20:23], a[0:3], v[36:39]
  ds_read_b128 a[40:43], v7 offset:33280
  v_mfma_f32_16x16x32_bf16 v[52:55], a[20:23], a[4:7], v[52:55]
  ds_read_b128 a[44:47], v7 offset:33536
  v_mfma_f32_16x16x32_bf16 v[68:71], a[20:23], a[8:11], v[68:71]
  ds_read_b64_tr_b16 a[52:53], v11 offset:40960
  v_mfma_f32_16x16x32_bf16 v[84:87], a[20:23], a[12:15], v[84:87]
  ds_read_b64_tr_b16 a[54:55], v11 offset:41984
  s_waitcnt lgkmcnt(10)
  v_mfma_f32_16x16x32_bf16 v[40:43], a[24:27], a[0:3], v[40:43]
  ds_read_b64_tr_b16 a[56:57], v12 offset:40960
  v_mfma_f32_16x16x32_bf16 v[56:59], a[24:27], a[4:7], v[56:59]
  ds_read_b64_tr_b16 a[58:59], v12 offset:41984
  v_mfma_f32_16x16x32_bf16 v[72:75], a[24:27], a[8:11], v[72:75]
  ds_read_b64_tr_b16 a[60:61], v13 offset:40960
  v_mfma_f32_16x16x32_bf16 v[88:91], a[24:27], a[12:15], v[88:91]
  ds_read_b64_tr_b16 a[62:63], v13 offset:41984
  s_waitcnt lgkmcnt(12)
  v_mfma_f32_16x16x32_bf16 v[44:47], a[28:31], a[0:3], v[44:47]
  v_mfma_f32_16x16x32_bf16 v[60:63], a[28:31], a[4:7], v[60:63]
  v_mfma_f32_16x16x32_bf16 v[76:79], a[28:31], a[8:11], v[76:79]
  v_mfma_f32_16x16x32_bf16 v[92:95], a[28:31], a[12:15], v[92:95]
  s_waitcnt lgkmcnt(9)
  v_mfma_f32_16x16x32_bf16 v[32:35], a[48:51], a[32:35], v[32:35]
  s_waitcnt lgkmcnt(8)
  v_mfma_f32_16x16x32_bf16 v[48:51], a[48:51], a[36:39], v[48:51]
  s_waitcnt lgkmcnt(7)
  v_mfma_f32_16x16x32_bf16 v[64:67], a[48:51], a[40:43], v[64:67]
  s_waitcnt lgkmcnt(6)
  v_mfma_f32_16x16x32_bf16 v[80:83], a[48:51], a[44:47], v[80:83]
  s_waitcnt lgkmcnt(0)
  s_barrier
  ds_read_b64_tr_b16 a[16:17], v14 offset:0
  v_mfma_f32_16x16x32_bf16 v[36:39], a[52:55], a[32:35], v[36:39]
  ds_read_b64_tr_b16 a[18:19], v14 offset:1024
  v_mfma_f32_16x16x32_bf16 v[52:55], a[52:55], a[36:39], v[52:55]
  ds_read_b128 a[0:3], v8 offset:0
  v_mfma_f32_16x16x32_bf16 v[68:71], a[52:55], a[40:43], v[68:71]
  ds_read_b128 a[4:7], v8 offset:256
  v_mfma_f32_16x16x32_bf16 v[84:87], a[52:55], a[44:47], v[84:87]
  ds_read_b128 a[8:11], v8 offset:512
  v_mfma_f32_16x16x32_bf16 v[40:43], a[56:59], a[32:35], v[40:43]
  ds_read_b128 a[12:15], v8 offset:768
  v_mfma_f32_16x16x32_bf16 v[56:59], a[56:59], a[36:39], v[56:59]
  ds_read_b64_tr_b16 a[20:21], v15 offset:0
  v_mfma_f32_16x16x32_bf16 v[72:75], a[56:59], a[40:43], v[72:75]
  ds_read_b64_tr_b16 a[22:23], v15 offset:1024
  v_mfma_f32_16x16x32_bf16 v[88:91], a[56:59], a[44:47], v[88:91]
  ds_read_b64_tr_b16 a[24:25], v16 offset:0
  v_mfma_f32_16x16x32_bf16 v[44:47], a[60:63], a[32:35], v[44:47]
  ds_read_b64_tr_b16 a[26:27], v16 offset:1024
  v_mfma_f32_16x16x32_bf16 v[60:63], a[60:63], a[36:39], v[60:63]
  ds_read_b64_tr_b16 a[28:29], v17 offset:0
  v_mfma_f32_16x16x32_bf16 v[76:79], a[60:63], a[40:43], v[76:79]
  ds_read_b64_tr_b16 a[30:31], v17 offset:1024
  v_mfma_f32_16x16x32_bf16 v[92:95], a[60:63], a[44:47], v[92:95]
  s_waitcnt lgkmcnt(2)
  v_mfma_f32_16x16x32_bf16 v[40:43], a[24:27], a[0:3], v[40:43]
  ds_read_b64_tr_b16 a[56:57], v16 offset:8192
  v_mfma_f32_16x16x32_bf16 v[56:59], a[24:27], a[4:7], v[56:59]
  ds_read_b64_tr_b16 a[58:59], v16 offset:9216
  v_mfma_f32_16x16x32_bf16 v[72:75], a[24:27], a[8:11], v[72:75]
  ds_read_b128 a[32:35], v9 offset:0
  v_mfma_f32_16x16x32_bf16 v[88:91], a[24:27], a[12:15], v[88:91]
  ds_read_b128 a[36:39], v9 offset:256
  s_waitcnt lgkmcnt(4)
  v_mfma_f32_16x16x32_bf16 v[44:47], a[28:31], a[0:3], v[44:47]
  ds_read_b128 a[40:43], v9 offset:512
  v_mfma_f32_16x16x32_bf16 v[60:63], a[28:31], a[4:7], v[60:63]
  ds_read_b128 a[44:47], v9 offset:768
  v_mfma_f32_16x16x32_bf16 v[76:79], a[28:31], a[8:11], v[76:79]
  ds_read_b64_tr_b16 a[60:61], v17 offset:8192
  v_mfma_f32_16x16x32_bf16 v[92:95], a[28:31], a[12:15], v[92:95]
  ds_read_b64_tr_b16 a[62:63], v17 offset:9216
  s_waitcnt lgkmcnt(5)
  v_mfma_f32_16x16x32_bf16 v[40:43], a[56:59], a[32:35], v[40:43]
  s_waitcnt lgkmcnt(0)
  s_barrier
  ds_read_b64_tr_b16 a[24:25], v16 offset:32768
  v_mfma_f32_16x16x32_bf16 v[56:59], a[56:59], a[36:39], v[56:59]
  ds_read_b64_tr_b16 a[26:27], v16 offset:33792
  v_mfma_f32_16x16x32_bf16 v[72:75], a[56:59], a[40:43], v[72:75]
  ds_read_b128 a[0:3], v8 offset:32768
  v_mfma_f32_16x16x32_bf16 v[88:91], a[56:59], a[44:47], v[88:91]
  ds_read_b128 a[4:7], v8 offset:33024
  v_mfma_f32_16x16x32_bf16 v[44:47], a[60:63], a[32:35], v[44:47]
  ds_read_b128 a[8:11], v8 offset:33280
  v_mfma_f32_16x16x32_bf16 v[60:63], a[60:63], a[36:39], v[60:63]
  ds_read_b128 a[12:15], v8 offset:33536
  v_mfma_f32_16x16x32_bf16 v[76:79], a[60:63], a[40:43], v[76:79]
  ds_read_b64_tr_b16 a[28:29], v17 offset:32768
  v_mfma_f32_16x16x32_bf16 v[92:95], a[60:63], a[44:47], v[92:95]
  ds_read_b64_tr_b16 a[30:31], v17 offset:33792
  s_waitcnt lgkmcnt(5)
  v_mfma_f32_16x16x32_bf16 v[40:43], a[24:27], a[0:3], v[40:43]
  ds_read_b64_tr_b16 a[56:57], v16 offset:40960
  s_waitcnt lgkmcnt(5)
  v_mfma_f32_16x16x32_bf16 v[56:59], a[24:27], a[4:7], v[56:59]
  ds_read_b64_tr_b16 a[58:59], v16 offset:41984
  s_waitcnt lgkmcnt(5)
  v_mfma_f32_16x16x32_bf16 v[72:75], a[24:27], a[8:11], v[72:75]
  ds_read_b128 a[32:35], v9 offset:32768
  s_waitcnt lgkmcnt(5)
  v_mfma_f32_16x16x32_bf16 v[88:91], a[24:27], a[12:15], v[88:91]
  ds_read_b128 a[36:39], v9 offset:33024
  s_waitcnt lgkmcnt(4)
  v_mfma_f32_16x16x32_bf16 v[44:47], a[28:31], a[0:3], v[44:47]
  ds_read_b128 a[40:43], v9 offset:33280
  v_mfma_f32_16x16x32_bf16 v[60:63], a[28:31], a[4:7], v[60:63]
  ds_read_b128 a[44:47], v9 offset:33536
  v_mfma_f32_16x16x32_bf16 v[76:79], a[28:31], a[8:11], v[76:79]
  ds_read_b64_tr_b16 a[60:61], v17 offset:40960
  v_mfma_f32_16x16x32_bf16 v[92:95], a[28:31], a[12:15], v[92:95]
  ds_read_b64_tr_b16 a[62:63], v17 offset:41984
  s_waitcnt lgkmcnt(5)
  v_mfma_f32_16x16x32_bf16 v[40:43], a[56:59], a[32:35], v[40:43]
  ds_read_b64_tr_b16 a[16:17], v14 offset:0
  s_waitcnt lgkmcnt(5)
  v_mfma_f32_16x16x32_bf16 v[56:59], a[56:59], a[36:39], v[56:59]
  ds_read_b64_tr_b16 a[18:19], v14 offset:1024
  s_waitcnt lgkmcnt(5)
  v_mfma_f32_16x16x32_bf16 v[72:75], a[56:59], a[40:43], v[72:75]
  ds_read_b128 a[0:3], v8 offset:0
  s_waitcnt lgkmcnt(5)
  v_mfma_f32_16x16x32_bf16 v[88:91], a[56:59], a[44:47], v[88:91]
  ds_read_b128 a[4:7], v8 offset:256
  s_waitcnt lgkmcnt(4)
  v_mfma_f32_16x16x32_bf16 v[44:47], a[60:63], a[32:35], v[44:47]
  ds_read_b128 a[8:11], v8 offset:512
  v_mfma_f32_16x16x32_bf16 v[60:63], a[60:63], a[36:39], v[60:63]
  ds_read_b128 a[12:15], v8 offset:768
  v_mfma_f32_16x16x32_bf16 v[76:79], a[60:63], a[40:43], v[76:79]
  ds_read_b64_tr_b16 a[20:21], v15 offset:0
  v_mfma_f32_16x16x32_bf16 v[92:95], a[60:63], a[44:47], v[92:95]
  ds_read_b64_tr_b16 a[22:23], v15 offset:1024
  s_waitcnt lgkmcnt(5)
  v_mfma_f32_16x16x32_bf16 v[32:35], a[16:19], a[0:3], v[32:35]
  ds_read_b64_tr_b16 a[48:49], v14 offset:8192
  v_cvt_pk_bf16_f32 v40, v40, v41
  s_waitcnt lgkmcnt(5)
  v_mfma_f32_16x16x32_bf16 v[48:51], a[16:19], a[4:7], v[48:51]
  ds_read_b64_tr_b16 a[50:51], v14 offset:9216
  v_cvt_pk_bf16_f32 v41, v42, v43
  s_waitcnt lgkmcnt(5)
  v_mfma_f32_16x16x32_bf16 v[64:67], a[16:19], a[8:11], v[64:67]
  ds_read_b128 a[32:35], v9 offset:0
  v_cvt_pk_bf16_f32 v42, v44, v45
  s_waitcnt lgkmcnt(5)
  v_mfma_f32_16x16x32_bf16 v[80:83], a[16:19], a[12:15], v[80:83]
  ds_read_b128 a[36:39], v9 offset:256
  v_cvt_pk_bf16_f32 v43, v46, v47
  s_waitcnt lgkmcnt(4)
  s_nop 0
  v_mfma_f32_16x16x32_bf16 v[36:39], a[20:23], a[0:3], v[36:39]
  ds_read_b128 a[40:43], v9 offset:512
  buffer_store_dwordx4 v[40:43], v5, s[4:7], s55 offen offset:0 sc1
  v_mfma_f32_16x16x32_bf16 v[52:55], a[20:23], a[4:7], v[52:55]
  ds_read_b128 a[44:47], v9 offset:768
  v_cvt_pk_bf16_f32 v56, v56, v57
  v_mfma_f32_16x16x32_bf16 v[68:71], a[20:23], a[8:11], v[68:71]
  ds_read_b64_tr_b16 a[52:53], v15 offset:8192
  v_cvt_pk_bf16_f32 v57, v58, v59
  v_mfma_f32_16x16x32_bf16 v[84:87], a[20:23], a[12:15], v[84:87]
  ds_read_b64_tr_b16 a[54:55], v15 offset:9216
  v_cvt_pk_bf16_f32 v58, v60, v61
  s_waitcnt lgkmcnt(5)
  v_mfma_f32_16x16x32_bf16 v[32:35], a[48:51], a[32:35], v[32:35]
  ds_read_b64_tr_b16 a[16:17], v14 offset:32768
  v_cvt_pk_bf16_f32 v59, v62, v63
  s_waitcnt lgkmcnt(5)
  v_mfma_f32_16x16x32_bf16 v[48:51], a[48:51], a[36:39], v[48:51]
  ds_read_b64_tr_b16 a[18:19], v14 offset:33792
  buffer_store_dwordx4 v[56:59], v5, s[4:7], s55 offen offset:1024 sc1
  s_waitcnt lgkmcnt(5)
  v_mfma_f32_16x16x32_bf16 v[64:67], a[48:51], a[40:43], v[64:67]
  ds_read_b128 a[0:3], v8 offset:32768
  v_cvt_pk_bf16_f32 v72, v72, v73
  s_waitcnt lgkmcnt(5)
  v_mfma_f32_16x16x32_bf16 v[80:83], a[48:51], a[44:47], v[80:83]
  ds_read_b128 a[4:7], v8 offset:33024
  v_cvt_pk_bf16_f32 v73, v74, v75
  s_waitcnt lgkmcnt(4)
  s_nop 0
  v_mfma_f32_16x16x32_bf16 v[36:39], a[52:55], a[32:35], v[36:39]
  ds_read_b128 a[8:11], v8 offset:33280
  v_cvt_pk_bf16_f32 v74, v76, v77
  v_mfma_f32_16x16x32_bf16 v[52:55], a[52:55], a[36:39], v[52:55]
  ds_read_b128 a[12:15], v8 offset:33536
  v_cvt_pk_bf16_f32 v75, v78, v79
  v_mfma_f32_16x16x32_bf16 v[68:71], a[52:55], a[40:43], v[68:71]
  ds_read_b64_tr_b16 a[20:21], v15 offset:32768
  buffer_store_dwordx4 v[72:75], v5, s[4:7], s55 offen offset:2048 sc1
  v_mfma_f32_16x16x32_bf16 v[84:87], a[52:55], a[44:47], v[84:87]
  ds_read_b64_tr_b16 a[22:23], v15 offset:33792
  v_cvt_pk_bf16_f32 v88, v88, v89
  s_waitcnt lgkmcnt(5)
  v_mfma_f32_16x16x32_bf16 v[32:35], a[16:19], a[0:3], v[32:35]
  ds_read_b64_tr_b16 a[48:49], v14 offset:40960
  v_cvt_pk_bf16_f32 v89, v90, v91
  s_waitcnt lgkmcnt(5)
  v_mfma_f32_16x16x32_bf16 v[48:51], a[16:19], a[4:7], v[48:51]
  ds_read_b64_tr_b16 a[50:51], v14 offset:41984
  v_cvt_pk_bf16_f32 v90, v92, v93
  s_waitcnt lgkmcnt(5)
  v_mfma_f32_16x16x32_bf16 v[64:67], a[16:19], a[8:11], v[64:67]
  ds_read_b128 a[32:35], v9 offset:32768
  v_cvt_pk_bf16_f32 v91, v94, v95
  s_waitcnt lgkmcnt(5)
  v_mfma_f32_16x16x32_bf16 v[80:83], a[16:19], a[12:15], v[80:83]
  ds_read_b128 a[36:39], v9 offset:33024
  buffer_store_dwordx4 v[88:91], v5, s[4:7], s55 offen offset:3072 sc1
  s_waitcnt lgkmcnt(4)
  v_mfma_f32_16x16x32_bf16 v[36:39], a[20:23], a[0:3], v[36:39]
  ds_read_b128 a[40:43], v9 offset:33280
  v_mfma_f32_16x16x32_bf16 v[52:55], a[20:23], a[4:7], v[52:55]
  ds_read_b128 a[44:47], v9 offset:33536
  v_mfma_f32_16x16x32_bf16 v[68:71], a[20:23], a[8:11], v[68:71]
  ds_read_b64_tr_b16 a[52:53], v15 offset:40960
  v_mfma_f32_16x16x32_bf16 v[84:87], a[20:23], a[12:15], v[84:87]
  ds_read_b64_tr_b16 a[54:55], v15 offset:41984
  s_waitcnt lgkmcnt(5)
  v_mfma_f32_16x16x32_bf16 v[32:35], a[48:51], a[32:35], v[32:35]
  s_waitcnt lgkmcnt(4)
  v_mfma_f32_16x16x32_bf16 v[48:51], a[48:51], a[36:39], v[48:51]
  s_waitcnt lgkmcnt(3)
  v_mfma_f32_16x16x32_bf16 v[64:67], a[48:51], a[40:43], v[64:67]
  s_waitcnt lgkmcnt(2)
  v_mfma_f32_16x16x32_bf16 v[80:83], a[48:51], a[44:47], v[80:83]
  s_waitcnt lgkmcnt(0)
  v_mfma_f32_16x16x32_bf16 v[36:39], a[52:55], a[32:35], v[36:39]
  v_mfma_f32_16x16x32_bf16 v[52:55], a[52:55], a[36:39], v[52:55]
  v_mfma_f32_16x16x32_bf16 v[68:71], a[52:55], a[40:43], v[68:71]
  v_mfma_f32_16x16x32_bf16 v[84:87], a[52:55], a[44:47], v[84:87]
  v_mov_b32 v6, v190
  v_mov_b32 v7, v191
  ds_read_b64 v[96:97], v28 offset:0
  ds_read_b64 v[98:99], v29 offset:0
  ds_read_b64 v[100:101], v28 offset:2048
  ds_read_b64 v[102:103], v29 offset:2048
  ds_read_b64 v[104:105], v28 offset:4096
  ds_read_b64 v[106:107], v29 offset:4096
  ds_read_b64 v[108:109], v28 offset:6144
  ds_read_b64 v[110:111], v29 offset:6144
  ds_read_b64_tr_b16 v[128:129], v30 offset:0
  ds_read_b64_tr_b16 v[130:131], v30 offset:4096
  ds_read_b64_tr_b16 v[132:133], v30 offset:32
  ds_read_b64_tr_b16 v[134:135], v30 offset:4128
  ds_read_b64_tr_b16 v[136:137], v30 offset:64
  ds_read_b64_tr_b16 v[138:139], v30 offset:4160
  ds_read_b64_tr_b16 v[140:141], v30 offset:96
  ds_read_b64_tr_b16 v[142:143], v30 offset:4192
  s_waitcnt vmcnt(4) lgkmcnt(8)
  v_lshlrev_b32 v176, 16, v112
  v_and_b32 v177, 0xffff0000, v112
  v_lshlrev_b32 v178, 16, v113
  v_and_b32 v179, 0xffff0000, v113
  v_lshlrev_b32 v180, 16, v114
  v_and_b32 v181, 0xffff0000, v114
  v_lshlrev_b32_e64 v182, 16, v115
  v_and_b32 v183, 0xffff0000, v115
  v_pk_add_f32 v[32:33], v[32:33], v[176:177]
  v_pk_add_f32 v[34:35], v[34:35], v[178:179]
  v_pk_add_f32 v[36:37], v[36:37], v[180:181]
  v_pk_add_f32 v[38:39], v[38:39], v[182:183]
  v_lshlrev_b32 v176, 16, v116
  v_and_b32 v177, 0xffff0000, v116
  v_lshlrev_b32 v178, 16, v117
  v_and_b32 v179, 0xffff0000, v117
  v_lshlrev_b32 v180, 16, v118
  v_and_b32 v181, 0xffff0000, v118
  v_lshlrev_b32 v182, 16, v119
  v_and_b32 v183, 0xffff0000, v119
  v_pk_add_f32 v[48:49], v[48:49], v[176:177]
  v_pk_add_f32 v[50:51], v[50:51], v[178:179]
  v_pk_add_f32 v[52:53], v[52:53], v[180:181]
  v_pk_add_f32 v[54:55], v[54:55], v[182:183]
  v_lshlrev_b32 v176, 16, v120
  v_and_b32 v177, 0xffff0000, v120
  v_lshlrev_b32 v178, 16, v121
  v_and_b32 v179, 0xffff0000, v121
  v_lshlrev_b32 v180, 16, v122
  v_and_b32 v181, 0xffff0000, v122
  v_lshlrev_b32 v182, 16, v123
  v_and_b32 v183, 0xffff0000, v123
  v_pk_add_f32 v[64:65], v[64:65], v[176:177]
  v_pk_add_f32 v[66:67], v[66:67], v[178:179]
  v_pk_add_f32 v[68:69], v[68:69], v[180:181]
  v_pk_add_f32 v[70:71], v[70:71], v[182:183]
  v_lshlrev_b32 v176, 16, v124
  v_and_b32 v177, 0xffff0000, v124
  v_lshlrev_b32 v178, 16, v125
  v_and_b32 v179, 0xffff0000, v125
  v_lshlrev_b32 v180, 16, v126
  v_and_b32 v181, 0xffff0000, v126
  v_lshlrev_b32 v182, 16, v127
  v_and_b32 v183, 0xffff0000, v127
  v_pk_add_f32 v[80:81], v[80:81], v[176:177]
  v_pk_add_f32 v[82:83], v[82:83], v[178:179]
  v_pk_add_f32 v[84:85], v[84:85], v[180:181]
  v_pk_add_f32 v[86:87], v[86:87], v[182:183]
  v_lshlrev_b32 v144, 16, v96
  v_and_b32 v145, 0xffff0000, v96
  v_lshlrev_b32 v146, 16, v97
  v_and_b32 v147, 0xffff0000, v97
  v_lshlrev_b32 v148, 16, v98
  v_and_b32 v149, 0xffff0000, v98
  v_lshlrev_b32 v150, 16, v99
  v_and_b32 v151, 0xffff0000, v99
  v_lshlrev_b32 v152, 16, v100
  v_and_b32 v153, 0xffff0000, v100
  v_lshlrev_b32 v154, 16, v101
  v_and_b32 v155, 0xffff0000, v101
  v_lshlrev_b32 v156, 16, v102
  v_and_b32 v157, 0xffff0000, v102
  v_lshlrev_b32 v158, 16, v103
  v_and_b32 v159, 0xffff0000, v103
  v_lshlrev_b32 v160, 16, v104
  v_and_b32 v161, 0xffff0000, v104
  v_lshlrev_b32 v162, 16, v105
  v_and_b32 v163, 0xffff0000, v105
  v_lshlrev_b32 v164, 16, v106
  v_and_b32 v165, 0xffff0000, v106
  v_lshlrev_b32 v166, 16, v107
  v_and_b32 v167, 0xffff0000, v107
  v_lshlrev_b32 v168, 16, v108
  v_and_b32 v169, 0xffff0000, v108
  v_lshlrev_b32 v170, 16, v109
  v_and_b32 v171, 0xffff0000, v109
  v_lshlrev_b32 v172, 16, v110
  v_and_b32 v173, 0xffff0000, v110
  v_lshlrev_b32 v174, 16, v111
  v_and_b32 v175, 0xffff0000, v111
  v_mov_b32 v3, 1
  v_mov_b32 v4, 0
  s_waitcnt vmcnt(0)
  s_mov_b64 exec, 1
  buffer_store_dword v3, v4, s[4:7], s53 offen sc1
  s_mov_b64 exec, -1
  s_waitcnt lgkmcnt(0)
  v_lshlrev_b32 v176, 16, v128
  v_and_b32 v177, 0xffff0000, v128
  v_lshlrev_b32 v178, 16, v129
  v_and_b32 v179, 0xffff0000, v129
  v_lshlrev_b32 v180, 16, v130
  v_and_b32 v181, 0xffff0000, v130
  v_lshlrev_b32 v182, 16, v131
  v_and_b32 v183, 0xffff0000, v131
  v_pk_fma_f32 v[96:97], v[144:145], v[20:21], v[20:21] op_sel:[0,1,0] op_sel_hi:[1,1,0]
  v_pk_fma_f32 v[98:99], v[146:147], v[20:21], v[20:21] op_sel:[0,1,0] op_sel_hi:[1,1,0]
  v_pk_fma_f32 v[100:101], v[148:149], v[20:21], v[20:21] op_sel:[0,1,0] op_sel_hi:[1,1,0]
  v_pk_fma_f32 v[102:103], v[150:151], v[20:21], v[20:21] op_sel:[0,1,0] op_sel_hi:[1,1,0]
  v_pk_mul_f32 v[96:97], v[96:97], v[176:177]
  v_pk_mul_f32 v[98:99], v[98:99], v[178:179]
  v_pk_mul_f32 v[100:101], v[100:101], v[180:181]
  v_pk_mul_f32 v[102:103], v[102:103], v[182:183]
  v_lshlrev_b32 v176, 16, v132
  v_and_b32 v177, 0xffff0000, v132
  v_lshlrev_b32 v178, 16, v133
  v_and_b32 v179, 0xffff0000, v133
  v_lshlrev_b32 v180, 16, v134
  v_and_b32 v181, 0xffff0000, v134
  v_lshlrev_b32 v182, 16, v135
  v_and_b32 v183, 0xffff0000, v135
  v_pk_fma_f32 v[104:105], v[152:153], v[22:23], v[22:23] op_sel:[0,1,0] op_sel_hi:[1,1,0]
  v_pk_fma_f32 v[106:107], v[154:155], v[22:23], v[22:23] op_sel:[0,1,0] op_sel_hi:[1,1,0]
  v_pk_fma_f32 v[108:109], v[156:157], v[22:23], v[22:23] op_sel:[0,1,0] op_sel_hi:[1,1,0]
  v_pk_fma_f32 v[110:111], v[158:159], v[22:23], v[22:23] op_sel:[0,1,0] op_sel_hi:[1,1,0]
  v_pk_mul_f32 v[104:105], v[104:105], v[176:177]
  v_pk_mul_f32 v[106:107], v[106:107], v[178:179]
  v_pk_mul_f32 v[108:109], v[108:109], v[180:181]
  v_pk_mul_f32 v[110:111], v[110:111], v[182:183]
  v_lshlrev_b32 v176, 16, v136
  v_and_b32 v177, 0xffff0000, v136
  v_lshlrev_b32 v178, 16, v137
  v_and_b32 v179, 0xffff0000, v137
  v_lshlrev_b32 v180, 16, v138
  v_and_b32 v181, 0xffff0000, v138
  v_lshlrev_b32 v182, 16, v139
  v_and_b32 v183, 0xffff0000, v139
  v_pk_fma_f32 v[112:113], v[160:161], v[24:25], v[24:25] op_sel:[0,1,0] op_sel_hi:[1,1,0]
  v_pk_fma_f32 v[114:115], v[162:163], v[24:25], v[24:25] op_sel:[0,1,0] op_sel_hi:[1,1,0]
  v_pk_fma_f32 v[116:117], v[164:165], v[24:25], v[24:25] op_sel:[0,1,0] op_sel_hi:[1,1,0]
  v_pk_fma_f32 v[118:119], v[166:167], v[24:25], v[24:25] op_sel:[0,1,0] op_sel_hi:[1,1,0]
  v_pk_mul_f32 v[112:113], v[112:113], v[176:177]
  v_pk_mul_f32 v[114:115], v[114:115], v[178:179]
  v_pk_mul_f32 v[116:117], v[116:117], v[180:181]
  v_pk_mul_f32 v[118:119], v[118:119], v[182:183]
  v_lshlrev_b32 v176, 16, v140
  v_and_b32 v177, 0xffff0000, v140
  v_lshlrev_b32 v178, 16, v141
  v_and_b32 v179, 0xffff0000, v141
  v_lshlrev_b32 v180, 16, v142
  v_and_b32 v181, 0xffff0000, v142
  v_lshlrev_b32 v182, 16, v143
  v_and_b32 v183, 0xffff0000, v143
  v_pk_fma_f32 v[120:121], v[168:169], v[26:27], v[26:27] op_sel:[0,1,0] op_sel_hi:[1,1,0]
  v_pk_fma_f32 v[122:123], v[170:171], v[26:27], v[26:27] op_sel:[0,1,0] op_sel_hi:[1,1,0]
  v_pk_fma_f32 v[124:125], v[172:173], v[26:27], v[26:27] op_sel:[0,1,0] op_sel_hi:[1,1,0]
  v_pk_fma_f32 v[126:127], v[174:175], v[26:27], v[26:27] op_sel:[0,1,0] op_sel_hi:[1,1,0]
  v_pk_mul_f32 v[120:121], v[120:121], v[176:177]
  v_pk_mul_f32 v[122:123], v[122:123], v[178:179]
  v_pk_mul_f32 v[124:125], v[124:125], v[180:181]
  v_pk_mul_f32 v[126:127], v[126:127], v[182:183]
k4_poll:
  buffer_load_dword v3, v4, s[4:7], s54 offen sc1
  s_waitcnt vmcnt(0)
  v_readfirstlane_b32 s51, v3
  s_nop 0
  s_cmp_eq_u32 s51, 1
  s_cbranch_scc1 k4_ready
  s_sleep 1
  s_add_u32 s101, s101, 1
  s_cmp_lt_u32 s101, 0x40000
  s_cbranch_scc1 k4_poll
k4_ready:
  buffer_load_dwordx4 v[40:43], v5, s[4:7], s56 offen offset:0 sc1
  buffer_load_dwordx4 v[56:59], v5, s[4:7], s56 offen offset:1024 sc1
  buffer_load_dwordx4 v[72:75], v5, s[4:7], s56 offen offset:2048 sc1
  buffer_load_dwordx4 v[88:91], v5, s[4:7], s56 offen offset:3072 sc1
  s_waitcnt vmcnt(3)
  v_lshlrev_b32 v176, 16, v40
  v_and_b32 v177, 0xffff0000, v40
  v_lshlrev_b32 v178, 16, v41
  v_and_b32 v179, 0xffff0000, v41
  v_lshlrev_b32 v180, 16, v42
  v_and_b32 v181, 0xffff0000, v42
  v_lshlrev_b32_e64 v182, 16, v43
  v_and_b32 v183, 0xffff0000, v43
  v_pk_add_f32 v[32:33], v[32:33], v[176:177]
  v_pk_add_f32 v[34:35], v[34:35], v[178:179]
  v_pk_add_f32 v[36:37], v[36:37], v[180:181]
  v_pk_add_f32 v[38:39], v[38:39], v[182:183]
  v_pk_mul_f32 v[176:177], v[32:33], s[44:45]
  v_pk_mul_f32 v[178:179], v[34:35], s[44:45]
  v_pk_mul_f32 v[180:181], v[36:37], s[44:45]
  v_pk_mul_f32 v[182:183], v[38:39], s[44:45]
  v_exp_f32 v176, v176
  v_exp_f32 v177, v177
  v_exp_f32 v178, v178
  v_exp_f32 v179, v179
  v_exp_f32 v180, v180
  v_exp_f32 v181, v181
  v_exp_f32 v182, v182
  v_exp_f32 v183, v183
  v_pk_mul_f32 v[32:33], v[32:33], v[96:97]
  v_pk_mul_f32 v[34:35], v[34:35], v[98:99]
  v_pk_mul_f32 v[36:37], v[36:37], v[100:101]
  v_pk_mul_f32 v[38:39], v[38:39], v[102:103]
  v_pk_add_f32 v[176:177], v[176:177], s[48:49]
  v_pk_add_f32 v[178:179], v[178:179], s[48:49]
  v_pk_add_f32 v[180:181], v[180:181], s[48:49]
  v_pk_add_f32 v[182:183], v[182:183], s[48:49]
  v_rcp_f32 v176, v176
  v_rcp_f32 v177, v177
  v_rcp_f32 v178, v178
  v_rcp_f32 v179, v179
  v_rcp_f32 v180, v180
  v_rcp_f32 v181, v181
  v_rcp_f32 v182, v182
  v_rcp_f32 v183, v183
  v_pk_fma_f32 v[176:177], v[176:177], v[32:33], v[144:145]
  v_pk_fma_f32 v[178:179], v[178:179], v[34:35], v[146:147]
  v_pk_fma_f32 v[180:181], v[180:181], v[36:37], v[148:149]
  v_pk_fma_f32 v[182:183], v[182:183], v[38:39], v[150:151]
  v_cvt_pk_bf16_f32 v128, v176, v177
  v_cvt_pk_bf16_f32 v129, v178, v179
  v_cvt_pk_bf16_f32 v130, v180, v181
  v_cvt_pk_bf16_f32 v131, v182, v183
  s_nop 0
  v_permlane16_swap_b32 v128, v130
  v_permlane16_swap_b32 v129, v131
  ds_write_b128 v6, v[128:131] offset:0
  ds_read_b128 v[44:47], v7 offset:0
  s_waitcnt vmcnt(2)
  v_lshlrev_b32 v184, 16, v56
  v_and_b32 v185, 0xffff0000, v56
  v_lshlrev_b32 v186, 16, v57
  v_and_b32 v187, 0xffff0000, v57
  v_lshlrev_b32 v188, 16, v58
  v_and_b32 v189, 0xffff0000, v58
  v_lshlrev_b32 v190, 16, v59
  v_and_b32 v191, 0xffff0000, v59
  v_pk_add_f32 v[48:49], v[48:49], v[184:185]
  v_pk_add_f32 v[50:51], v[50:51], v[186:187]
  v_pk_add_f32 v[52:53], v[52:53], v[188:189]
  v_pk_add_f32 v[54:55], v[54:55], v[190:191]
  v_pk_mul_f32 v[184:185], v[48:49], s[44:45]
  v_pk_mul_f32 v[186:187], v[50:51], s[44:45]
  v_pk_mul_f32 v[188:189], v[52:53], s[44:45]
  v_pk_mul_f32 v[190:191], v[54:55], s[44:45]
  v_exp_f32 v184, v184
  v_exp_f32 v185, v185
  v_exp_f32 v186, v186
  v_exp_f32 v187, v187
  v_exp_f32 v188, v188
  v_exp_f32 v189, v189
  v_exp_f32 v190, v190
  v_exp_f32 v191, v191
  v_pk_mul_f32 v[48:49], v[48:49], v[104:105]
  v_pk_mul_f32 v[50:51], v[50:51], v[106:107]
  v_pk_mul_f32 v[52:53], v[52:53], v[108:109]
  v_pk_mul_f32 v[54:55], v[54:55], v[110:111]
  v_pk_add_f32 v[184:185], v[184:185], s[48:49]
  v_pk_add_f32 v[186:187], v[186:187], s[48:49]
  v_pk_add_f32 v[188:189], v[188:189], s[48:49]
  v_pk_add_f32 v[190:191], v[190:191], s[48:49]
  v_rcp_f32 v184, v184
  v_rcp_f32 v185, v185
  v_rcp_f32 v186, v186
  v_rcp_f32 v187, v187
  v_rcp_f32 v188, v188
  v_rcp_f32 v189, v189
  v_rcp_f32 v190, v190
  v_rcp_f32 v191, v191
  v_pk_fma_f32 v[184:185], v[184:185], v[48:49], v[152:153]
  v_pk_fma_f32 v[186:187], v[186:187], v[50:51], v[154:155]
  v_pk_fma_f32 v[188:189], v[188:189], v[52:53], v[156:157]
  v_pk_fma_f32 v[190:191], v[190:191], v[54:55], v[158:159]
  v_cvt_pk_bf16_f32 v132, v184, v185
  v_cvt_pk_bf16_f32 v133, v186, v187
  v_cvt_pk_bf16_f32 v134, v188, v189
  v_cvt_pk_bf16_f32 v135, v190, v191
  s_nop 0
  v_permlane16_swap_b32 v132, v134
  v_permlane16_swap_b32 v133, v135
  s_waitcnt lgkmcnt(0)
  s_add_u32 s51, s50, 0
  buffer_store_dwordx4 v[44:47], v18, s[20:23], s51 offen sc1 nt
  ds_write_b128 v6, v[132:135] offset:1024
  ds_read_b128 v[60:63], v7 offset:1024
  s_waitcnt vmcnt(2)
  v_lshlrev_b32 v176, 16, v72
  v_and_b32 v177, 0xffff0000, v72
  v_lshlrev_b32 v178, 16, v73
  v_and_b32 v179, 0xffff0000, v73
  v_lshlrev_b32 v180, 16, v74
  v_and_b32 v181, 0xffff0000, v74
  v_lshlrev_b32 v182, 16, v75
  v_and_b32 v183, 0xffff0000, v75
  v_pk_add_f32 v[64:65], v[64:65], v[176:177]
  v_pk_add_f32 v[66:67], v[66:67], v[178:179]
  v_pk_add_f32 v[68:69], v[68:69], v[180:181]
  v_pk_add_f32 v[70:71], v[70:71], v[182:183]
  v_pk_mul_f32 v[176:177], v[64:65], s[44:45]
  v_pk_mul_f32 v[178:179], v[66:67], s[44:45]
  v_pk_mul_f32 v[180:181], v[68:69], s[44:45]
  v_pk_mul_f32 v[182:183], v[70:71], s[44:45]
  v_exp_f32 v176, v176
  v_exp_f32 v177, v177
  v_exp_f32 v178, v178
  v_exp_f32 v179, v179
  v_exp_f32 v180, v180
  v_exp_f32 v181, v181
  v_exp_f32 v182, v182
  v_exp_f32 v183, v183
  v_pk_mul_f32 v[64:65], v[64:65], v[112:113]
  v_pk_mul_f32 v[66:67], v[66:67], v[114:115]
  v_pk_mul_f32 v[68:69], v[68:69], v[116:117]
  v_pk_mul_f32 v[70:71], v[70:71], v[118:119]
  v_pk_add_f32 v[176:177], v[176:177], s[48:49]
  v_pk_add_f32 v[178:179], v[178:179], s[48:49]
  v_pk_add_f32 v[180:181], v[180:181], s[48:49]
  v_pk_add_f32 v[182:183], v[182:183], s[48:49]
  v_rcp_f32 v176, v176
  v_rcp_f32 v177, v177
  v_rcp_f32 v178, v178
  v_rcp_f32 v179, v179
  v_rcp_f32 v180, v180
  v_rcp_f32 v181, v181
  v_rcp_f32 v182, v182
  v_rcp_f32 v183, v183
  v_pk_fma_f32 v[176:177], v[176:177], v[64:65], v[160:161]
  v_pk_fma_f32 v[178:179], v[178:179], v[66:67], v[162:163]
  v_pk_fma_f32 v[180:181], v[180:181], v[68:69], v[164:165]
  v_pk_fma_f32 v[182:183], v[182:183], v[70:71], v[166:167]
  v_cvt_pk_bf16_f32 v136, v176, v177
  v_cvt_pk_bf16_f32 v137, v178, v179
  v_cvt_pk_bf16_f32 v138, v180, v181
  v_cvt_pk_bf16_f32 v139, v182, v183
  s_nop 0
  v_permlane16_swap_b32 v136, v138
  v_permlane16_swap_b32 v137, v139
  s_waitcnt lgkmcnt(0)
  s_add_u32 s51, s50, 32768
  buffer_store_dwordx4 v[60:63], v18, s[20:23], s51 offen sc1 nt
  ds_write_b128 v6, v[136:139] offset:2048
  ds_read_b128 v[76:79], v7 offset:2048
  s_waitcnt vmcnt(2)
  v_lshlrev_b32 v184, 16, v88
  v_and_b32 v185, 0xffff0000, v88
  v_lshlrev_b32 v186, 16, v89
  v_and_b32 v187, 0xffff0000, v89
  v_lshlrev_b32 v188, 16, v90
  v_and_b32 v189, 0xffff0000, v90
  v_lshlrev_b32_e64 v190, 16, v91
  v_and_b32 v191, 0xffff0000, v91
  v_pk_add_f32 v[80:81], v[80:81], v[184:185]
  v_pk_add_f32 v[82:83], v[82:83], v[186:187]
  v_pk_add_f32 v[84:85], v[84:85], v[188:189]
  v_pk_add_f32 v[86:87], v[86:87], v[190:191]
  v_pk_mul_f32 v[184:185], v[80:81], s[44:45]
  v_pk_mul_f32 v[186:187], v[82:83], s[44:45]
  v_pk_mul_f32 v[188:189], v[84:85], s[44:45]
  v_pk_mul_f32 v[190:191], v[86:87], s[44:45]
  v_exp_f32 v184, v184
  v_exp_f32 v185, v185
  v_exp_f32 v186, v186
  v_exp_f32 v187, v187
  v_exp_f32 v188, v188
  v_exp_f32 v189, v189
  v_exp_f32 v190, v190
  v_exp_f32 v191, v191
  v_pk_mul_f32 v[80:81], v[80:81], v[120:121]
  v_pk_mul_f32 v[82:83], v[82:83], v[122:123]
  v_pk_mul_f32 v[84:85], v[84:85], v[124:125]
  v_pk_mul_f32 v[86:87], v[86:87], v[126:127]
  v_pk_add_f32 v[184:185], v[184:185], s[48:49]
  v_pk_add_f32 v[186:187], v[186:187], s[48:49]
  v_pk_add_f32 v[188:189], v[188:189], s[48:49]
  v_pk_add_f32 v[190:191], v[190:191], s[48:49]
  v_rcp_f32 v184, v184
  v_rcp_f32 v185, v185
  v_rcp_f32 v186, v186
  v_rcp_f32 v187, v187
  v_rcp_f32 v188, v188
  v_rcp_f32 v189, v189
  v_rcp_f32 v190, v190
  v_rcp_f32 v191, v191
  v_pk_fma_f32 v[184:185], v[184:185], v[80:81], v[168:169]
  v_pk_fma_f32 v[186:187], v[186:187], v[82:83], v[170:171]
  v_pk_fma_f32 v[188:189], v[188:189], v[84:85], v[172:173]
  v_pk_fma_f32 v[190:191], v[190:191], v[86:87], v[174:175]
  v_cvt_pk_bf16_f32 v140, v184, v185
  v_cvt_pk_bf16_f32 v141, v186, v187
  v_cvt_pk_bf16_f32 v142, v188, v189
  v_cvt_pk_bf16_f32 v143, v190, v191
  s_nop 0
  v_permlane16_swap_b32 v140, v142
  v_permlane16_swap_b32 v141, v143
  s_waitcnt lgkmcnt(0)
  s_add_u32 s51, s50, 65536
  buffer_store_dwordx4 v[76:79], v18, s[20:23], s51 offen sc1 nt
  ds_write_b128 v6, v[140:143] offset:3072
  ds_read_b128 v[92:95], v7 offset:3072
  s_waitcnt lgkmcnt(0)
  s_add_u32 s51, s50, 98304
  buffer_store_dwordx4 v[92:95], v18, s[20:23], s51 offen sc1 nt
  s_endpgm
k1_prep:
  s_load_dwordx2 s[16:17], s[0:1], 8
  s_mov_b32 s18, 4194304
  s_mov_b32 s19, 0x20000
  s_load_dwordx2 s[20:21], s[0:1], 16
  s_mov_b32 s22, 4194304
  s_mov_b32 s23, 0x20000
  s_load_dwordx2 s[24:25], s[0:1], 24
  s_mov_b32 s26, 8192
  s_mov_b32 s27, 0x20000
  s_load_dwordx2 s[84:85], s[0:1], 64
  s_mov_b32 s86, 2097152
  s_mov_b32 s87, 0x20000
  s_load_dwordx2 s[88:89], s[0:1], 32
  s_mov_b32 s90, 4194304
  s_mov_b32 s91, 0x20000
  s_load_dwordx2 s[80:81], s[0:1], 72
  s_mov_b32 s82, 7340032
  s_mov_b32 s83, 0x20000
  s_lshl_b32 s57, s29, 3
  s_add_u32 s57, s57, s28
  s_lshl_b32 s58, s57, 3
  s_add_u32 s58, s58, s33
  s_lshl_b32 s51, s58, 12
  s_lshr_b32 s59, s29, 1
  s_lshl_b32 s94, s59, 3
  s_add_u32 s94, s94, s33
  v_lshlrev_b32 v12, 4, v1
  s_lshr_b32 s34, s57, 2
  s_and_b32 s35, s57, 3
  v_and_b32 v2, 31, v0
  v_lshrrev_b32 v3, 5, v0
  s_lshl_b32 s36, s34, 17
  s_lshl_b32 s37, s35, 9
  s_add_u32 s36, s36, s37
  v_lshlrev_b32 v4, 13, v3
  v_lshl_add_u32 v4, v2, 4, v4
  v_add_u32 v6, s36, v4
  v_add_u32 v9, 4096, v6
  v_lshrrev_b32 v4, 5, v1
  v_lshlrev_b32 v4, 11, v4
  v_lshl_add_u32 v4, v2, 4, v4
  v_add_u32 v8, s36, v4
  s_lshl_b32 s37, s33, 14
  v_add_u32 v7, s37, v8
  s_lshl_b32 s37, s33, 12
  s_sub_u32 s37, s37, 8192
  v_add_u32 v8, s37, v8
  s_lshl_b32 s38, s35, 11
  s_lshl_b32 s39, s33, 10
  s_add_u32 s38, s38, s39
  s_sub_u32 s38, s38, 2048
  s_mov_b32 s40, 3072
  s_mov_b32 s41, 6144
  s_mov_b32 s42, 9216
  s_bitcmp1_b32 s29, 0
  s_cbranch_scc1 k1_classB
  s_lshl_b32 s50, s28, 6
  s_add_u32 s50, s50, s94
  s_lshl_b32 s95, s50, 13
  s_add_u32 s96, s95, 4096
  s_and_b32 s92, s28, 6
  s_lshr_b32 s53, s59, 2
  s_add_u32 s92, s92, s53
  s_and_b32 s93, s28, 1
  s_lshl_b32 s93, s93, 2
  s_and_b32 s53, s59, 3
  s_add_u32 s93, s93, s53
  s_lshl_b32 s52, s92, 18
  s_lshl_b32 s53, s33, 15
  s_add_u32 s52, s52, s53
  s_lshl_b32 s53, s93, 8
  s_add_u32 s52, s52, s53
  v_lshrrev_b32 v13, 4, v1
  v_and_b32 v14, 15, v1
  v_lshlrev_b32 v15, 4, v14
  v_lshl_add_u32 v15, v13, 11, v15
  s_waitcnt lgkmcnt(0)
  buffer_load_dwordx4 v[16:19], v12, s[8:11], s95 offen offset:0
  buffer_load_dwordx4 v[20:23], v12, s[8:11], s95 offen offset:1024
  buffer_load_dwordx4 v[24:27], v12, s[8:11], s95 offen offset:2048
  buffer_load_dwordx4 v[28:31], v12, s[8:11], s95 offen offset:3072
  buffer_load_dwordx4 v[32:35], v12, s[8:11], s96 offen offset:0
  buffer_load_dwordx4 v[36:39], v12, s[8:11], s96 offen offset:1024
  buffer_load_dwordx4 v[40:43], v12, s[8:11], s96 offen offset:2048
  buffer_load_dwordx4 v[44:47], v12, s[8:11], s96 offen offset:3072
  buffer_load_dwordx4 v[48:51], v15, s[12:15], s52 offen
  s_add_u32 s52, s52, 8192
  buffer_load_dwordx4 v[52:55], v15, s[12:15], s52 offen
  s_add_u32 s52, s52, 8192
  buffer_load_dwordx4 v[56:59], v15, s[12:15], s52 offen
  s_add_u32 s52, s52, 8192
  buffer_load_dwordx4 v[60:63], v15, s[12:15], s52 offen
  s_barrier
  s_lshl_b32 s37, s33, 12
  s_add_u32 m0, s37, 43008
  s_nop 0
  buffer_load_dwordx4 v7, s[16:19], 0 offen offset:0 nt lds
  buffer_load_dwordx4 v7, s[16:19], s40 offen offset:1024 nt lds
  buffer_load_dwordx4 v7, s[16:19], s41 offen offset:2048 nt lds
  buffer_load_dwordx4 v7, s[16:19], s42 offen offset:3072 nt lds
  buffer_load_dwordx4 v[108:111], v6, s[20:23], 0 offen offset:0 nt
  buffer_load_dwordx4 v[112:115], v6, s[20:23], 0 offen offset:2048 nt
  buffer_load_dwordx4 v[116:119], v9, s[20:23], 0 offen offset:0 nt
  buffer_load_dwordx4 v[120:123], v9, s[20:23], 0 offen offset:2048 nt
  s_cmp_ge_u32 s33, 4
  s_cbranch_scc1 recurrent_scan__ssm_conv_h3__mixer_s_mlp__prompt_kernel_b5
  s_cmp_ge_u32 s33, 2
  s_cbranch_scc1 recurrent_scan__ssm_conv_h3__mixer_s_mlp__prompt_kernel_b4
  s_add_u32 m0, s39, 40960
  s_nop 0
  buffer_load_dwordx4 v8, s[16:19], 0 offen lds
  s_branch recurrent_scan__ssm_conv_h3__mixer_s_mlp__prompt_kernel_b5
recurrent_scan__ssm_conv_h3__mixer_s_mlp__prompt_kernel_b4:
  s_add_u32 m0, s39, 73728
  s_nop 0
  buffer_load_dwordx4 v12, s[24:27], s38 offen lds
recurrent_scan__ssm_conv_h3__mixer_s_mlp__prompt_kernel_b5:
  s_mov_b32 s44, 0x3f803f80
  s_mov_b32 s45, 0x00003f80
  s_mov_b32 s46, 0x3f800000
  v_mov_b32 v64, 0
  v_mov_b32 v65, 0
  v_mov_b32 v66, 0
  v_mov_b32 v67, 0
  v_mov_b32 v68, 0
  v_mov_b32 v69, 0
  v_mov_b32 v70, 0
  v_mov_b32 v71, 0
  v_mov_b32 v72, 0
  v_mov_b32 v73, 0
  v_mov_b32 v74, 0
  v_mov_b32 v75, 0
  v_mov_b32 v76, 0
  v_mov_b32 v77, 0
  v_mov_b32 v78, 0
  v_mov_b32 v79, 0
  v_lshlrev_b32 v13, 3, v13
  v_lshl_add_u32 v14, v14, 5, v13
  s_lshl_b32 s36, s33, 9
  v_add_u32 v14, s36, v14
  s_lshl_b32 s50, s50, 5
  s_add_u32 s55, s50, 36700160
  s_add_u32 s50, s50, 36732928
  s_lshl_b32 s52, s92, 12
  s_lshl_b32 s53, s93, 9
  s_add_u32 s52, s52, s53
  s_add_u32 s52, s52, 37224448
  s_waitcnt vmcnt(12)
  v_dot2c_f32_bf16 v64, s44, v16
  v_dot2c_f32_bf16 v65, v16, v16
  v_dot2c_f32_bf16 v66, s44, v24
  v_dot2c_f32_bf16 v67, v24, v24
  v_dot2c_f32_bf16 v68, s44, v32
  v_dot2c_f32_bf16 v69, v32, v32
  v_dot2c_f32_bf16 v70, s44, v40
  v_dot2c_f32_bf16 v71, v40, v40
  v_dot2c_f32_bf16 v64, s44, v17
  v_dot2c_f32_bf16 v65, v17, v17
  v_dot2c_f32_bf16 v66, s44, v25
  v_dot2c_f32_bf16 v67, v25, v25
  v_dot2c_f32_bf16 v68, s44, v33
  v_dot2c_f32_bf16 v69, v33, v33
  v_dot2c_f32_bf16 v70, s44, v41
  v_dot2c_f32_bf16 v71, v41, v41
  v_dot2c_f32_bf16 v64, s44, v18
  v_dot2c_f32_bf16 v65, v18, v18
  v_dot2c_f32_bf16 v66, s44, v26
  v_dot2c_f32_bf16 v67, v26, v26
  v_dot2c_f32_bf16 v68, s44, v34
  v_dot2c_f32_bf16 v69, v34, v34
  v_dot2c_f32_bf16 v70, s44, v42
  v_dot2c_f32_bf16 v71, v42, v42
  v_dot2c_f32_bf16 v64, s44, v19
  v_dot2c_f32_bf16 v65, v19, v19
  v_dot2c_f32_bf16 v66, s44, v27
  v_dot2c_f32_bf16 v67, v27, v27
  v_dot2c_f32_bf16 v68, s44, v35
  v_dot2c_f32_bf16 v69, v35, v35
  v_dot2c_f32_bf16 v70, s44, v43
  v_dot2c_f32_bf16 v71, v43, v43
  v_dot2c_f32_bf16 v64, s44, v20
  v_dot2c_f32_bf16 v65, v20, v20
  v_dot2c_f32_bf16 v66, s44, v28
  v_dot2c_f32_bf16 v67, v28, v28
  v_dot2c_f32_bf16 v68, s44, v36
  v_dot2c_f32_bf16 v69, v36, v36
  v_dot2c_f32_bf16 v70, s44, v44
  v_dot2c_f32_bf16 v71, v44, v44
  v_dot2c_f32_bf16 v64, s44, v21
  v_dot2c_f32_bf16 v65, v21, v21
  v_dot2c_f32_bf16 v66, s44, v29
  v_dot2c_f32_bf16 v67, v29, v29
  v_dot2c_f32_bf16 v68, s44, v37
  v_dot2c_f32_bf16 v69, v37, v37
  v_dot2c_f32_bf16 v70, s44, v45
  v_dot2c_f32_bf16 v71, v45, v45
  v_dot2c_f32_bf16 v64, s44, v22
  v_dot2c_f32_bf16 v65, v22, v22
  v_dot2c_f32_bf16 v66, s44, v30
  v_dot2c_f32_bf16 v67, v30, v30
  v_dot2c_f32_bf16 v68, s44, v38
  v_dot2c_f32_bf16 v69, v38, v38
  v_dot2c_f32_bf16 v70, s44, v46
  v_dot2c_f32_bf16 v71, v46, v46
  v_dot2c_f32_bf16 v64, s44, v23
  v_dot2c_f32_bf16 v65, v23, v23
  v_dot2c_f32_bf16 v66, s44, v31
  v_dot2c_f32_bf16 v67, v31, v31
  v_dot2c_f32_bf16 v68, s44, v39
  v_dot2c_f32_bf16 v69, v39, v39
  v_dot2c_f32_bf16 v70, s44, v47
  v_dot2c_f32_bf16 v71, v47, v47
  s_waitcnt vmcnt(8)
  v_dot2c_f32_bf16 v72, s45, v48
  v_dot2c_f32_bf16 v73, s46, v48
  v_dot2c_f32_bf16 v74, s45, v49
  v_dot2c_f32_bf16 v75, s46, v49
  v_dot2c_f32_bf16 v76, s45, v50
  v_dot2c_f32_bf16 v77, s46, v50
  v_dot2c_f32_bf16 v78, s45, v51
  v_dot2c_f32_bf16 v79, s46, v51
  v_dot2c_f32_bf16 v72, s45, v52
  v_dot2c_f32_bf16 v73, s46, v52
  v_dot2c_f32_bf16 v74, s45, v53
  v_dot2c_f32_bf16 v75, s46, v53
  v_dot2c_f32_bf16 v76, s45, v54
  v_dot2c_f32_bf16 v77, s46, v54
  v_dot2c_f32_bf16 v78, s45, v55
  v_dot2c_f32_bf16 v79, s46, v55
  v_dot2c_f32_bf16 v72, s45, v56
  v_dot2c_f32_bf16 v73, s46, v56
  v_dot2c_f32_bf16 v74, s45, v57
  v_dot2c_f32_bf16 v75, s46, v57
  v_dot2c_f32_bf16 v76, s45, v58
  v_dot2c_f32_bf16 v77, s46, v58
  v_dot2c_f32_bf16 v78, s45, v59
  v_dot2c_f32_bf16 v79, s46, v59
  v_dot2c_f32_bf16 v72, s45, v60
  v_dot2c_f32_bf16 v73, s46, v60
  v_dot2c_f32_bf16 v74, s45, v61
  v_dot2c_f32_bf16 v75, s46, v61
  v_dot2c_f32_bf16 v76, s45, v62
  v_dot2c_f32_bf16 v77, s46, v62
  v_dot2c_f32_bf16 v78, s45, v63
  v_dot2c_f32_bf16 v79, s46, v63
  v_permlane32_swap_b32 v72, v76
  v_permlane32_swap_b32 v73, v77
  v_permlane32_swap_b32 v74, v78
  v_permlane32_swap_b32 v75, v79
  v_add_f32 v72, v72, v76
  v_add_f32 v73, v73, v77
  v_add_f32 v74, v74, v78
  v_add_f32 v75, v75, v79
  s_nop 0
  v_permlane16_swap_b32 v72, v74
  v_permlane16_swap_b32 v73, v75
  v_add_f32 v72, v72, v74
  v_add_f32 v73, v73, v75
  ds_write_b64 v14, v[72:73] offset:36864
  v_permlane32_swap_b32 v64, v68
  v_permlane32_swap_b32 v65, v69
  v_permlane32_swap_b32 v66, v70
  v_permlane32_swap_b32 v67, v71
  v_add_f32 v64, v64, v68
  v_add_f32 v65, v65, v69
  v_add_f32 v66, v66, v70
  v_add_f32 v67, v67, v71
  s_nop 0
  v_permlane16_swap_b32 v64, v66
  v_permlane16_swap_b32 v65, v67
  v_add_f32 v64, v64, v66
  v_add_f32 v65, v65, v67
  s_nop 0
  v_add_f32_dpp v64, v64, v64 row_ror:8 row_mask:0xf bank_mask:0xf
  v_add_f32_dpp v65, v65, v65 row_ror:8 row_mask:0xf bank_mask:0xf
  s_nop 0
  v_add_f32_dpp v64, v64, v64 row_ror:4 row_mask:0xf bank_mask:0xf
  v_add_f32_dpp v65, v65, v65 row_ror:4 row_mask:0xf bank_mask:0xf
  s_nop 0
  v_add_f32_dpp v64, v64, v64 row_ror:2 row_mask:0xf bank_mask:0xf
  v_add_f32_dpp v65, v65, v65 row_ror:2 row_mask:0xf bank_mask:0xf
  s_nop 0
  s_nop 0
  v_add_f32_dpp v64, v64, v64 row_ror:1 row_mask:0xf bank_mask:0xf
  v_add_f32_dpp v65, v65, v65 row_ror:1 row_mask:0xf bank_mask:0xf
  v_mul_f32 v64, 0x3a800000, v64
  v_mul_f32 v65, 0x3a800000, v65
  v_fma_f32 v65, -v64, v64, v65
  v_max_f32_e64 v65, 0, v65
  v_cvt_pk_bf16_f32 v68, v64, v64
  v_and_b32 v68, 0xffff0000, v68
  v_cvt_pk_bf16_f32 v66, v65, v65
  v_and_b32 v66, 0xffff0000, v66
  v_add_f32 v66, 0x3727c5ac, v66
  v_cvt_pk_bf16_f32 v66, v66, v66
  v_and_b32 v66, 0xffff0000, v66
  v_sqrt_f32 v66, v66
  s_nop 0
  v_cvt_pk_bf16_f32 v66, v66, v66
  v_and_b32 v66, 0xffff0000, v66
  v_rcp_f32 v69, v66
  v_sub_f32 v64, v64, v68
  v_mul_f32 v64, v64, v69
  v_mul_f32 v65, v65, v69
  v_mul_f32_e64 v65, v65, v69
  v_cvt_pk_bf16_f32 v64, v64, v64
  v_and_b32 v64, 0xffff0000, v64
  v_cvt_pk_bf16_f32 v65, v65, v65
  v_and_b32 v65, 0xffff0000, v65
  v_add_f32 v65, 0x3727c5ac, v65
  v_cvt_pk_bf16_f32 v65, v65, v65
  v_and_b32 v65, 0xffff0000, v65
  v_sqrt_f32_e64 v65, v65
  v_fma_f32 v64, v68, v69, v64
  v_cvt_pk_bf16_f32 v65, v65, v65
  v_and_b32 v65, 0xffff0000, v65
  v_rcp_f32 v65, v65
  v_mul_f32 v68, v68, v69
  v_sub_f32 v68, 0, v68
  v_mul_f32 v70, v69, v65
  v_mul_f32 v71, v64, v65
  v_sub_f32 v71, 0, v71
  s_mov_b32 exec_lo, 0x00010001
  s_mov_b32 exec_hi, 0x00010001
  buffer_store_dwordx2 v[70:71], v13, s[4:7], s50 offen sc1
  buffer_store_dwordx2 v[68:69], v13, s[4:7], s55 offen sc1
  s_mov_b64 exec, -1
  s_waitcnt lgkmcnt(0)
  s_barrier
  s_cmp_lg_u32 s33, 0
  s_cbranch_scc1 k1_nocs
  v_lshlrev_b32 v4, 3, v1
  ds_read_b64 v[16:17], v4 offset:36864
  ds_read_b64 v[18:19], v4 offset:37376
  ds_read_b64 v[20:21], v4 offset:37888
  ds_read_b64 v[22:23], v4 offset:38400
  ds_read_b64 v[24:25], v4 offset:38912
  ds_read_b64 v[26:27], v4 offset:39424
  ds_read_b64 v[28:29], v4 offset:39936
  ds_read_b64 v[30:31], v4 offset:40448
  s_waitcnt lgkmcnt(0)
  v_add_f32 v16, v16, v18
  v_add_f32 v17, v17, v19
  v_add_f32 v16, v16, v20
  v_add_f32 v17, v17, v21
  v_add_f32 v16, v16, v22
  v_add_f32 v17, v17, v23
  v_add_f32 v16, v16, v24
  v_add_f32 v17, v17, v25
  v_add_f32 v16, v16, v26
  v_add_f32 v17, v17, v27
  v_add_f32 v16, v16, v28
  v_add_f32 v17, v17, v29
  v_add_f32 v16, v16, v30
  v_add_f32 v17, v17, v31
  buffer_store_dwordx2 v[16:17], v4, s[4:7], s52 offen sc1
k1_nocs:
  s_waitcnt vmcnt(0)
  s_barrier
  s_cmp_lg_u32 s33, 0
  s_cbranch_scc1 k1_af
  v_mov_b32 v16, 1
  v_mov_b32 v17, 0
  s_lshl_b32 s55, s28, 5
  s_mov_b64 exec, 1
  buffer_atomic_add v16, v17, s[76:79], s55 offen sc1
  s_mov_b64 exec, -1
k1_af:
  s_branch k1_kv
k1_classB:
  s_xor_b32 s95, s28, 1
  s_lshl_b32 s95, s95, 19
  s_lshl_b32 s96, s94, 13
  s_add_u32 s95, s95, s96
  s_lshl_b32 s96, s94, 15
  s_and_b32 s97, s28, 1
  s_lshl_b32 s97, s97, 10
  s_add_u32 s96, s96, s97
  v_lshlrev_b32 v17, 7, v1
  v_lshrrev_b32 v18, 3, v1
  v_and_b32 v19, 7, v1
  v_lshlrev_b32 v19, 7, v19
  v_lshl_add_u32 v18, v18, 11, v19
  v_and_b32 v19, 15, v1
  v_lshlrev_b32 v19, 11, v19
  s_add_u32 s93, s96, 16384
  s_lshr_b32 s92, s94, 4
  s_lshr_b32 s97, s28, 1
  s_waitcnt lgkmcnt(0)
  s_cmp_lg_u32 s33, 5
  s_cbranch_scc1 k1_nofz
  v_mov_b32 v20, 0
  v_mov_b32 v21, 0
  v_mov_b32 v22, 0
  v_mov_b32 v23, 0
  s_lshl_b32 s56, s59, 3
  s_add_u32 s56, s56, s28
  s_mul_i32 s56, s56, 3072
  s_add_u32 s56, s56, 39845888
  buffer_store_dwordx4 v[20:23], v12, s[4:7], s56 offen offset:0 sc1
  buffer_store_dwordx4 v[20:23], v12, s[4:7], s56 offen offset:1024 sc1
  buffer_store_dwordx4 v[20:23], v12, s[4:7], s56 offen offset:2048 sc1
  v_mov_b32 v24, 1
  s_lshl_b32 s55, s28, 5
  s_waitcnt vmcnt(0)
  s_mov_b64 exec, 1
  buffer_atomic_add v24, v20, s[76:79], s55 offen sc1
  s_mov_b64 exec, -1
k1_nofz:
  buffer_load_dword v16, v17, s[8:11], s95 offen
  s_cmp_eq_u32 s92, s97
  s_cbranch_scc1 k1_now1
  buffer_load_dword v16, v18, s[12:15], s96 offen
  buffer_load_dword v16, v18, s[12:15], s93 offen
k1_now1:
  s_barrier
  s_lshl_b32 s37, s33, 12
  s_add_u32 m0, s37, 43008
  s_nop 0
  buffer_load_dwordx4 v7, s[16:19], 0 offen offset:0 nt lds
  buffer_load_dwordx4 v7, s[16:19], s40 offen offset:1024 nt lds
  buffer_load_dwordx4 v7, s[16:19], s41 offen offset:2048 nt lds
  buffer_load_dwordx4 v7, s[16:19], s42 offen offset:3072 nt lds
  buffer_load_dwordx4 v[108:111], v6, s[20:23], 0 offen offset:0 nt
  buffer_load_dwordx4 v[112:115], v6, s[20:23], 0 offen offset:2048 nt
  buffer_load_dwordx4 v[116:119], v9, s[20:23], 0 offen offset:0 nt
  buffer_load_dwordx4 v[120:123], v9, s[20:23], 0 offen offset:2048 nt
  s_cmp_ge_u32 s33, 4
  s_cbranch_scc1 recurrent_scan__ssm_conv_h3__mixer_s_mlp__prompt_kernel_b7
  s_cmp_ge_u32 s33, 2
  s_cbranch_scc1 recurrent_scan__ssm_conv_h3__mixer_s_mlp__prompt_kernel_b6
  s_add_u32 m0, s39, 40960
  s_nop 0
  buffer_load_dwordx4 v8, s[16:19], 0 offen lds
  s_branch recurrent_scan__ssm_conv_h3__mixer_s_mlp__prompt_kernel_b7
recurrent_scan__ssm_conv_h3__mixer_s_mlp__prompt_kernel_b6:
  s_add_u32 m0, s39, 73728
  s_nop 0
  buffer_load_dwordx4 v12, s[24:27], s38 offen lds
recurrent_scan__ssm_conv_h3__mixer_s_mlp__prompt_kernel_b7:
  s_waitcnt vmcnt(0)
  s_barrier
  buffer_load_dword v190, v19, s[84:87], s96 offen offset:384
k1_kv:
  v_lshlrev_b32 v4, 11, v3
  v_lshl_add_u32 v4, v2, 4, v4
  v_add_u32 v4, 41472, v4
  ds_read_b128 v[80:83], v4 offset:0
  ds_read_b128 v[84:87], v4 offset:512
  ds_read_b128 v[88:91], v4 offset:1024
  ds_read_b128 v[92:95], v4 offset:1536
  ds_read_b128 v[96:99], v4 offset:2048
  ds_read_b128 v[100:103], v4 offset:2560
  ds_read_b128 v[104:107], v4 offset:3072
  v_lshlrev_b32 v5, 6, v2
  v_add_u32 v5, 75776, v5
  ds_read_b128 v[124:127], v5 offset:0
  ds_read_b128 v[128:131], v5 offset:16
  ds_read_b128 v[132:135], v5 offset:32
  ds_read_b128 v[136:139], v5 offset:48
  v_and_b32 v15, 15, v1
  v_lshlrev_b32 v15, 7, v15
  s_lshl_b32 s54, s58, 11
  v_lshlrev_b32 v14, 7, v2
  buffer_load_dword v190, v15, s[84:87], s54 offen
  s_mul_i32 s50, s33, 4160
  s_add_u32 m0, s50, 90144
  s_nop 0
  buffer_load_dwordx4 v12, s[88:91], s51 offen offset:0 nt lds
  buffer_load_dwordx4 v12, s[88:91], s51 offen offset:1024 nt lds
  buffer_load_dwordx4 v12, s[88:91], s51 offen offset:2048 nt lds
  buffer_load_dwordx4 v12, s[88:91], s51 offen offset:3072 nt lds
  s_mul_i32 s46, s57, 2341
  s_lshr_b32 s46, s46, 16
  s_mul_i32 s47, s46, 28
  s_sub_u32 s47, s57, s47
  s_lshl_b32 s44, s46, 3
  s_add_u32 s44, s44, s33
  s_mul_i32 s44, s44, 229376
  s_lshl_b32 s45, s47, 8
  s_add_u32 s44, s44, s45
  s_mul_i32 s46, s46, 14336
  s_lshl_b32 s47, s47, 9
  s_add_u32 s46, s46, s47
  s_add_u32 s46, s46, 38797312
  v_lshrrev_b32 v10, 4, v1
  v_and_b32 v11, 15, v1
  v_mul_u32_u24 v13, 7168, v10
  v_lshl_add_u32 v13, v11, 4, v13
  v_lshlrev_b32 v10, 3, v10
  v_lshl_add_u32 v10, v11, 5, v10
  s_lshl_b32 s45, s33, 9
  v_add_u32 v10, s45, v10
  s_mov_b32 s92, s44
  s_mov_b32 s93, s46
  v_and_b32 v8, 7, v1
  v_lshlrev_b32 v8, 5, v8
  s_waitcnt lgkmcnt(0)
  v_lshlrev_b32 v48, 16, v80
  v_and_b32 v49, 0xffff0000, v80
  v_lshlrev_b32 v50, 16, v81
  v_and_b32 v51, 0xffff0000, v81
  v_lshlrev_b32 v52, 16, v84
  v_and_b32 v53, 0xffff0000, v84
  v_lshlrev_b32 v54, 16, v85
  v_and_b32 v55, 0xffff0000, v85
  v_lshlrev_b32 v56, 16, v88
  v_and_b32 v57, 0xffff0000, v88
  v_lshlrev_b32 v58, 16, v89
  v_and_b32 v59, 0xffff0000, v89
  v_lshlrev_b32 v60, 16, v92
  v_and_b32 v61, 0xffff0000, v92
  v_lshlrev_b32 v62, 16, v93
  v_and_b32 v63, 0xffff0000, v93
  v_lshlrev_b32 v64, 16, v96
  v_and_b32 v65, 0xffff0000, v96
  v_lshlrev_b32 v66, 16, v97
  v_and_b32 v67, 0xffff0000, v97
  v_lshlrev_b32 v68, 16, v100
  v_and_b32 v69, 0xffff0000, v100
  v_lshlrev_b32 v70, 16, v101
  v_and_b32 v71, 0xffff0000, v101
  v_lshlrev_b32 v72, 16, v104
  v_and_b32 v73, 0xffff0000, v104
  v_lshlrev_b32 v74, 16, v105
  v_and_b32 v75, 0xffff0000, v105
  v_lshlrev_b32 v140, 16, v124
  v_and_b32 v144, 0xffff0000, v124
  v_lshlrev_b32 v148, 16, v125
  v_and_b32 v152, 0xffff0000, v125
  v_lshlrev_b32 v141, 16, v126
  v_and_b32 v145, 0xffff0000, v126
  v_lshlrev_b32 v149, 16, v127
  v_and_b32 v153, 0xffff0000, v127
  v_lshlrev_b32 v142, 16, v128
  v_and_b32 v146, 0xffff0000, v128
  v_lshlrev_b32 v150, 16, v129
  v_and_b32 v154, 0xffff0000, v129
  v_lshlrev_b32 v143, 16, v130
  v_and_b32 v147, 0xffff0000, v130
  v_lshlrev_b32 v151, 16, v131
  v_and_b32 v155, 0xffff0000, v131
  v_lshlrev_b32 v76, 16, v108
  v_and_b32 v77, 0xffff0000, v108
  v_lshlrev_b32_e64 v78, 16, v109
  v_and_b32 v79, 0xffff0000, v109
  v_pk_mul_f32 v[156:157], v[48:49], v[152:153]
  v_pk_mul_f32 v[158:159], v[50:51], v[154:155]
  v_pk_fma_f32 v[156:157], v[52:53], v[148:149], v[156:157]
  v_pk_fma_f32 v[158:159], v[54:55], v[150:151], v[158:159]
  v_pk_fma_f32 v[156:157], v[56:57], v[144:145], v[156:157]
  v_pk_fma_f32 v[158:159], v[58:59], v[146:147], v[158:159]
  v_pk_fma_f32 v[156:157], v[60:61], v[140:141], v[156:157]
  v_pk_fma_f32 v[158:159], v[62:63], v[142:143], v[158:159]
  v_pk_mul_f32 v[156:157], v[156:157], v[76:77]
  v_pk_mul_f32 v[158:159], v[158:159], v[78:79]
  v_cvt_pk_bf16_f32 v160, v156, v157
  v_cvt_pk_bf16_f32 v161, v158, v159
  v_lshlrev_b32 v76, 16, v112
  v_and_b32 v77, 0xffff0000, v112
  v_lshlrev_b32 v78, 16, v113
  v_and_b32 v79, 0xffff0000, v113
  v_pk_mul_f32 v[156:157], v[52:53], v[152:153]
  v_pk_mul_f32 v[158:159], v[54:55], v[154:155]
  v_pk_fma_f32 v[156:157], v[56:57], v[148:149], v[156:157]
  v_pk_fma_f32 v[158:159], v[58:59], v[150:151], v[158:159]
  v_pk_fma_f32 v[156:157], v[60:61], v[144:145], v[156:157]
  v_pk_fma_f32 v[158:159], v[62:63], v[146:147], v[158:159]
  v_pk_fma_f32 v[156:157], v[64:65], v[140:141], v[156:157]
  v_pk_fma_f32 v[158:159], v[66:67], v[142:143], v[158:159]
  v_pk_mul_f32 v[156:157], v[156:157], v[76:77]
  v_pk_mul_f32 v[158:159], v[158:159], v[78:79]
  v_cvt_pk_bf16_f32 v164, v156, v157
  v_cvt_pk_bf16_f32 v165, v158, v159
  v_lshlrev_b32 v76, 16, v116
  v_and_b32 v77, 0xffff0000, v116
  v_lshlrev_b32 v78, 16, v117
  v_and_b32 v79, 0xffff0000, v117
  v_pk_mul_f32 v[156:157], v[56:57], v[152:153]
  v_pk_mul_f32 v[158:159], v[58:59], v[154:155]
  v_pk_fma_f32 v[156:157], v[60:61], v[148:149], v[156:157]
  v_pk_fma_f32 v[158:159], v[62:63], v[150:151], v[158:159]
  v_pk_fma_f32 v[156:157], v[64:65], v[144:145], v[156:157]
  v_pk_fma_f32 v[158:159], v[66:67], v[146:147], v[158:159]
  v_pk_fma_f32 v[156:157], v[68:69], v[140:141], v[156:157]
  v_pk_fma_f32 v[158:159], v[70:71], v[142:143], v[158:159]
  v_pk_mul_f32 v[156:157], v[156:157], v[76:77]
  v_pk_mul_f32 v[158:159], v[158:159], v[78:79]
  v_cvt_pk_bf16_f32 v168, v156, v157
  v_cvt_pk_bf16_f32 v169, v158, v159
  v_lshlrev_b32 v76, 16, v120
  v_and_b32 v77, 0xffff0000, v120
  v_lshlrev_b32 v78, 16, v121
  v_and_b32 v79, 0xffff0000, v121
  v_pk_mul_f32 v[156:157], v[60:61], v[152:153]
  v_pk_mul_f32 v[158:159], v[62:63], v[154:155]
  v_pk_fma_f32 v[156:157], v[64:65], v[148:149], v[156:157]
  v_pk_fma_f32 v[158:159], v[66:67], v[150:151], v[158:159]
  v_pk_fma_f32 v[156:157], v[68:69], v[144:145], v[156:157]
  v_pk_fma_f32 v[158:159], v[70:71], v[146:147], v[158:159]
  v_pk_fma_f32 v[156:157], v[72:73], v[140:141], v[156:157]
  v_pk_fma_f32 v[158:159], v[74:75], v[142:143], v[158:159]
  v_pk_mul_f32 v[156:157], v[156:157], v[76:77]
  v_pk_mul_f32 v[158:159], v[158:159], v[78:79]
  v_cvt_pk_bf16_f32 v172, v156, v157
  v_cvt_pk_bf16_f32 v173, v158, v159
  v_lshlrev_b32 v48, 16, v82
  v_and_b32 v49, 0xffff0000, v82
  v_lshlrev_b32 v50, 16, v83
  v_and_b32 v51, 0xffff0000, v83
  v_lshlrev_b32 v52, 16, v86
  v_and_b32 v53, 0xffff0000, v86
  v_lshlrev_b32 v54, 16, v87
  v_and_b32 v55, 0xffff0000, v87
  v_lshlrev_b32 v56, 16, v90
  v_and_b32 v57, 0xffff0000, v90
  v_lshlrev_b32 v58, 16, v91
  v_and_b32 v59, 0xffff0000, v91
  v_lshlrev_b32 v60, 16, v94
  v_and_b32 v61, 0xffff0000, v94
  v_lshlrev_b32 v62, 16, v95
  v_and_b32 v63, 0xffff0000, v95
  v_lshlrev_b32 v64, 16, v98
  v_and_b32 v65, 0xffff0000, v98
  v_lshlrev_b32 v66, 16, v99
  v_and_b32 v67, 0xffff0000, v99
  v_lshlrev_b32 v68, 16, v102
  v_and_b32 v69, 0xffff0000, v102
  v_lshlrev_b32 v70, 16, v103
  v_and_b32 v71, 0xffff0000, v103
  v_lshlrev_b32 v72, 16, v106
  v_and_b32 v73, 0xffff0000, v106
  v_lshlrev_b32 v74, 16, v107
  v_and_b32 v75, 0xffff0000, v107
  v_lshlrev_b32 v140, 16, v132
  v_and_b32 v144, 0xffff0000, v132
  v_lshlrev_b32 v148, 16, v133
  v_and_b32 v152, 0xffff0000, v133
  v_lshlrev_b32 v141, 16, v134
  v_and_b32 v145, 0xffff0000, v134
  v_lshlrev_b32 v149, 16, v135
  v_and_b32 v153, 0xffff0000, v135
  v_lshlrev_b32 v142, 16, v136
  v_and_b32 v146, 0xffff0000, v136
  v_lshlrev_b32 v150, 16, v137
  v_and_b32 v154, 0xffff0000, v137
  v_lshlrev_b32 v143, 16, v138
  v_and_b32 v147, 0xffff0000, v138
  v_lshlrev_b32 v151, 16, v139
  v_and_b32 v155, 0xffff0000, v139
  v_lshlrev_b32 v76, 16, v110
  v_and_b32 v77, 0xffff0000, v110
  v_lshlrev_b32 v78, 16, v111
  v_and_b32 v79, 0xffff0000, v111
  v_pk_mul_f32 v[156:157], v[48:49], v[152:153]
  v_pk_mul_f32 v[158:159], v[50:51], v[154:155]
  v_pk_fma_f32 v[156:157], v[52:53], v[148:149], v[156:157]
  v_pk_fma_f32 v[158:159], v[54:55], v[150:151], v[158:159]
  v_pk_fma_f32 v[156:157], v[56:57], v[144:145], v[156:157]
  v_pk_fma_f32 v[158:159], v[58:59], v[146:147], v[158:159]
  v_pk_fma_f32 v[156:157], v[60:61], v[140:141], v[156:157]
  v_pk_fma_f32 v[158:159], v[62:63], v[142:143], v[158:159]
  v_pk_mul_f32 v[156:157], v[156:157], v[76:77]
  v_pk_mul_f32 v[158:159], v[158:159], v[78:79]
  v_cvt_pk_bf16_f32 v162, v156, v157
  v_cvt_pk_bf16_f32 v163, v158, v159
  v_lshlrev_b32 v76, 16, v114
  v_and_b32 v77, 0xffff0000, v114
  v_lshlrev_b32 v78, 16, v115
  v_and_b32 v79, 0xffff0000, v115
  v_pk_mul_f32 v[156:157], v[52:53], v[152:153]
  v_pk_mul_f32 v[158:159], v[54:55], v[154:155]
  v_pk_fma_f32 v[156:157], v[56:57], v[148:149], v[156:157]
  v_pk_fma_f32 v[158:159], v[58:59], v[150:151], v[158:159]
  v_pk_fma_f32 v[156:157], v[60:61], v[144:145], v[156:157]
  v_pk_fma_f32 v[158:159], v[62:63], v[146:147], v[158:159]
  v_pk_fma_f32 v[156:157], v[64:65], v[140:141], v[156:157]
  v_pk_fma_f32 v[158:159], v[66:67], v[142:143], v[158:159]
  v_pk_mul_f32 v[156:157], v[156:157], v[76:77]
  v_pk_mul_f32 v[158:159], v[158:159], v[78:79]
  v_cvt_pk_bf16_f32 v166, v156, v157
  v_cvt_pk_bf16_f32 v167, v158, v159
  v_lshlrev_b32 v76, 16, v118
  v_and_b32 v77, 0xffff0000, v118
  v_lshlrev_b32 v78, 16, v119
  v_and_b32 v79, 0xffff0000, v119
  v_pk_mul_f32 v[156:157], v[56:57], v[152:153]
  v_pk_mul_f32 v[158:159], v[58:59], v[154:155]
  v_pk_fma_f32 v[156:157], v[60:61], v[148:149], v[156:157]
  v_pk_fma_f32 v[158:159], v[62:63], v[150:151], v[158:159]
  v_pk_fma_f32 v[156:157], v[64:65], v[144:145], v[156:157]
  v_pk_fma_f32 v[158:159], v[66:67], v[146:147], v[158:159]
  v_pk_fma_f32 v[156:157], v[68:69], v[140:141], v[156:157]
  v_pk_fma_f32 v[158:159], v[70:71], v[142:143], v[158:159]
  v_pk_mul_f32 v[156:157], v[156:157], v[76:77]
  v_pk_mul_f32 v[158:159], v[158:159], v[78:79]
  v_cvt_pk_bf16_f32 v170, v156, v157
  v_cvt_pk_bf16_f32 v171, v158, v159
  v_lshlrev_b32 v76, 16, v122
  v_and_b32 v77, 0xffff0000, v122
  v_lshlrev_b32 v78, 16, v123
  v_and_b32 v79, 0xffff0000, v123
  v_pk_mul_f32 v[156:157], v[60:61], v[152:153]
  v_pk_mul_f32 v[158:159], v[62:63], v[154:155]
  v_pk_fma_f32 v[156:157], v[64:65], v[148:149], v[156:157]
  v_pk_fma_f32 v[158:159], v[66:67], v[150:151], v[158:159]
  v_pk_fma_f32 v[156:157], v[68:69], v[144:145], v[156:157]
  v_pk_fma_f32 v[158:159], v[70:71], v[146:147], v[158:159]
  v_pk_fma_f32 v[156:157], v[72:73], v[140:141], v[156:157]
  v_pk_fma_f32 v[158:159], v[74:75], v[142:143], v[158:159]
  v_pk_mul_f32 v[156:157], v[156:157], v[76:77]
  v_pk_mul_f32 v[158:159], v[158:159], v[78:79]
  v_cvt_pk_bf16_f32 v174, v156, v157
  v_cvt_pk_bf16_f32 v175, v158, v159
  v_mul_u32_u24 v4, 544, v3
  v_lshl_add_u32 v4, v2, 4, v4
  ds_write_b128 v4, v[160:163] offset:0
  ds_write_b128 v4, v[164:167] offset:8832
  ds_write_b128 v4, v[168:171] offset:17664
  ds_write_b128 v4, v[172:175] offset:26496
  v_lshrrev_b32_e64 v4, 4, v1
  v_mul_u32_u24 v5, 8832, v4
  v_bfe_u32 v6, v1, 2, 2
  v_bfe_u32 v7, v1, 1, 1
  v_lshl_add_u32 v6, v7, 3, v6
  v_mul_u32_u24 v6, 544, v6
  v_add_u32 v5, v5, v6
  v_and_b32 v6, 1, v1
  v_lshl_add_u32 v5, v6, 3, v5
  s_lshl_b32 s36, s33, 6
  v_add_u32 v5, s36, v5
  v_lshlrev_b32 v6, 4, v1
  s_lshl_b32 s38, s35, 20
  s_lshl_b32 s39, s33, 17
  s_add_u32 s38, s38, s39
  s_lshl_b32 s39, s34, 10
  s_add_u32 s38, s38, s39
  s_add_u32 s38, s38, 50331648
  s_waitcnt lgkmcnt(0)
  s_barrier
  s_cmp_lg_u32 s33, 0
  s_cbranch_scc1 k1_nozl
  buffer_load_dword v9, v8, s[76:79], 0 offen sc1
k1_nozl:
  ds_read_b64_tr_b16 v[48:49], v5 offset:0
  ds_read_b64_tr_b16 v[50:51], v5 offset:2176
  ds_read_b64_tr_b16 v[52:53], v5 offset:16
  ds_read_b64_tr_b16 v[54:55], v5 offset:2192
  ds_read_b64_tr_b16 v[56:57], v5 offset:32
  ds_read_b64_tr_b16 v[58:59], v5 offset:2208
  ds_read_b64_tr_b16 v[60:61], v5 offset:48
  ds_read_b64_tr_b16 v[62:63], v5 offset:2224
  s_waitcnt lgkmcnt(6)
  buffer_store_dwordx4 v[48:51], v6, s[4:7], s38 offen sc1
  s_add_u32 s38, s38, 32768
  s_waitcnt lgkmcnt(4)
  buffer_store_dwordx4 v[52:55], v6, s[4:7], s38 offen sc1
  s_add_u32 s38, s38, 32768
  s_waitcnt lgkmcnt(2)
  buffer_store_dwordx4 v[56:59], v6, s[4:7], s38 offen sc1
  s_add_u32 s38, s38, 32768
  s_waitcnt lgkmcnt(0)
  buffer_store_dwordx4 v[60:63], v6, s[4:7], s38 offen sc1
  s_mov_b32 s45, 0x00003f80
  s_mov_b32 s47, 0x3f800000
  v_mov_b32 v64, 0
  v_mov_b32 v65, 0
  v_mov_b32 v66, 0
  v_mov_b32 v67, 0
  v_mov_b32 v68, 0
  v_mov_b32 v69, 0
  v_mov_b32 v70, 0
  v_mov_b32 v71, 0
  v_mov_b32 v72, 1
  v_mov_b32 v73, 0
  s_lshl_b32 s54, s35, 7
  s_add_u32 s54, s54, 39960576
  s_lshr_b32 s56, s57, 5
  s_lshl_b32 s56, s56, 7
  s_add_u32 s56, s56, 39960576
  s_waitcnt vmcnt(0)
  s_barrier
  s_cmp_lg_u32 s33, 0
  s_cbranch_scc1 k1_w3
k1_zpoll:
  v_cmp_gt_u32 vcc, 16, v9
  s_nop 4
  s_cbranch_vccz k1_zok
  s_sleep 8
  buffer_load_dword v9, v8, s[76:79], 0 offen sc1
  s_waitcnt vmcnt(0)
  s_add_u32 s101, s101, 1
  s_cmp_lt_u32 s101, 0x40000
  s_cbranch_scc1 k1_zpoll
k1_zok:
  s_mov_b64 exec, 1
  buffer_atomic_add v72, v73, s[4:7], s54 offen sc1
  s_mov_b64 exec, -1
k1_w3:
  s_barrier
  buffer_load_dwordx4 v[16:19], v13, s[80:83], s44 offen
  s_add_u32 s44, s44, 28672
  buffer_load_dwordx4 v[20:23], v13, s[80:83], s44 offen
  s_add_u32 s44, s44, 28672
  buffer_load_dwordx4 v[24:27], v13, s[80:83], s44 offen
  s_add_u32 s44, s44, 28672
  buffer_load_dwordx4 v[28:31], v13, s[80:83], s44 offen
  s_add_u32 s44, s44, 28672
  buffer_load_dwordx4 v[32:35], v13, s[80:83], s44 offen
  s_add_u32 s44, s44, 28672
  buffer_load_dwordx4 v[36:39], v13, s[80:83], s44 offen
  s_add_u32 s44, s44, 28672
  buffer_load_dwordx4 v[40:43], v13, s[80:83], s44 offen
  s_add_u32 s44, s44, 28672
  buffer_load_dwordx4 v[44:47], v13, s[80:83], s44 offen
  s_waitcnt vmcnt(7)
  v_dot2c_f32_bf16 v64, s45, v16
  v_dot2c_f32_bf16 v65, s47, v16
  v_dot2c_f32_bf16 v66, s45, v17
  v_dot2c_f32_bf16 v67, s47, v17
  v_dot2c_f32_bf16 v68, s45, v18
  v_dot2c_f32_bf16 v69, s47, v18
  v_dot2c_f32_bf16 v70, s45, v19
  v_dot2c_f32_bf16 v71, s47, v19
  s_waitcnt vmcnt(6)
  v_dot2c_f32_bf16 v64, s45, v20
  v_dot2c_f32_bf16 v65, s47, v20
  v_dot2c_f32_bf16 v66, s45, v21
  v_dot2c_f32_bf16 v67, s47, v21
  v_dot2c_f32_bf16 v68, s45, v22
  v_dot2c_f32_bf16 v69, s47, v22
  v_dot2c_f32_bf16 v70, s45, v23
  v_dot2c_f32_bf16 v71, s47, v23
  s_waitcnt vmcnt(5)
  v_dot2c_f32_bf16 v64, s45, v24
  v_dot2c_f32_bf16 v65, s47, v24
  v_dot2c_f32_bf16 v66, s45, v25
  v_dot2c_f32_bf16 v67, s47, v25
  v_dot2c_f32_bf16 v68, s45, v26
  v_dot2c_f32_bf16 v69, s47, v26
  v_dot2c_f32_bf16 v70, s45, v27
  v_dot2c_f32_bf16 v71, s47, v27
  s_waitcnt vmcnt(4)
  v_dot2c_f32_bf16 v64, s45, v28
  v_dot2c_f32_bf16 v65, s47, v28
  v_dot2c_f32_bf16 v66, s45, v29
  v_dot2c_f32_bf16 v67, s47, v29
  v_dot2c_f32_bf16 v68, s45, v30
  v_dot2c_f32_bf16 v69, s47, v30
  v_dot2c_f32_bf16 v70, s45, v31
  v_dot2c_f32_bf16 v71, s47, v31
  s_waitcnt vmcnt(3)
  v_dot2c_f32_bf16 v64, s45, v32
  v_dot2c_f32_bf16 v65, s47, v32
  v_dot2c_f32_bf16 v66, s45, v33
  v_dot2c_f32_bf16 v67, s47, v33
  v_dot2c_f32_bf16 v68, s45, v34
  v_dot2c_f32_bf16 v69, s47, v34
  v_dot2c_f32_bf16 v70, s45, v35
  v_dot2c_f32_bf16 v71, s47, v35
  s_waitcnt vmcnt(2)
  v_dot2c_f32_bf16 v64, s45, v36
  v_dot2c_f32_bf16 v65, s47, v36
  v_dot2c_f32_bf16 v66, s45, v37
  v_dot2c_f32_bf16 v67, s47, v37
  v_dot2c_f32_bf16 v68, s45, v38
  v_dot2c_f32_bf16 v69, s47, v38
  v_dot2c_f32_bf16 v70, s45, v39
  v_dot2c_f32_bf16 v71, s47, v39
  s_waitcnt vmcnt(1)
  v_dot2c_f32_bf16 v64, s45, v40
  v_dot2c_f32_bf16 v65, s47, v40
  v_dot2c_f32_bf16 v66, s45, v41
  v_dot2c_f32_bf16 v67, s47, v41
  v_dot2c_f32_bf16 v68, s45, v42
  v_dot2c_f32_bf16 v69, s47, v42
  v_dot2c_f32_bf16 v70, s45, v43
  v_dot2c_f32_bf16 v71, s47, v43
  s_waitcnt vmcnt(0)
  v_dot2c_f32_bf16 v64, s45, v44
  v_dot2c_f32_bf16 v65, s47, v44
  v_dot2c_f32_bf16 v66, s45, v45
  v_dot2c_f32_bf16 v67, s47, v45
  v_dot2c_f32_bf16 v68, s45, v46
  v_dot2c_f32_bf16 v69, s47, v46
  v_dot2c_f32_bf16 v70, s45, v47
  v_dot2c_f32_bf16 v71, s47, v47
  v_permlane32_swap_b32 v64, v68
  v_permlane32_swap_b32 v65, v69
  v_permlane32_swap_b32 v66, v70
  v_permlane32_swap_b32 v67, v71
  v_add_f32 v64, v64, v68
  v_add_f32 v65, v65, v69
  v_add_f32 v66, v66, v70
  v_add_f32 v67, v67, v71
  s_nop 0
  v_permlane16_swap_b32 v64, v66
  v_permlane16_swap_b32 v65, v67
  v_add_f32 v64, v64, v66
  v_add_f32 v65, v65, v67
  ds_write_b64 v10, v[64:65] offset:36864
  s_waitcnt lgkmcnt(0)
  s_barrier
  s_cmp_lg_u32 s33, 1
  s_cbranch_scc1 k2_conv
  s_cmp_ge_u32 s57, 112
  s_cbranch_scc1 k2_conv
  v_lshlrev_b32 v4, 3, v1
  ds_read_b64 v[16:17], v4 offset:36864
  ds_read_b64 v[18:19], v4 offset:37376
  ds_read_b64 v[20:21], v4 offset:37888
  ds_read_b64 v[22:23], v4 offset:38400
  ds_read_b64 v[24:25], v4 offset:38912
  ds_read_b64 v[26:27], v4 offset:39424
  ds_read_b64 v[28:29], v4 offset:39936
  ds_read_b64 v[30:31], v4 offset:40448
  s_waitcnt lgkmcnt(0)
  v_add_f32 v16, v16, v18
  v_add_f32 v17, v17, v19
  v_add_f32 v16, v16, v20
  v_add_f32 v17, v17, v21
  v_add_f32 v16, v16, v22
  v_add_f32 v17, v17, v23
  v_add_f32 v16, v16, v24
  v_add_f32 v17, v17, v25
  v_add_f32 v16, v16, v26
  v_add_f32 v17, v17, v27
  v_add_f32 v16, v16, v28
  v_add_f32 v17, v17, v29
  v_add_f32 v16, v16, v30
  v_add_f32 v17, v17, v31
  buffer_store_dwordx2 v[16:17], v4, s[4:7], s46 offen sc1
  s_branch k2_conv
k2_conv:
  s_load_dwordx2 s[12:13], s[0:1], 80
  s_mov_b32 s14, 7340032
  s_mov_b32 s15, 0x20000
  s_load_dwordx2 s[16:17], s[0:1], 40
  s_lshl_b32 s29, s29, 3
  s_add_u32 s29, s29, s28
  s_lshl_b32 s87, s29, 2
  s_add_u32 s87, s87, 39944192
  s_lshl_b32 s59, s29, 3
  s_add_u32 s59, s59, s33
  s_mul_i32 s50, s33, 4160
  s_add_u32 s50, s50, 90112
  s_lshl_b32 s51, s59, 12
  s_add_u32 s52, s51, 50331648
  s_lshl_b32 s53, s59, 8
  s_add_u32 s53, s53, 20971520
  s_lshr_b32 s54, s59, 1
  s_lshl_b32 s54, s54, 2
  v_lshlrev_b32 v11, 4, v1
  s_lshl_b32 s48, s33, 4
  s_add_u32 s48, s48, 123392
  v_lshrrev_b32 v3, 3, v1
  v_mul_u32_u24 v3, 1056, v3
  v_and_b32 v4, 7, v1
  v_lshl_add_u32 v3, v4, 7, v3
  v_add_u32 v3, s48, v3
  v_and_b32 v4, 16, v11
  v_add_u32 v4, s50, v4
  v_cmp_gt_u32 vcc, 32, v1
  v_mov_b32 v32, 0
  v_mov_b32 v33, 0
  v_mov_b32 v34, 0
  v_mov_b32 v35, 0
  v_cndmask_b32 v3, v4, v3, vcc
  ds_write_b128 v3, v[32:35]
  v_lshrrev_b32 v3, 4, v1
  v_bfe_u32 v4, v1, 2, 2
  v_and_b32 v5, 3, v1
  v_lshlrev_b32 v12, 6, v3
  v_lshl_add_u32 v12, v4, 3, v12
  v_lshlrev_b32 v5, 3, v5
  v_sub_u32 v12, v5, v12
  v_add_u32 v12, 224, v12
  v_add_u32 v12, s50, v12
  v_and_b32 v4, 15, v1
  v_lshl_add_u32 v5, v3, 1, v4
  v_add_u32 v2, 1, v5
  v_and_b32 v13, 1, v2
  v_lshlrev_b32 v13, 3, v13
  v_bfe_u32 v6, v2, 1, 1
  v_lshl_add_u32 v13, v6, 7, v13
  v_lshrrev_b32 v2, 2, v2
  v_mul_u32_u24 v2, 1056, v2
  v_add3_u32 v13, v13, v2, s48
  v_add_u32 v2, 2, v5
  v_and_b32 v14, 1, v2
  v_lshlrev_b32 v14, 3, v14
  v_bfe_u32 v6, v2, 1, 1
  v_lshl_add_u32 v14, v6, 7, v14
  v_lshrrev_b32 v2, 2, v2
  v_mul_u32_u24 v2, 1056, v2
  v_add3_u32 v14, v14, v2, s48
  s_mul_i32 s49, s33, 4224
  s_waitcnt lgkmcnt(0)
  s_load_dword s55, s[16:17], s54
  ds_read_b64_tr_b16 a[0:1], v12 offset:32
  ds_read_b64_tr_b16 a[2:3], v12 offset:0
  ds_read_b64_tr_b16 a[4:5], v12 offset:288
  ds_read_b64_tr_b16 a[6:7], v12 offset:256
  ds_read_b64_tr_b16 a[8:9], v12 offset:544
  ds_read_b64_tr_b16 a[10:11], v12 offset:512
  ds_read_b64_tr_b16 a[12:13], v12 offset:800
  ds_read_b64_tr_b16 a[14:15], v12 offset:768
  ds_read_b64_tr_b16 a[16:17], v12 offset:1056
  ds_read_b64_tr_b16 a[18:19], v12 offset:1024
  ds_read_b64_tr_b16 a[20:21], v12 offset:1312
  ds_read_b64_tr_b16 a[22:23], v12 offset:1280
  ds_read_b64_tr_b16 a[24:25], v12 offset:1568
  ds_read_b64_tr_b16 a[26:27], v12 offset:1536
  ds_read_b64_tr_b16 a[28:29], v12 offset:1824
  ds_read_b64_tr_b16 a[30:31], v12 offset:1792
  ds_read_b64_tr_b16 a[32:33], v12 offset:2080
  ds_read_b64_tr_b16 a[34:35], v12 offset:2048
  ds_read_b64_tr_b16 a[36:37], v12 offset:2336
  ds_read_b64_tr_b16 a[38:39], v12 offset:2304
  ds_read_b64_tr_b16 a[40:41], v12 offset:2592
  ds_read_b64_tr_b16 a[42:43], v12 offset:2560
  ds_read_b64_tr_b16 a[44:45], v12 offset:2848
  ds_read_b64_tr_b16 a[46:47], v12 offset:2816
  ds_read_b64_tr_b16 a[48:49], v12 offset:3104
  ds_read_b64_tr_b16 a[50:51], v12 offset:3072
  ds_read_b64_tr_b16 a[52:53], v12 offset:3360
  ds_read_b64_tr_b16 a[54:55], v12 offset:3328
  ds_read_b64_tr_b16 a[56:57], v12 offset:3616
  ds_read_b64_tr_b16 a[58:59], v12 offset:3584
  ds_read_b64_tr_b16 a[60:61], v12 offset:3872
  ds_read_b64_tr_b16 a[62:63], v12 offset:3840
  s_cmp_lg_u32 s33, 0
  s_cbranch_scc1 k1_kok
  s_mov_b64 exec, 1
k1_kpoll:
  buffer_load_dword v25, v73, s[4:7], s56 offen sc1
  s_waitcnt vmcnt(0)
  v_readfirstlane_b32 s44, v25
  s_nop 0
  s_cmp_ge_u32 s44, 32
  s_cbranch_scc1 k1_kok
  s_sleep 4
  s_add_u32 s101, s101, 1
  s_cmp_lt_u32 s101, 0x40000
  s_cbranch_scc1 k1_kpoll
k1_kok:
  s_mov_b64 exec, -1
  s_barrier
  s_add_u32 m0, s49, 127616
  s_nop 0
  buffer_load_dwordx4 v11, s[4:7], s52 offen offset:0 sc1 lds
  s_add_u32 m0, s49, 127648
  s_nop 0
  buffer_load_dwordx4 v11, s[4:7], s52 offen offset:1024 sc1 lds
  s_add_u32 m0, s49, 127680
  s_nop 0
  buffer_load_dwordx4 v11, s[4:7], s52 offen offset:2048 sc1 lds
  s_add_u32 m0, s49, 127712
  s_nop 0
  buffer_load_dwordx4 v11, s[4:7], s52 offen offset:3072 sc1 lds
  s_waitcnt vmcnt(0) lgkmcnt(0)
  s_barrier
  ds_read_b64 v[16:17], v13 offset:0
  ds_read_b64 v[18:19], v14 offset:0
  ds_read_b64 v[20:21], v13 offset:31680
  ds_read_b64 v[22:23], v14 offset:31680
  ds_read_b64 v[24:25], v13 offset:256
  ds_read_b64 v[26:27], v14 offset:256
  s_waitcnt lgkmcnt(4)
  v_mfma_f32_16x16x32_bf16 v[64:67], a[4:7], v[16:19], 0
  ds_read_b64 v[28:29], v13 offset:31936
  ds_read_b64 v[30:31], v14 offset:31936
  v_mfma_f32_16x16x32_bf16 v[68:71], a[12:15], v[16:19], 0
  v_mov_b32 v36, 0
  v_mfma_f32_16x16x32_bf16 v[72:75], a[20:23], v[16:19], 0
  v_mov_b32 v37, 0
  v_mfma_f32_16x16x32_bf16 v[76:79], a[28:31], v[16:19], 0
  v_mov_b32 v38, 0
  v_mfma_f32_16x16x32_bf16 v[80:83], a[36:39], v[16:19], 0
  v_mov_b32 v39, 0
  v_mfma_f32_16x16x32_bf16 v[84:87], a[44:47], v[16:19], 0
  v_mov_b32 v40, 0
  v_mfma_f32_16x16x32_bf16 v[88:91], a[52:55], v[16:19], 0
  v_mov_b32 v41, 0
  v_mfma_f32_16x16x32_bf16 v[92:95], a[60:63], v[16:19], 0
  v_mov_b32 v42, 0
  s_waitcnt lgkmcnt(4)
  v_mfma_f32_16x16x32_bf16 v[92:95], a[0:3], v[20:23], v[92:95]
  ds_read_b64 v[16:17], v13 offset:512
  ds_read_b64 v[18:19], v14 offset:512
  s_waitcnt lgkmcnt(4)
  v_mfma_f32_16x16x32_bf16 v[96:99], a[4:7], v[24:27], 0
  ds_read_b64 v[20:21], v13 offset:32192
  ds_read_b64 v[22:23], v14 offset:32192
  v_mfma_f32_16x16x32_bf16 v[100:103], a[12:15], v[24:27], 0
  v_mov_b32 v43, 0
  v_mfma_f32_16x16x32_bf16 v[104:107], a[20:23], v[24:27], 0
  v_mov_b32 v44, 0
  v_mfma_f32_16x16x32_bf16 v[108:111], a[28:31], v[24:27], 0
  v_mov_b32 v45, 0
  v_mfma_f32_16x16x32_bf16 v[112:115], a[36:39], v[24:27], 0
  v_mov_b32 v46, 0
  v_mfma_f32_16x16x32_bf16 v[116:119], a[44:47], v[24:27], 0
  v_mov_b32 v47, 0
  v_mfma_f32_16x16x32_bf16 v[120:123], a[52:55], v[24:27], 0
  v_mov_b32 v48, 0
  v_mfma_f32_16x16x32_bf16 v[124:127], a[60:63], v[24:27], 0
  v_mov_b32 v49, 0
  s_waitcnt lgkmcnt(4)
  v_mfma_f32_16x16x32_bf16 v[124:127], a[0:3], v[28:31], v[124:127]
  ds_read_b64 v[24:25], v13 offset:768
  ds_read_b64 v[26:27], v14 offset:768
  s_waitcnt lgkmcnt(4)
  v_mfma_f32_16x16x32_bf16 v[128:131], a[4:7], v[16:19], 0
  ds_read_b64 v[28:29], v13 offset:32448
  ds_read_b64 v[30:31], v14 offset:32448
  v_mfma_f32_16x16x32_bf16 v[132:135], a[12:15], v[16:19], 0
  v_mov_b32 v50, 0
  v_mfma_f32_16x16x32_bf16 v[136:139], a[20:23], v[16:19], 0
  v_mov_b32 v51, 0
  v_mfma_f32_16x16x32_bf16 v[140:143], a[28:31], v[16:19], 0
  v_mov_b32 v52, 0
  v_mfma_f32_16x16x32_bf16 v[144:147], a[36:39], v[16:19], 0
  v_mov_b32 v53, 0
  v_mfma_f32_16x16x32_bf16 v[148:151], a[44:47], v[16:19], 0
  v_mov_b32 v54, 0
  v_mfma_f32_16x16x32_bf16 v[152:155], a[52:55], v[16:19], 0
  v_mov_b32 v55, 0
  v_mfma_f32_16x16x32_bf16 v[156:159], a[60:63], v[16:19], 0
  v_mov_b32 v56, 0
  s_waitcnt lgkmcnt(4)
  v_mfma_f32_16x16x32_bf16 v[156:159], a[0:3], v[20:23], v[156:159]
  ds_read_b64 v[16:17], v13 offset:2112
  ds_read_b64 v[18:19], v14 offset:2112
  s_waitcnt lgkmcnt(4)
  v_mfma_f32_16x16x32_bf16 v[160:163], a[4:7], v[24:27], 0
  ds_read_b64 v[20:21], v13 offset:29568
  ds_read_b64 v[22:23], v14 offset:29568
  v_mfma_f32_16x16x32_bf16 v[164:167], a[12:15], v[24:27], 0
  v_mov_b32 v57, 0
  v_mfma_f32_16x16x32_bf16 v[168:171], a[20:23], v[24:27], 0
  v_mov_b32 v58, 0
  v_mfma_f32_16x16x32_bf16 v[172:175], a[28:31], v[24:27], 0
  v_mov_b32 v59, 0
  v_mfma_f32_16x16x32_bf16 v[176:179], a[36:39], v[24:27], 0
  v_mov_b32 v60, 0
  v_mfma_f32_16x16x32_bf16 v[180:183], a[44:47], v[24:27], 0
  v_mov_b32 v61, 0
  v_mfma_f32_16x16x32_bf16 v[184:187], a[52:55], v[24:27], 0
  v_mov_b32 v62, 0
  v_mfma_f32_16x16x32_bf16 v[188:191], a[60:63], v[24:27], 0
  v_mov_b32 v63, 0
  s_waitcnt lgkmcnt(4)
  v_mfma_f32_16x16x32_bf16 v[188:191], a[0:3], v[28:31], v[188:191]
  ds_read_b64 v[24:25], v13 offset:2368
  ds_read_b64 v[26:27], v14 offset:2368
  s_waitcnt lgkmcnt(4)
  v_mfma_f32_16x16x32_bf16 v[64:67], a[0:3], v[16:19], v[64:67]
  ds_read_b64 v[28:29], v13 offset:29824
  ds_read_b64 v[30:31], v14 offset:29824
  v_mfma_f32_16x16x32_bf16 v[68:71], a[8:11], v[16:19], v[68:71]
  v_lshl_add_u32 v2, v4, 2, v3
  v_mfma_f32_16x16x32_bf16 v[72:75], a[16:19], v[16:19], v[72:75]
  v_and_b32 v10, 7, v2
  v_mfma_f32_16x16x32_bf16 v[76:79], a[24:27], v[16:19], v[76:79]
  v_lshlrev_b32 v10, 1, v10
  v_mfma_f32_16x16x32_bf16 v[80:83], a[32:35], v[16:19], v[80:83]
  v_bfe_u32 v6, v2, 3, 1
  v_mfma_f32_16x16x32_bf16 v[84:87], a[40:43], v[16:19], v[84:87]
  v_lshl_add_u32 v10, v6, 7, v10
  v_mfma_f32_16x16x32_bf16 v[88:91], a[48:51], v[16:19], v[88:91]
  v_lshrrev_b32 v2, 4, v2
  v_mfma_f32_16x16x32_bf16 v[92:95], a[56:59], v[16:19], v[92:95]
  v_mul_u32_u24 v2, 1056, v2
  s_waitcnt lgkmcnt(4)
  v_mfma_f32_16x16x32_bf16 v[92:95], a[4:7], v[20:23], v[92:95]
  ds_read_b64 v[16:17], v13 offset:2624
  ds_read_b64 v[18:19], v14 offset:2624
  s_waitcnt lgkmcnt(4)
  v_mfma_f32_16x16x32_bf16 v[96:99], a[0:3], v[24:27], v[96:99]
  ds_read_b64 v[20:21], v13 offset:30080
  ds_read_b64 v[22:23], v14 offset:30080
  v_mfma_f32_16x16x32_bf16 v[100:103], a[8:11], v[24:27], v[100:103]
  v_add_u32 v10, v10, v2
  v_mfma_f32_16x16x32_bf16 v[104:107], a[16:19], v[24:27], v[104:107]
  v_add_u32 v10, s48, v10
  v_mfma_f32_16x16x32_bf16 v[108:111], a[24:27], v[24:27], v[108:111]
  v_subrev_u32 v15, 16, v1
  v_mfma_f32_16x16x32_bf16 v[112:115], a[32:35], v[24:27], v[112:115]
  v_add_u32 v5, 47, v1
  v_mfma_f32_16x16x32_bf16 v[116:119], a[40:43], v[24:27], v[116:119]
  v_cmp_gt_u32 vcc, 16, v1
  v_mfma_f32_16x16x32_bf16 v[120:123], a[48:51], v[24:27], v[120:123]
  s_nop 0
  v_cndmask_b32 v15, v15, v5, vcc
  v_mfma_f32_16x16x32_bf16 v[124:127], a[56:59], v[24:27], v[124:127]
  v_mov_b32 v5, 63
  s_waitcnt lgkmcnt(4)
  v_mfma_f32_16x16x32_bf16 v[124:127], a[4:7], v[28:31], v[124:127]
  ds_read_b64 v[24:25], v13 offset:2880
  ds_read_b64 v[26:27], v14 offset:2880
  s_waitcnt lgkmcnt(4)
  v_mfma_f32_16x16x32_bf16 v[128:131], a[0:3], v[16:19], v[128:131]
  ds_read_b64 v[28:29], v13 offset:30336
  ds_read_b64 v[30:31], v14 offset:30336
  v_mfma_f32_16x16x32_bf16 v[132:135], a[8:11], v[16:19], v[132:135]
  v_cmp_eq_u32 vcc, 0, v1
  v_mfma_f32_16x16x32_bf16 v[136:139], a[16:19], v[16:19], v[136:139]
  s_nop 0
  v_cndmask_b32 v15, v15, v5, vcc
  v_mfma_f32_16x16x32_bf16 v[140:143], a[24:27], v[16:19], v[140:143]
  v_lshlrev_b32 v15, 2, v15
  v_mfma_f32_16x16x32_bf16 v[144:147], a[32:35], v[16:19], v[144:147]
  v_and_b32 v5, 1, v3
  v_mfma_f32_16x16x32_bf16 v[148:151], a[40:43], v[16:19], v[148:151]
  v_lshlrev_b32 v5, 1, v5
  v_mfma_f32_16x16x32_bf16 v[152:155], a[48:51], v[16:19], v[152:155]
  v_lshrrev_b32 v6, 3, v4
  v_mfma_f32_16x16x32_bf16 v[156:159], a[56:59], v[16:19], v[156:159]
  v_add_u32 v5, v5, v6
  s_waitcnt lgkmcnt(4)
  v_mfma_f32_16x16x32_bf16 v[156:159], a[4:7], v[20:23], v[156:159]
  ds_read_b64 v[16:17], v13 offset:4224
  ds_read_b64 v[18:19], v14 offset:4224
  s_waitcnt lgkmcnt(4)
  v_mfma_f32_16x16x32_bf16 v[160:163], a[0:3], v[24:27], v[160:163]
  ds_read_b64 v[20:21], v13 offset:27456
  ds_read_b64 v[22:23], v14 offset:27456
  v_mfma_f32_16x16x32_bf16 v[164:167], a[8:11], v[24:27], v[164:167]
  v_lshlrev_b32 v5, 18, v5
  v_mfma_f32_16x16x32_bf16 v[168:171], a[16:19], v[24:27], v[168:171]
  v_and_b32 v6, 7, v4
  v_mfma_f32_16x16x32_bf16 v[172:175], a[24:27], v[24:27], v[172:175]
  v_lshl_add_u32 v5, v6, 5, v5
  v_mfma_f32_16x16x32_bf16 v[176:179], a[32:35], v[24:27], v[176:179]
  v_lshrrev_b32 v3, 1, v3
  v_mfma_f32_16x16x32_bf16 v[180:183], a[40:43], v[24:27], v[180:183]
  v_lshl_add_u32 v5, v3, 4, v5
  v_mfma_f32_16x16x32_bf16 v[184:187], a[48:51], v[24:27], v[184:187]
  v_cmp_eq_u32 s[56:57], 63, v1
  v_mfma_f32_16x16x32_bf16 v[188:191], a[56:59], v[24:27], v[188:191]
  s_bitcmp1_b32 s59, 0
  s_waitcnt lgkmcnt(4)
  v_mfma_f32_16x16x32_bf16 v[188:191], a[4:7], v[28:31], v[188:191]
  ds_read_b64 v[24:25], v13 offset:4480
  ds_read_b64 v[26:27], v14 offset:4480
  s_waitcnt lgkmcnt(4)
  v_mfma_f32_16x16x32_bf16 v[68:71], a[4:7], v[16:19], v[68:71]
  ds_read_b64 v[28:29], v13 offset:27712
  ds_read_b64 v[30:31], v14 offset:27712
  v_mfma_f32_16x16x32_bf16 v[72:75], a[12:15], v[16:19], v[72:75]
  s_cselect_b32 s54, 0, 16
  v_mfma_f32_16x16x32_bf16 v[76:79], a[20:23], v[16:19], v[76:79]
  s_lshl_b32 s55, s55, s54
  v_mfma_f32_16x16x32_bf16 v[80:83], a[28:31], v[16:19], v[80:83]
  s_and_b32 s55, s55, 0xffff0000
  v_mfma_f32_16x16x32_bf16 v[84:87], a[36:39], v[16:19], v[84:87]
  v_mov_b32 v2, 0
  v_mfma_f32_16x16x32_bf16 v[88:91], a[44:47], v[16:19], v[88:91]
  ds_read_u16_d16_hi v32, v10 offset:4224
  v_mfma_f32_16x16x32_bf16 v[92:95], a[52:55], v[16:19], v[92:95]
  ds_read_u16_d16_hi v33, v10 offset:4480
  s_waitcnt lgkmcnt(6)
  v_mfma_f32_16x16x32_bf16 v[88:91], a[0:3], v[20:23], v[88:91]
  ds_read_b64 v[16:17], v13 offset:4736
  ds_read_b64 v[18:19], v14 offset:4736
  v_mfma_f32_16x16x32_bf16 v[92:95], a[8:11], v[20:23], v[92:95]
  ds_read_u16_d16_hi v34, v10 offset:4736
  s_waitcnt lgkmcnt(7)
  v_mfma_f32_16x16x32_bf16 v[100:103], a[4:7], v[24:27], v[100:103]
  ds_read_b64 v[20:21], v13 offset:27968
  ds_read_b64 v[22:23], v14 offset:27968
  v_mfma_f32_16x16x32_bf16 v[104:107], a[12:15], v[24:27], v[104:107]
  ds_read_u16_d16_hi v35, v10 offset:4992
  v_mfma_f32_16x16x32_bf16 v[108:111], a[20:23], v[24:27], v[108:111]
  ds_read_u16_d16_hi v36, v10 offset:8448
  v_mfma_f32_16x16x32_bf16 v[112:115], a[28:31], v[24:27], v[112:115]
  ds_read_u16_d16_hi v37, v10 offset:8704
  v_mfma_f32_16x16x32_bf16 v[116:119], a[36:39], v[24:27], v[116:119]
  ds_read_u16_d16_hi v38, v10 offset:8960
  v_mfma_f32_16x16x32_bf16 v[120:123], a[44:47], v[24:27], v[120:123]
  ds_read_u16_d16_hi v39, v10 offset:9216
  v_mfma_f32_16x16x32_bf16 v[124:127], a[52:55], v[24:27], v[124:127]
  ds_read_u16_d16_hi v40, v10 offset:12672
  s_waitcnt lgkmcnt(13)
  v_mfma_f32_16x16x32_bf16 v[120:123], a[0:3], v[28:31], v[120:123]
  ds_read_b64 v[24:25], v13 offset:4992
  ds_read_b64 v[26:27], v14 offset:4992
  v_mfma_f32_16x16x32_bf16 v[124:127], a[8:11], v[28:31], v[124:127]
  ds_read_u16_d16_hi v41, v10 offset:12928
  s_waitcnt lgkmcnt(12)
  v_mfma_f32_16x16x32_bf16 v[132:135], a[4:7], v[16:19], v[132:135]
  ds_read_b64 v[28:29], v13 offset:28224
  ds_read_b64 v[30:31], v14 offset:28224
  v_mfma_f32_16x16x32_bf16 v[136:139], a[12:15], v[16:19], v[136:139]
  ds_read_u16_d16_hi v42, v10 offset:13184
  v_mfma_f32_16x16x32_bf16 v[140:143], a[20:23], v[16:19], v[140:143]
  ds_read_u16_d16_hi v43, v10 offset:13440
  v_mfma_f32_16x16x32_bf16 v[144:147], a[28:31], v[16:19], v[144:147]
  ds_read_u16_d16_hi v44, v10 offset:16896
  v_mfma_f32_16x16x32_bf16 v[148:151], a[36:39], v[16:19], v[148:151]
  ds_read_u16_d16_hi v45, v10 offset:17152
  v_mfma_f32_16x16x32_bf16 v[152:155], a[44:47], v[16:19], v[152:155]
  ds_read_u16_d16_hi v46, v10 offset:17408
  v_mfma_f32_16x16x32_bf16 v[156:159], a[52:55], v[16:19], v[156:159]
  ds_read_u16_d16_hi v47, v10 offset:17664
  s_waitcnt lgkmcnt(15)
  v_mfma_f32_16x16x32_bf16 v[152:155], a[0:3], v[20:23], v[152:155]
  ds_read_b64 v[16:17], v13 offset:6336
  ds_read_b64 v[18:19], v14 offset:6336
  v_mfma_f32_16x16x32_bf16 v[156:159], a[8:11], v[20:23], v[156:159]
  ds_read_u16_d16_hi v48, v10 offset:21120
  s_waitcnt lgkmcnt(12)
  v_mfma_f32_16x16x32_bf16 v[164:167], a[4:7], v[24:27], v[164:167]
  ds_read_b64 v[20:21], v13 offset:25344
  ds_read_b64 v[22:23], v14 offset:25344
  v_mfma_f32_16x16x32_bf16 v[168:171], a[12:15], v[24:27], v[168:171]
  ds_read_u16_d16_hi v49, v10 offset:21376
  v_mfma_f32_16x16x32_bf16 v[172:175], a[20:23], v[24:27], v[172:175]
  ds_read_u16_d16_hi v50, v10 offset:21632
  v_mfma_f32_16x16x32_bf16 v[176:179], a[28:31], v[24:27], v[176:179]
  ds_read_u16_d16_hi v51, v10 offset:21888
  v_mfma_f32_16x16x32_bf16 v[180:183], a[36:39], v[24:27], v[180:183]
  ds_read_u16_d16_hi v52, v10 offset:25344
  v_mfma_f32_16x16x32_bf16 v[184:187], a[44:47], v[24:27], v[184:187]
  ds_read_u16_d16_hi v53, v10 offset:25600
  v_mfma_f32_16x16x32_bf16 v[188:191], a[52:55], v[24:27], v[188:191]
  ds_read_u16_d16_hi v54, v10 offset:25856
  s_waitcnt lgkmcnt(15)
  v_mfma_f32_16x16x32_bf16 v[184:187], a[0:3], v[28:31], v[184:187]
  ds_read_b64 v[24:25], v13 offset:6592
  ds_read_b64 v[26:27], v14 offset:6592
  v_mfma_f32_16x16x32_bf16 v[188:191], a[8:11], v[28:31], v[188:191]
  ds_read_u16_d16_hi v55, v10 offset:26112
  s_waitcnt lgkmcnt(12)
  v_mfma_f32_16x16x32_bf16 v[68:71], a[0:3], v[16:19], v[68:71]
  ds_read_b64 v[28:29], v13 offset:25600
  ds_read_b64 v[30:31], v14 offset:25600
  v_mfma_f32_16x16x32_bf16 v[72:75], a[8:11], v[16:19], v[72:75]
  ds_read_u16_d16_hi v56, v10 offset:29568
  v_mfma_f32_16x16x32_bf16 v[76:79], a[16:19], v[16:19], v[76:79]
  ds_read_u16_d16_hi v57, v10 offset:29824
  v_mfma_f32_16x16x32_bf16 v[80:83], a[24:27], v[16:19], v[80:83]
  ds_read_u16_d16_hi v58, v10 offset:30080
  v_mfma_f32_16x16x32_bf16 v[84:87], a[32:35], v[16:19], v[84:87]
  ds_read_u16_d16_hi v59, v10 offset:30336
  v_mfma_f32_16x16x32_bf16 v[88:91], a[40:43], v[16:19], v[88:91]
  ds_read_u16_d16_hi v60, v10 offset:33792
  v_mfma_f32_16x16x32_bf16 v[92:95], a[48:51], v[16:19], v[92:95]
  ds_read_u16_d16_hi v61, v10 offset:34048
  s_waitcnt lgkmcnt(15)
  v_mfma_f32_16x16x32_bf16 v[88:91], a[4:7], v[20:23], v[88:91]
  ds_read_b64 v[16:17], v13 offset:6848
  ds_read_b64 v[18:19], v14 offset:6848
  v_mfma_f32_16x16x32_bf16 v[92:95], a[12:15], v[20:23], v[92:95]
  ds_read_u16_d16_hi v62, v10 offset:34304
  s_waitcnt lgkmcnt(12)
  v_mfma_f32_16x16x32_bf16 v[100:103], a[0:3], v[24:27], v[100:103]
  ds_read_b64 v[20:21], v13 offset:25856
  ds_read_b64 v[22:23], v14 offset:25856
  v_mfma_f32_16x16x32_bf16 v[104:107], a[8:11], v[24:27], v[104:107]
  ds_read_u16_d16_hi v63, v10 offset:34560
  v_mfma_f32_16x16x32_bf16 v[108:111], a[16:19], v[24:27], v[108:111]
  v_mfma_f32_16x16x32_bf16 v[112:115], a[24:27], v[24:27], v[112:115]
  v_mfma_f32_16x16x32_bf16 v[116:119], a[32:35], v[24:27], v[116:119]
  v_mfma_f32_16x16x32_bf16 v[120:123], a[40:43], v[24:27], v[120:123]
  v_mfma_f32_16x16x32_bf16 v[124:127], a[48:51], v[24:27], v[124:127]
  s_waitcnt lgkmcnt(12)
  v_mfma_f32_16x16x32_bf16 v[120:123], a[4:7], v[28:31], v[120:123]
  ds_read_b64 v[24:25], v13 offset:7104
  ds_read_b64 v[26:27], v14 offset:7104
  v_mfma_f32_16x16x32_bf16 v[124:127], a[12:15], v[28:31], v[124:127]
  s_waitcnt lgkmcnt(6)
  v_mfma_f32_16x16x32_bf16 v[132:135], a[0:3], v[16:19], v[132:135]
  ds_read_b64 v[28:29], v13 offset:26112
  ds_read_b64 v[30:31], v14 offset:26112
  v_mfma_f32_16x16x32_bf16 v[136:139], a[8:11], v[16:19], v[136:139]
  v_mfma_f32_16x16x32_bf16 v[140:143], a[16:19], v[16:19], v[140:143]
  v_mfma_f32_16x16x32_bf16 v[144:147], a[24:27], v[16:19], v[144:147]
  v_mfma_f32_16x16x32_bf16 v[148:151], a[32:35], v[16:19], v[148:151]
  v_mfma_f32_16x16x32_bf16 v[152:155], a[40:43], v[16:19], v[152:155]
  v_mfma_f32_16x16x32_bf16 v[156:159], a[48:51], v[16:19], v[156:159]
  s_waitcnt lgkmcnt(5)
  v_mfma_f32_16x16x32_bf16 v[152:155], a[4:7], v[20:23], v[152:155]
  ds_read_b64 v[16:17], v13 offset:8448
  ds_read_b64 v[18:19], v14 offset:8448
  v_mfma_f32_16x16x32_bf16 v[156:159], a[12:15], v[20:23], v[156:159]
  s_waitcnt lgkmcnt(4)
  v_mfma_f32_16x16x32_bf16 v[164:167], a[0:3], v[24:27], v[164:167]
  ds_read_b64 v[20:21], v13 offset:23232
  ds_read_b64 v[22:23], v14 offset:23232
  v_mfma_f32_16x16x32_bf16 v[168:171], a[8:11], v[24:27], v[168:171]
  v_mfma_f32_16x16x32_bf16 v[172:175], a[16:19], v[24:27], v[172:175]
  v_mfma_f32_16x16x32_bf16 v[176:179], a[24:27], v[24:27], v[176:179]
  v_mfma_f32_16x16x32_bf16 v[180:183], a[32:35], v[24:27], v[180:183]
  v_mfma_f32_16x16x32_bf16 v[184:187], a[40:43], v[24:27], v[184:187]
  v_mfma_f32_16x16x32_bf16 v[188:191], a[48:51], v[24:27], v[188:191]
  s_waitcnt lgkmcnt(4)
  v_mfma_f32_16x16x32_bf16 v[184:187], a[4:7], v[28:31], v[184:187]
  ds_read_b64 v[24:25], v13 offset:8704
  ds_read_b64 v[26:27], v14 offset:8704
  v_mfma_f32_16x16x32_bf16 v[188:191], a[12:15], v[28:31], v[188:191]
  s_waitcnt lgkmcnt(4)
  v_mfma_f32_16x16x32_bf16 v[72:75], a[4:7], v[16:19], v[72:75]
  ds_read_b64 v[28:29], v13 offset:23488
  ds_read_b64 v[30:31], v14 offset:23488
  v_mfma_f32_16x16x32_bf16 v[76:79], a[12:15], v[16:19], v[76:79]
  v_mfma_f32_16x16x32_bf16 v[80:83], a[20:23], v[16:19], v[80:83]
  v_mfma_f32_16x16x32_bf16 v[84:87], a[28:31], v[16:19], v[84:87]
  v_mfma_f32_16x16x32_bf16 v[88:91], a[36:39], v[16:19], v[88:91]
  v_mfma_f32_16x16x32_bf16 v[92:95], a[44:47], v[16:19], v[92:95]
  s_waitcnt lgkmcnt(4)
  v_mfma_f32_16x16x32_bf16 v[84:87], a[0:3], v[20:23], v[84:87]
  ds_read_b64 v[16:17], v13 offset:8960
  ds_read_b64 v[18:19], v14 offset:8960
  v_mfma_f32_16x16x32_bf16 v[88:91], a[8:11], v[20:23], v[88:91]
  v_mfma_f32_16x16x32_bf16 v[92:95], a[16:19], v[20:23], v[92:95]
  s_waitcnt lgkmcnt(4)
  v_mfma_f32_16x16x32_bf16 v[104:107], a[4:7], v[24:27], v[104:107]
  ds_read_b64 v[20:21], v13 offset:23744
  ds_read_b64 v[22:23], v14 offset:23744
  v_mfma_f32_16x16x32_bf16 v[108:111], a[12:15], v[24:27], v[108:111]
  v_mfma_f32_16x16x32_bf16 v[112:115], a[20:23], v[24:27], v[112:115]
  v_mfma_f32_16x16x32_bf16 v[116:119], a[28:31], v[24:27], v[116:119]
  v_mfma_f32_16x16x32_bf16 v[120:123], a[36:39], v[24:27], v[120:123]
  v_mfma_f32_16x16x32_bf16 v[124:127], a[44:47], v[24:27], v[124:127]
  s_waitcnt lgkmcnt(4)
  v_mfma_f32_16x16x32_bf16 v[116:119], a[0:3], v[28:31], v[116:119]
  ds_read_b64 v[24:25], v13 offset:9216
  ds_read_b64 v[26:27], v14 offset:9216
  v_mfma_f32_16x16x32_bf16 v[120:123], a[8:11], v[28:31], v[120:123]
  v_mfma_f32_16x16x32_bf16 v[124:127], a[16:19], v[28:31], v[124:127]
  s_waitcnt lgkmcnt(4)
  v_mfma_f32_16x16x32_bf16 v[136:139], a[4:7], v[16:19], v[136:139]
  ds_read_b64 v[28:29], v13 offset:24000
  ds_read_b64 v[30:31], v14 offset:24000
  v_mfma_f32_16x16x32_bf16 v[140:143], a[12:15], v[16:19], v[140:143]
  v_mfma_f32_16x16x32_bf16 v[144:147], a[20:23], v[16:19], v[144:147]
  v_mfma_f32_16x16x32_bf16 v[148:151], a[28:31], v[16:19], v[148:151]
  v_mfma_f32_16x16x32_bf16 v[152:155], a[36:39], v[16:19], v[152:155]
  v_mfma_f32_16x16x32_bf16 v[156:159], a[44:47], v[16:19], v[156:159]
  s_waitcnt lgkmcnt(4)
  v_mfma_f32_16x16x32_bf16 v[148:151], a[0:3], v[20:23], v[148:151]
  ds_read_b64 v[16:17], v13 offset:10560
  ds_read_b64 v[18:19], v14 offset:10560
  v_mfma_f32_16x16x32_bf16 v[152:155], a[8:11], v[20:23], v[152:155]
  v_mfma_f32_16x16x32_bf16 v[156:159], a[16:19], v[20:23], v[156:159]
  s_waitcnt lgkmcnt(4)
  v_mfma_f32_16x16x32_bf16 v[168:171], a[4:7], v[24:27], v[168:171]
  ds_read_b64 v[20:21], v13 offset:21120
  ds_read_b64 v[22:23], v14 offset:21120
  v_mfma_f32_16x16x32_bf16 v[172:175], a[12:15], v[24:27], v[172:175]
  v_mfma_f32_16x16x32_bf16 v[176:179], a[20:23], v[24:27], v[176:179]
  v_mfma_f32_16x16x32_bf16 v[180:183], a[28:31], v[24:27], v[180:183]
  v_mfma_f32_16x16x32_bf16 v[184:187], a[36:39], v[24:27], v[184:187]
  v_mfma_f32_16x16x32_bf16 v[188:191], a[44:47], v[24:27], v[188:191]
  s_waitcnt lgkmcnt(4)
  v_mfma_f32_16x16x32_bf16 v[180:183], a[0:3], v[28:31], v[180:183]
  ds_read_b64 v[24:25], v13 offset:10816
  ds_read_b64 v[26:27], v14 offset:10816
  v_mfma_f32_16x16x32_bf16 v[184:187], a[8:11], v[28:31], v[184:187]
  v_mfma_f32_16x16x32_bf16 v[188:191], a[16:19], v[28:31], v[188:191]
  s_waitcnt lgkmcnt(4)
  v_mfma_f32_16x16x32_bf16 v[72:75], a[0:3], v[16:19], v[72:75]
  ds_read_b64 v[28:29], v13 offset:21376
  ds_read_b64 v[30:31], v14 offset:21376
  v_mfma_f32_16x16x32_bf16 v[76:79], a[8:11], v[16:19], v[76:79]
  v_mfma_f32_16x16x32_bf16 v[80:83], a[16:19], v[16:19], v[80:83]
  v_mfma_f32_16x16x32_bf16 v[84:87], a[24:27], v[16:19], v[84:87]
  v_mfma_f32_16x16x32_bf16 v[88:91], a[32:35], v[16:19], v[88:91]
  v_mfma_f32_16x16x32_bf16 v[92:95], a[40:43], v[16:19], v[92:95]
  s_waitcnt lgkmcnt(4)
  v_mfma_f32_16x16x32_bf16 v[84:87], a[4:7], v[20:23], v[84:87]
  ds_read_b64 v[16:17], v13 offset:11072
  ds_read_b64 v[18:19], v14 offset:11072
  v_mfma_f32_16x16x32_bf16 v[88:91], a[12:15], v[20:23], v[88:91]
  v_mfma_f32_16x16x32_bf16 v[92:95], a[20:23], v[20:23], v[92:95]
  s_waitcnt lgkmcnt(4)
  v_mfma_f32_16x16x32_bf16 v[104:107], a[0:3], v[24:27], v[104:107]
  ds_read_b64 v[20:21], v13 offset:21632
  ds_read_b64 v[22:23], v14 offset:21632
  v_mfma_f32_16x16x32_bf16 v[108:111], a[8:11], v[24:27], v[108:111]
  v_mfma_f32_16x16x32_bf16 v[112:115], a[16:19], v[24:27], v[112:115]
  v_mfma_f32_16x16x32_bf16 v[116:119], a[24:27], v[24:27], v[116:119]
  v_mfma_f32_16x16x32_bf16 v[120:123], a[32:35], v[24:27], v[120:123]
  v_mfma_f32_16x16x32_bf16 v[124:127], a[40:43], v[24:27], v[124:127]
  s_waitcnt lgkmcnt(4)
  v_mfma_f32_16x16x32_bf16 v[116:119], a[4:7], v[28:31], v[116:119]
  ds_read_b64 v[24:25], v13 offset:11328
  ds_read_b64 v[26:27], v14 offset:11328
  v_mfma_f32_16x16x32_bf16 v[120:123], a[12:15], v[28:31], v[120:123]
  v_mfma_f32_16x16x32_bf16 v[124:127], a[20:23], v[28:31], v[124:127]
  s_waitcnt lgkmcnt(4)
  v_mfma_f32_16x16x32_bf16 v[136:139], a[0:3], v[16:19], v[136:139]
  ds_read_b64 v[28:29], v13 offset:21888
  ds_read_b64 v[30:31], v14 offset:21888
  v_mfma_f32_16x16x32_bf16 v[140:143], a[8:11], v[16:19], v[140:143]
  v_mfma_f32_16x16x32_bf16 v[144:147], a[16:19], v[16:19], v[144:147]
  v_mfma_f32_16x16x32_bf16 v[148:151], a[24:27], v[16:19], v[148:151]
  v_mfma_f32_16x16x32_bf16 v[152:155], a[32:35], v[16:19], v[152:155]
  v_mfma_f32_16x16x32_bf16 v[156:159], a[40:43], v[16:19], v[156:159]
  s_waitcnt lgkmcnt(4)
  v_mfma_f32_16x16x32_bf16 v[148:151], a[4:7], v[20:23], v[148:151]
  ds_read_b64 v[16:17], v13 offset:12672
  ds_read_b64 v[18:19], v14 offset:12672
  v_mfma_f32_16x16x32_bf16 v[152:155], a[12:15], v[20:23], v[152:155]
  v_mfma_f32_16x16x32_bf16 v[156:159], a[20:23], v[20:23], v[156:159]
  s_waitcnt lgkmcnt(4)
  v_mfma_f32_16x16x32_bf16 v[168:171], a[0:3], v[24:27], v[168:171]
  ds_read_b64 v[20:21], v13 offset:19008
  ds_read_b64 v[22:23], v14 offset:19008
  v_mfma_f32_16x16x32_bf16 v[172:175], a[8:11], v[24:27], v[172:175]
  v_mfma_f32_16x16x32_bf16 v[176:179], a[16:19], v[24:27], v[176:179]
  v_mfma_f32_16x16x32_bf16 v[180:183], a[24:27], v[24:27], v[180:183]
  v_mfma_f32_16x16x32_bf16 v[184:187], a[32:35], v[24:27], v[184:187]
  v_mfma_f32_16x16x32_bf16 v[188:191], a[40:43], v[24:27], v[188:191]
  s_waitcnt lgkmcnt(4)
  v_mfma_f32_16x16x32_bf16 v[180:183], a[4:7], v[28:31], v[180:183]
  ds_read_b64 v[24:25], v13 offset:12928
  ds_read_b64 v[26:27], v14 offset:12928
  v_mfma_f32_16x16x32_bf16 v[184:187], a[12:15], v[28:31], v[184:187]
  v_mfma_f32_16x16x32_bf16 v[188:191], a[20:23], v[28:31], v[188:191]
  s_waitcnt lgkmcnt(4)
  v_mfma_f32_16x16x32_bf16 v[76:79], a[4:7], v[16:19], v[76:79]
  ds_read_b64 v[28:29], v13 offset:19264
  ds_read_b64 v[30:31], v14 offset:19264
  v_mfma_f32_16x16x32_bf16 v[80:83], a[12:15], v[16:19], v[80:83]
  v_mfma_f32_16x16x32_bf16 v[84:87], a[20:23], v[16:19], v[84:87]
  v_mfma_f32_16x16x32_bf16 v[88:91], a[28:31], v[16:19], v[88:91]
  v_mfma_f32_16x16x32_bf16 v[92:95], a[36:39], v[16:19], v[92:95]
  s_waitcnt lgkmcnt(4)
  v_mfma_f32_16x16x32_bf16 v[80:83], a[0:3], v[20:23], v[80:83]
  ds_read_b64 v[16:17], v13 offset:13184
  ds_read_b64 v[18:19], v14 offset:13184
  v_mfma_f32_16x16x32_bf16 v[84:87], a[8:11], v[20:23], v[84:87]
  v_mfma_f32_16x16x32_bf16 v[88:91], a[16:19], v[20:23], v[88:91]
  v_mfma_f32_16x16x32_bf16 v[92:95], a[24:27], v[20:23], v[92:95]
  s_waitcnt lgkmcnt(4)
  v_mfma_f32_16x16x32_bf16 v[108:111], a[4:7], v[24:27], v[108:111]
  ds_read_b64 v[20:21], v13 offset:19520
  ds_read_b64 v[22:23], v14 offset:19520
  v_mfma_f32_16x16x32_bf16 v[112:115], a[12:15], v[24:27], v[112:115]
  v_mfma_f32_16x16x32_bf16 v[116:119], a[20:23], v[24:27], v[116:119]
  v_mfma_f32_16x16x32_bf16 v[120:123], a[28:31], v[24:27], v[120:123]
  v_mfma_f32_16x16x32_bf16 v[124:127], a[36:39], v[24:27], v[124:127]
  s_waitcnt lgkmcnt(4)
  v_mfma_f32_16x16x32_bf16 v[112:115], a[0:3], v[28:31], v[112:115]
  ds_read_b64 v[24:25], v13 offset:13440
  ds_read_b64 v[26:27], v14 offset:13440
  v_mfma_f32_16x16x32_bf16 v[116:119], a[8:11], v[28:31], v[116:119]
  v_mfma_f32_16x16x32_bf16 v[120:123], a[16:19], v[28:31], v[120:123]
  v_mfma_f32_16x16x32_bf16 v[124:127], a[24:27], v[28:31], v[124:127]
  s_waitcnt lgkmcnt(4)
  v_mfma_f32_16x16x32_bf16 v[140:143], a[4:7], v[16:19], v[140:143]
  ds_read_b64 v[28:29], v13 offset:19776
  ds_read_b64 v[30:31], v14 offset:19776
  v_mfma_f32_16x16x32_bf16 v[144:147], a[12:15], v[16:19], v[144:147]
  v_mfma_f32_16x16x32_bf16 v[148:151], a[20:23], v[16:19], v[148:151]
  v_mfma_f32_16x16x32_bf16 v[152:155], a[28:31], v[16:19], v[152:155]
  v_mfma_f32_16x16x32_bf16 v[156:159], a[36:39], v[16:19], v[156:159]
  s_waitcnt lgkmcnt(4)
  v_mfma_f32_16x16x32_bf16 v[144:147], a[0:3], v[20:23], v[144:147]
  ds_read_b64 v[16:17], v13 offset:14784
  ds_read_b64 v[18:19], v14 offset:14784
  v_mfma_f32_16x16x32_bf16 v[148:151], a[8:11], v[20:23], v[148:151]
  v_mfma_f32_16x16x32_bf16 v[152:155], a[16:19], v[20:23], v[152:155]
  v_mfma_f32_16x16x32_bf16 v[156:159], a[24:27], v[20:23], v[156:159]
  s_waitcnt lgkmcnt(4)
  v_mfma_f32_16x16x32_bf16 v[172:175], a[4:7], v[24:27], v[172:175]
  ds_read_b64 v[20:21], v13 offset:16896
  ds_read_b64 v[22:23], v14 offset:16896
  v_mfma_f32_16x16x32_bf16 v[176:179], a[12:15], v[24:27], v[176:179]
  v_mfma_f32_16x16x32_bf16 v[180:183], a[20:23], v[24:27], v[180:183]
  v_mfma_f32_16x16x32_bf16 v[184:187], a[28:31], v[24:27], v[184:187]
  v_mfma_f32_16x16x32_bf16 v[188:191], a[36:39], v[24:27], v[188:191]
  s_waitcnt lgkmcnt(4)
  v_mfma_f32_16x16x32_bf16 v[176:179], a[0:3], v[28:31], v[176:179]
  ds_read_b64 v[24:25], v13 offset:15040
  ds_read_b64 v[26:27], v14 offset:15040
  v_mfma_f32_16x16x32_bf16 v[180:183], a[8:11], v[28:31], v[180:183]
  v_mfma_f32_16x16x32_bf16 v[184:187], a[16:19], v[28:31], v[184:187]
  v_mfma_f32_16x16x32_bf16 v[188:191], a[24:27], v[28:31], v[188:191]
  s_waitcnt lgkmcnt(4)
  v_mfma_f32_16x16x32_bf16 v[76:79], a[0:3], v[16:19], v[76:79]
  ds_read_b64 v[28:29], v13 offset:17152
  ds_read_b64 v[30:31], v14 offset:17152
  v_mfma_f32_16x16x32_bf16 v[80:83], a[8:11], v[16:19], v[80:83]
  v_mfma_f32_16x16x32_bf16 v[84:87], a[16:19], v[16:19], v[84:87]
  v_mfma_f32_16x16x32_bf16 v[88:91], a[24:27], v[16:19], v[88:91]
  v_mfma_f32_16x16x32_bf16 v[92:95], a[32:35], v[16:19], v[92:95]
  s_waitcnt lgkmcnt(4)
  v_mfma_f32_16x16x32_bf16 v[80:83], a[4:7], v[20:23], v[80:83]
  ds_read_b64 v[16:17], v13 offset:15296
  ds_read_b64 v[18:19], v14 offset:15296
  v_mfma_f32_16x16x32_bf16 v[84:87], a[12:15], v[20:23], v[84:87]
  v_mfma_f32_16x16x32_bf16 v[88:91], a[20:23], v[20:23], v[88:91]
  v_mfma_f32_16x16x32_bf16 v[92:95], a[28:31], v[20:23], v[92:95]
  s_waitcnt lgkmcnt(4)
  v_mfma_f32_16x16x32_bf16 v[108:111], a[0:3], v[24:27], v[108:111]
  ds_read_b64 v[20:21], v13 offset:17408
  ds_read_b64 v[22:23], v14 offset:17408
  v_mfma_f32_16x16x32_bf16 v[112:115], a[8:11], v[24:27], v[112:115]
  v_mfma_f32_16x16x32_bf16 v[116:119], a[16:19], v[24:27], v[116:119]
  v_mfma_f32_16x16x32_bf16 v[120:123], a[24:27], v[24:27], v[120:123]
  v_mfma_f32_16x16x32_bf16 v[124:127], a[32:35], v[24:27], v[124:127]
  s_waitcnt lgkmcnt(4)
  v_mfma_f32_16x16x32_bf16 v[112:115], a[4:7], v[28:31], v[112:115]
  ds_read_b64 v[24:25], v13 offset:15552
  ds_read_b64 v[26:27], v14 offset:15552
  v_mfma_f32_16x16x32_bf16 v[116:119], a[12:15], v[28:31], v[116:119]
  v_mfma_f32_16x16x32_bf16 v[120:123], a[20:23], v[28:31], v[120:123]
  v_mfma_f32_16x16x32_bf16 v[124:127], a[28:31], v[28:31], v[124:127]
  s_waitcnt lgkmcnt(4)
  v_mfma_f32_16x16x32_bf16 v[140:143], a[0:3], v[16:19], v[140:143]
  ds_read_b64 v[28:29], v13 offset:17664
  ds_read_b64 v[30:31], v14 offset:17664
  v_mfma_f32_16x16x32_bf16 v[144:147], a[8:11], v[16:19], v[144:147]
  v_mfma_f32_16x16x32_bf16 v[148:151], a[16:19], v[16:19], v[148:151]
  v_mfma_f32_16x16x32_bf16 v[152:155], a[24:27], v[16:19], v[152:155]
  v_mfma_f32_16x16x32_bf16 v[156:159], a[32:35], v[16:19], v[156:159]
  s_waitcnt lgkmcnt(4)
  v_mfma_f32_16x16x32_bf16 v[144:147], a[4:7], v[20:23], v[144:147]
  v_mfma_f32_16x16x32_bf16 v[148:151], a[12:15], v[20:23], v[148:151]
  v_mfma_f32_16x16x32_bf16 v[152:155], a[20:23], v[20:23], v[152:155]
  v_mfma_f32_16x16x32_bf16 v[156:159], a[28:31], v[20:23], v[156:159]
  s_waitcnt lgkmcnt(2)
  v_mfma_f32_16x16x32_bf16 v[172:175], a[0:3], v[24:27], v[172:175]
  v_mfma_f32_16x16x32_bf16 v[176:179], a[8:11], v[24:27], v[176:179]
  v_mfma_f32_16x16x32_bf16 v[180:183], a[16:19], v[24:27], v[180:183]
  v_mfma_f32_16x16x32_bf16 v[184:187], a[24:27], v[24:27], v[184:187]
  v_mfma_f32_16x16x32_bf16 v[188:191], a[32:35], v[24:27], v[188:191]
  s_waitcnt lgkmcnt(0)
  v_mfma_f32_16x16x32_bf16 v[176:179], a[4:7], v[28:31], v[176:179]
  v_mfma_f32_16x16x32_bf16 v[180:183], a[12:15], v[28:31], v[180:183]
  v_mfma_f32_16x16x32_bf16 v[184:187], a[20:23], v[28:31], v[184:187]
  v_mfma_f32_16x16x32_bf16 v[188:191], a[28:31], v[28:31], v[188:191]
  s_cmp_ge_u32 s33, 4
  s_cbranch_scc1 k2_nopf
  v_lshlrev_b32 v6, 7, v1
  s_lshl_b32 s44, s29, 2
  s_add_u32 s44, s44, s33
  s_mul_i32 s44, s44, 14336
  buffer_load_dword v9, v6, s[12:15], s44 offen
  s_add_u32 s44, s44, 6144
  buffer_load_dword v9, v6, s[12:15], s44 offen
k2_nopf:
  v_add_f32 v99, v99, v130
  v_add_f32 v99, v99, v161
  v_add_f32 v131, v131, v162
  v_add_f32 v103, v103, v134
  v_add_f32 v103, v103, v165
  v_add_f32 v135, v135, v166
  v_add_f32 v107, v107, v138
  v_add_f32 v107, v107, v169
  v_add_f32 v139, v139, v170
  v_add_f32 v111, v111, v142
  v_add_f32 v111, v111, v173
  v_add_f32 v143, v143, v174
  v_add_f32 v115, v115, v146
  v_add_f32 v115, v115, v177
  v_add_f32 v147, v147, v178
  v_add_f32 v119, v119, v150
  v_add_f32 v119, v119, v181
  v_add_f32 v151, v151, v182
  v_add_f32 v123, v123, v154
  v_add_f32 v123, v123, v185
  v_add_f32 v155, v155, v186
  v_add_f32 v127, v127, v158
  v_add_f32 v127, v127, v189
  v_add_f32_e64 v159, v159, v190
  v_cndmask_b32 v127, v127, v123, s[56:57]
  v_cndmask_b32 v159, v159, v155, s[56:57]
  v_cndmask_b32 v191, v191, v187, s[56:57]
  v_cndmask_b32 v123, v123, v119, s[56:57]
  v_cndmask_b32 v155, v155, v151, s[56:57]
  v_cndmask_b32 v187, v187, v183, s[56:57]
  v_cndmask_b32 v119, v119, v115, s[56:57]
  v_cndmask_b32 v151, v151, v147, s[56:57]
  v_cndmask_b32 v183, v183, v179, s[56:57]
  v_cndmask_b32 v115, v115, v111, s[56:57]
  v_cndmask_b32 v147, v147, v143, s[56:57]
  v_cndmask_b32 v179, v179, v175, s[56:57]
  v_cndmask_b32 v111, v111, v107, s[56:57]
  v_cndmask_b32 v143, v143, v139, s[56:57]
  v_cndmask_b32 v175, v175, v171, s[56:57]
  v_cndmask_b32 v107, v107, v103, s[56:57]
  v_cndmask_b32 v139, v139, v135, s[56:57]
  v_cndmask_b32 v171, v171, v167, s[56:57]
  v_cndmask_b32 v103, v103, v99, s[56:57]
  v_cndmask_b32 v135, v135, v131, s[56:57]
  v_cndmask_b32 v167, v167, v163, s[56:57]
  v_cndmask_b32 v99, v99, v2, s[56:57]
  v_cndmask_b32 v131, v131, v2, s[56:57]
  v_cndmask_b32 v163, v163, v2, s[56:57]
  ds_bpermute_b32 v99, v15, v99
  ds_bpermute_b32 v131, v15, v131
  ds_bpermute_b32 v163, v15, v163
  ds_bpermute_b32 v103, v15, v103
  ds_bpermute_b32 v135, v15, v135
  ds_bpermute_b32 v167, v15, v167
  ds_bpermute_b32 v107, v15, v107
  ds_bpermute_b32 v139, v15, v139
  ds_bpermute_b32 v171, v15, v171
  ds_bpermute_b32 v111, v15, v111
  ds_bpermute_b32 v143, v15, v143
  ds_bpermute_b32 v175, v15, v175
  ds_bpermute_b32 v115, v15, v115
  ds_bpermute_b32 v147, v15, v147
  ds_bpermute_b32 v179, v15, v179
  ds_bpermute_b32 v119, v15, v119
  ds_bpermute_b32 v151, v15, v151
  ds_bpermute_b32 v183, v15, v183
  ds_bpermute_b32 v123, v15, v123
  ds_bpermute_b32 v155, v15, v155
  ds_bpermute_b32 v187, v15, v187
  ds_bpermute_b32 v127, v15, v127
  ds_bpermute_b32 v159, v15, v159
  ds_bpermute_b32 v191, v15, v191
  v_add_f32 v65, v65, v96
  v_add_f32 v66, v66, v97
  v_add_f32 v67, v67, v98
  v_add_f32 v66, v66, v128
  v_add_f32 v67, v67, v129
  v_add_f32 v67, v67, v160
  v_fmac_f32 v64, s55, v32
  v_fmac_f32 v65, s55, v33
  v_fmac_f32 v66, s55, v34
  v_fmac_f32 v67, s55, v35
  v_add_f32 v69, v69, v100
  v_add_f32 v70, v70, v101
  v_add_f32 v71, v71, v102
  v_add_f32 v70, v70, v132
  v_add_f32 v71, v71, v133
  v_add_f32 v71, v71, v164
  v_fmac_f32 v68, s55, v36
  v_fmac_f32 v69, s55, v37
  v_fmac_f32 v70, s55, v38
  v_fmac_f32 v71, s55, v39
  v_add_f32 v73, v73, v104
  v_add_f32 v74, v74, v105
  v_add_f32 v75, v75, v106
  v_add_f32 v74, v74, v136
  v_add_f32 v75, v75, v137
  v_add_f32 v75, v75, v168
  v_fmac_f32 v72, s55, v40
  v_fmac_f32 v73, s55, v41
  v_fmac_f32 v74, s55, v42
  v_fmac_f32 v75, s55, v43
  v_add_f32 v77, v77, v108
  v_add_f32 v78, v78, v109
  v_add_f32 v79, v79, v110
  v_add_f32 v78, v78, v140
  v_add_f32 v79, v79, v141
  v_add_f32 v79, v79, v172
  v_fmac_f32 v76, s55, v44
  v_fmac_f32 v77, s55, v45
  v_fmac_f32 v78, s55, v46
  v_fmac_f32 v79, s55, v47
  v_add_f32 v81, v81, v112
  v_add_f32 v82, v82, v113
  v_add_f32 v83, v83, v114
  v_add_f32 v82, v82, v144
  v_add_f32 v83, v83, v145
  v_add_f32 v83, v83, v176
  v_fmac_f32 v80, s55, v48
  v_fmac_f32 v81, s55, v49
  v_fmac_f32 v82, s55, v50
  v_fmac_f32 v83, s55, v51
  v_add_f32 v85, v85, v116
  v_add_f32 v86, v86, v117
  v_add_f32 v87, v87, v118
  v_add_f32 v86, v86, v148
  v_add_f32 v87, v87, v149
  v_add_f32 v87, v87, v180
  v_fmac_f32 v84, s55, v52
  v_fmac_f32 v85, s55, v53
  v_fmac_f32 v86, s55, v54
  v_fmac_f32 v87, s55, v55
  v_add_f32 v89, v89, v120
  v_add_f32 v90, v90, v121
  v_add_f32 v91, v91, v122
  v_add_f32 v90, v90, v152
  v_add_f32 v91, v91, v153
  v_add_f32 v91, v91, v184
  v_fmac_f32 v88, s55, v56
  v_fmac_f32 v89, s55, v57
  v_fmac_f32 v90, s55, v58
  v_fmac_f32 v91, s55, v59
  v_add_f32 v93, v93, v124
  v_add_f32 v94, v94, v125
  v_add_f32 v95, v95, v126
  v_add_f32 v94, v94, v156
  v_add_f32 v95, v95, v157
  v_add_f32 v95, v95, v188
  v_fmac_f32 v92, s55, v60
  v_fmac_f32 v93, s55, v61
  v_fmac_f32 v94, s55, v62
  v_fmac_f32 v95, s55, v63
  s_waitcnt lgkmcnt(0)
  v_add_f32 v64, v64, v99
  v_add_f32 v65, v65, v131
  v_add_f32 v66, v66, v163
  v_add_f32 v68, v68, v103
  v_add_f32 v69, v69, v135
  v_add_f32_e64 v70, v70, v167
  v_cvt_pk_bf16_f32 v16, v64, v65
  v_cvt_pk_bf16_f32 v17, v66, v67
  v_cvt_pk_bf16_f32 v18, v68, v69
  v_cvt_pk_bf16_f32 v19, v70, v71
  s_nop 0
  v_permlane16_swap_b32 v16, v18
  v_permlane16_swap_b32 v17, v19
  buffer_store_dwordx4 v[16:19], v5, s[4:7], s53 offen sc1
  s_add_u32 s53, s53, 0x100000
  v_add_f32 v72, v72, v107
  v_add_f32 v73, v73, v139
  v_add_f32 v74, v74, v171
  v_add_f32 v76, v76, v111
  v_add_f32 v77, v77, v143
  v_add_f32_e64 v78, v78, v175
  v_cvt_pk_bf16_f32 v20, v72, v73
  v_cvt_pk_bf16_f32 v21, v74, v75
  v_cvt_pk_bf16_f32 v22, v76, v77
  v_cvt_pk_bf16_f32 v23, v78, v79
  s_nop 0
  v_permlane16_swap_b32 v20, v22
  v_permlane16_swap_b32 v21, v23
  buffer_store_dwordx4 v[20:23], v5, s[4:7], s53 offen sc1
  s_add_u32 s53, s53, 0x100000
  v_add_f32 v80, v80, v115
  v_add_f32 v81, v81, v147
  v_add_f32 v82, v82, v179
  v_add_f32 v84, v84, v119
  v_add_f32 v85, v85, v151
  v_add_f32_e64 v86, v86, v183
  v_cvt_pk_bf16_f32 v24, v80, v81
  v_cvt_pk_bf16_f32 v25, v82, v83
  v_cvt_pk_bf16_f32 v26, v84, v85
  v_cvt_pk_bf16_f32 v27, v86, v87
  s_nop 0
  v_permlane16_swap_b32 v24, v26
  v_permlane16_swap_b32 v25, v27
  buffer_store_dwordx4 v[24:27], v5, s[4:7], s53 offen sc1
  s_add_u32 s53, s53, 0x100000
  v_add_f32 v88, v88, v123
  v_add_f32 v89, v89, v155
  v_add_f32 v90, v90, v187
  v_add_f32 v92, v92, v127
  v_add_f32 v93, v93, v159
  v_add_f32_e64 v94, v94, v191
  v_cvt_pk_bf16_f32 v28, v88, v89
  v_cvt_pk_bf16_f32 v29, v90, v91
  v_cvt_pk_bf16_f32 v30, v92, v93
  v_cvt_pk_bf16_f32 v31, v94, v95
  s_nop 0
  v_permlane16_swap_b32 v28, v30
  v_permlane16_swap_b32 v29, v31
  buffer_store_dwordx4 v[28:31], v5, s[4:7], s53 offen sc1
  s_add_u32 s53, s53, 0x100000
  s_xor_b32 s33, s33, 4
  s_cmp_ge_u32 s33, 4
  s_cbranch_scc1 k3_lbody
  s_branch k3_cbody
recurrent_scan__ssm_conv_h3__mixer_s_mlp__prompt_kernel_end:
  s_endpgm
code_end:
  s_endpgm
.section .rodata,"a"
.p2align 6
.amdhsa_kernel recurrent_scan__ssm_conv_h3__mixer_s_mlp__prompt_kernel
  .amdhsa_next_free_vgpr 256
  .amdhsa_next_free_sgpr 102
  .amdhsa_accum_offset 192
  .amdhsa_group_segment_fixed_size 0
  .amdhsa_kernarg_size 112
  .amdhsa_user_sgpr_count 2
  .amdhsa_user_sgpr_kernarg_segment_ptr 1
  .amdhsa_system_sgpr_workgroup_id_x 1
  .amdhsa_float_denorm_mode_32 3
  .amdhsa_float_denorm_mode_16_64 3
.end_amdhsa_kernel
```
